```python
import torch

def _softmax(x, axis=-1):
    return torch.softmax(x, dim=axis)
def _gelu(x):
    return torch.nn.functional.gelu(x, approximate="tanh")
def _silu(x):
    return torch.nn.functional.silu(x)
def _sigmoid(x):
    return torch.sigmoid(x)
def _layernorm(x, axis=-1, eps=1e-5):
    m = x.mean(dim=axis, keepdim=True)
    v = x.var(dim=axis, keepdim=True, unbiased=False)
    return (x - m) / torch.sqrt(v + eps)
def _scatter_add(tgt, idx, src, axis=0):
    return tgt.clone().index_add_(axis, idx, src)
def _segment_sum(src, seg, n):
    out = torch.zeros((n,) + src.shape[1:], dtype=src.dtype)
    return out.index_add_(0, seg, src)
def _pad(x, pw):
    flat = tuple(v for pair in reversed(pw) for v in pair)
    return torch.nn.functional.pad(x, flat)

kernel_name = 'standalone__gqa_block_cached__near_ridge'

def setup_inputs():

    _w = (lambda a: (lambda t: t.to(torch.bfloat16) if t.is_floating_point() else t)(torch.as_tensor(a)))
    B, Sq, D = 8, 256, 512
    Hq, Hkv, Sk, Dh = 32, 32, 1024, 128
    assert Hq % Hkv == 0, (Hq, Hkv)
    return {
        "x": _w((lambda *s: torch.randn(*s, dtype=torch.bfloat16) * 0.8)(B, Sq, D)),
        "k_cache": _w((lambda *s: torch.randn(*s, dtype=torch.bfloat16) * 0.8)(B, Hkv, Sk, Dh)),
        "v_cache": _w((lambda *s: torch.randn(*s, dtype=torch.bfloat16) * 0.05)(B, Hkv, Sk, Dh)),
        "wq": _w((lambda *s: torch.randn(*s, dtype=torch.bfloat16) * 0.8)(D, Hq * Dh) * (D ** -0.5)),
        "wo": _w((lambda *s: torch.randn(*s, dtype=torch.bfloat16) * 0.05)(Hq * Dh, D) * ((Hq * Dh) ** -0.5)),
    }

def reference(x, k_cache, v_cache, wq, wo):
    B, Sq, D = x.shape
    Hq, Dh = 32, 128
    Hkv = k_cache.shape[1]
    rep = Hq // Hkv
    q = (lambda x, *d: x.permute(*d))((x @ wq).reshape(B, Sq, Hq, Dh), 0, 2, 1, 3)
    k = (lambda x, n, axis: torch.repeat_interleave(x, n, dim=axis))(k_cache, rep, axis=1)
    v = (lambda x, n, axis: torch.repeat_interleave(x, n, dim=axis))(v_cache, rep, axis=1)
    scores = torch.einsum("bhqd,bhkd->bhqk", q, k) * (Dh ** -0.5)
    p = _softmax(scores, axis=-1)
    o = torch.einsum("bhqk,bhkd->bhqd", p, v)
    return (lambda x, *d: x.permute(*d))(o, 0, 2, 1, 3).reshape(B, Sq, Hq * Dh) @ wo
```

```asm
; @launch kernel=attn_kernel grid=(256,1,1) block=(512,1,1) lds=163840
; @launch kernel=oproj_kernel grid=(256,1,1) block=(512,1,1) lds=131072
.amdgcn_target "amdgcn-amd-amdhsa--gfx950"
.text
.globl attn_kernel
.p2align 8
.type attn_kernel,@function
attn_kernel:
    s_cmp_ge_u32 s2, 256
    s_cbranch_scc1 L_attn_done
    s_load_dwordx4 s[44:47], s[0:1], 0
    s_load_dwordx4 s[48:51], s[0:1], 16
    s_load_dwordx2 s[52:53], s[0:1], 56
    s_lshr_b32 s3, s2, 5
    s_and_b32 s33, s2, 31
    s_lshl_b32 s60, s3, 5
    s_add_u32 s60, s60, s33
    v_lshrrev_b32 v2, 6, v0
    v_and_b32 v1, 63, v0
    s_nop 0
    v_readfirstlane_b32 s34, v2
    s_load_dwordx2 s[56:57], s[0:1], 32
    v_and_b32 v40, 31, v1
    v_lshrrev_b32 v41, 5, v1
    v_lshrrev_b32 v42, 4, v1
    v_bfe_u32 v43, v1, 2, 2
    v_and_b32 v44, 3, v1
    s_lshl_b32 s54, s34, 3
    v_add_u32 v45, s54, v42
    v_and_b32 v46, 15, v1
    v_and_b32 v47, 15, v45
    v_xor_b32 v47, v47, v46
    v_lshlrev_b32 v47, 4, v47
    v_lshl_add_u32 v24, v45, 8, v47
    v_add_u32 v47, 4, v45
    v_and_b32 v47, 15, v47
    v_xor_b32 v47, v47, v46
    v_lshlrev_b32 v47, 4, v47
    v_lshl_add_u32 v25, v45, 8, v47
    v_and_b32 v47, 3, v45
    v_lshlrev_b32 v47, 2, v47
    v_xor_b32 v47, v47, v46
    v_lshlrev_b32 v47, 4, v47
    v_lshl_add_u32 v26, v45, 8, v47
    v_lshl_add_u32 v27, v45, 13, v47
    v_add_u32 v28, 31744, v27
    s_lshl_b32 s54, s34, 11
    s_add_u32 s38, s54, 0
    s_add_u32 s39, s54, 65536
    s_add_u32 s40, s54, 98304
    s_mov_b32 s36, 0
    s_mov_b32 s37, 0
    s_mov_b32 s41, 0
    v_and_b32 v46, 15, v1
    v_xor_b32 v46, v46, v42
    s_lshl_b32 s54, s34, 15
    v_xor_b32 v47, 0, v46
    v_lshrrev_b32 v45, 3, v47
    v_lshl_add_u32 v45, v42, 1, v45
    v_lshlrev_b32 v45, 10, v45
    v_and_b32 v47, 7, v47
    v_lshl_add_u32 v45, v47, 4, v45
    v_add_u32 v45, 0, v45
    v_add_u32 v48, s54, v45
    v_xor_b32 v47, 4, v46
    v_lshrrev_b32 v45, 3, v47
    v_lshl_add_u32 v45, v42, 1, v45
    v_lshlrev_b32 v45, 10, v45
    v_and_b32 v47, 7, v47
    v_lshl_add_u32 v45, v47, 4, v45
    v_add_u32 v45, 7168, v45
    v_add_u32 v49, s54, v45
    v_xor_b32 v47, 8, v46
    v_lshrrev_b32 v45, 3, v47
    v_lshl_add_u32 v45, v42, 1, v45
    v_lshlrev_b32 v45, 10, v45
    v_and_b32 v47, 7, v47
    v_lshl_add_u32 v45, v47, 4, v45
    v_add_u32 v45, 14336, v45
    v_add_u32 v50, s54, v45
    v_xor_b32 v47, 12, v46
    v_lshrrev_b32 v45, 3, v47
    v_lshl_add_u32 v45, v42, 1, v45
    v_lshlrev_b32 v45, 10, v45
    v_and_b32 v47, 7, v47
    v_lshl_add_u32 v45, v47, 4, v45
    v_add_u32 v45, 21504, v45
    v_add_u32 v51, s54, v45
    s_lshl_b32 s54, s34, 12
    s_mov_b32 s43, 0
    s_mov_b32 s63, s54
    s_waitcnt lgkmcnt(0)
    s_lshl_b32 s54, s3, 18
    s_add_u32 s12, s44, s54
    s_addc_u32 s13, s45, 0
    s_mov_b32 s14, 262144
    s_mov_b32 s15, 0x00020000
    s_lshl_b32 s54, s33, 8
    s_add_u32 s24, s50, s54
    s_addc_u32 s25, s51, 0
    s_sub_u32 s26, 4194304, s54
    s_mov_b32 s27, 0x00020000
    s_add_u32 m0, s40, 16384
    s_nop 0
    buffer_load_dwordx4 v27, s[24:27], s41 offen lds
    buffer_load_dwordx4 v28, s[24:27], s41 offen offset:1024 lds
    s_add_u32 s41, s41, 524288
    s_and_b32 s41, s41, 0x3fffff
    s_add_u32 m0, s63, 32768
    s_nop 0
    buffer_load_dwordx4 v48, s[12:15], s43 offen offset:0 lds
    buffer_load_dwordx4 v49, s[12:15], s43 offen offset:1024 lds
    buffer_load_dwordx4 v50, s[12:15], s43 offen offset:2048 lds
    buffer_load_dwordx4 v51, s[12:15], s43 offen offset:3072 lds
    s_add_u32 s43, s43, 128
    s_and_b32 s43, s43, 1023
    s_barrier
    s_add_u32 m0, s40, 32768
    s_nop 0
    buffer_load_dwordx4 v27, s[24:27], s41 offen lds
    buffer_load_dwordx4 v28, s[24:27], s41 offen offset:1024 lds
    s_add_u32 s41, s41, 524288
    s_and_b32 s41, s41, 0x3fffff
    s_add_u32 m0, s63, 81920
    s_nop 0
    buffer_load_dwordx4 v48, s[12:15], s43 offen offset:0 lds
    buffer_load_dwordx4 v49, s[12:15], s43 offen offset:1024 lds
    buffer_load_dwordx4 v50, s[12:15], s43 offen offset:2048 lds
    buffer_load_dwordx4 v51, s[12:15], s43 offen offset:3072 lds
    s_add_u32 s43, s43, 128
    s_and_b32 s43, s43, 1023
    s_lshl_b32 s54, s2, 14
    s_lshl_b32 s55, s34, 11
    s_add_u32 s54, s54, s55
    s_add_u32 s8, s50, s54
    s_addc_u32 s9, s51, 0
    s_mov_b32 s10, 2048
    s_mov_b32 s11, 0x00020000
    v_lshlrev_b32 v204, 4, v1
    buffer_load_dwordx4 v[192:195], v204, s[8:11], 0 offen
    buffer_load_dwordx4 v[196:199], v204, s[8:11], 0 offen offset:1024
    s_lshl_b32 s54, s2, 13
    s_lshl_b32 s55, s34, 10
    s_add_u32 s54, s54, s55
    s_add_u32 s8, s44, s54
    s_addc_u32 s9, s45, 0
    s_mov_b32 s10, 1024
    buffer_load_dwordx4 v[200:203], v204, s[8:11], 0 offen
    s_lshl_b32 s54, s60, 18
    s_add_u32 s16, s46, s54
    s_addc_u32 s17, s47, 0
    s_mov_b32 s18, 262144
    s_mov_b32 s19, 0x00020000
    s_add_u32 s20, s48, s54
    s_addc_u32 s21, s49, 0
    s_mov_b32 s22, 262144
    s_mov_b32 s23, 0x00020000
    s_lshl_b32 s54, s3, 21
    s_lshl_b32 s55, s33, 13
    s_add_u32 s54, s54, s55
    s_add_u32 s28, s52, s54
    s_addc_u32 s29, s53, 0
    s_sub_u32 s30, 16777216, s54
    s_mov_b32 s31, 0x00020000
    s_mov_b32 s35, 0x3e0293ee
    s_lshl_b32 s54, s2, 14
    s_add_u32 s4, s56, s54
    s_addc_u32 s5, s57, 0
    s_mov_b32 s6, 16384
    s_mov_b32 s7, 0x00020000
    v_and_b32 v45, 15, v40
    v_xor_b32 v45, v45, v41
    v_xor_b32 v46, 0, v45
    v_lshlrev_b32 v46, 4, v46
    v_lshl_add_u32 v8, v40, 8, v46
    v_xor_b32 v46, 2, v45
    v_lshlrev_b32 v46, 4, v46
    v_lshl_add_u32 v9, v40, 8, v46
    v_xor_b32 v46, 4, v45
    v_lshlrev_b32 v46, 4, v46
    v_lshl_add_u32 v10, v40, 8, v46
    v_xor_b32 v46, 6, v45
    v_lshlrev_b32 v46, 4, v46
    v_lshl_add_u32 v11, v40, 8, v46
    v_xor_b32 v46, 8, v45
    v_lshlrev_b32 v46, 4, v46
    v_lshl_add_u32 v12, v40, 8, v46
    v_xor_b32 v46, 10, v45
    v_lshlrev_b32 v46, 4, v46
    v_lshl_add_u32 v13, v40, 8, v46
    v_xor_b32 v46, 12, v45
    v_lshlrev_b32 v46, 4, v46
    v_lshl_add_u32 v14, v40, 8, v46
    v_xor_b32 v46, 14, v45
    v_lshlrev_b32 v46, 4, v46
    v_lshl_add_u32 v15, v40, 8, v46
    v_lshrrev_b32 v45, 1, v42
    v_lshl_add_u32 v46, v45, 2, v43
    v_lshlrev_b32 v46, 8, v46
    v_and_b32 v47, 1, v42
    v_lshl_add_u32 v46, v47, 5, v46
    v_lshl_add_u32 v46, v44, 3, v46
    v_add_u32 v46, 65536, v46
    v_xor_b32 v47, 0, v43
    v_lshl_add_u32 v16, v47, 6, v46
    v_add_u32 v235, 0x10000, v16
    v_xor_b32 v47, 1, v43
    v_lshl_add_u32 v17, v47, 6, v46
    v_add_u32 v236, 0x10000, v17
    v_xor_b32 v47, 2, v43
    v_lshl_add_u32 v18, v47, 6, v46
    v_add_u32 v237, 0x10000, v18
    v_xor_b32 v47, 3, v43
    v_lshl_add_u32 v19, v47, 6, v46
    v_add_u32 v238, 0x10000, v19
    v_lshl_add_u32 v239, v41, 2, v43
    v_lshlrev_b32 v239, 10, v239
    v_and_b32 v47, 1, v42
    v_lshl_add_u32 v239, v47, 5, v239
    v_lshl_add_u32 v239, v44, 3, v239
    s_lshl_b32 s54, s34, 7
    s_add_u32 s54, s54, 147456
    v_add_u32 v239, s54, v239
    v_lshlrev_b32 v248, 4, v1
    v_lshl_add_u32 v46, v45, 3, v43
    v_lshlrev_b32 v46, 8, v46
    v_and_b32 v47, 1, v42
    v_lshl_add_u32 v46, v47, 5, v46
    v_and_b32 v47, 1, v44
    v_lshl_add_u32 v46, v47, 4, v46
    v_lshrrev_b32 v47, 1, v44
    v_lshl_add_u32 v46, v47, 3, v46
    v_add_u32 v46, 98304, v46
    v_xor_b32 v47, 0, v43
    v_lshl_add_u32 v20, v47, 6, v46
    v_xor_b32 v47, 1, v43
    v_lshl_add_u32 v21, v47, 6, v46
    v_xor_b32 v47, 2, v43
    v_lshl_add_u32 v22, v47, 6, v46
    v_xor_b32 v47, 3, v43
    v_lshl_add_u32 v23, v47, 6, v46
    s_lshl_b32 s54, s34, 5
    v_add_u32 v45, s54, v40
    v_lshlrev_b32 v45, 10, v45
    v_lshl_add_u32 v29, v41, 4, v45
    s_lshl_b32 s54, s34, 18
    v_lshlrev_b32 v45, 4, v1
    v_add_u32 v234, s54, v45
    v_lshrrev_b32 v45, 1, v40
    v_and_b32 v46, 1, v40
    v_lshl_add_u32 v46, v46, 3, v41
    v_xor_b32 v46, v46, v45
    s_lshl_b32 s54, s34, 12
    v_lshlrev_b32 v45, 8, v45
    v_add_u32 v45, s54, v45
    v_add_u32 v45, 32768, v45
    v_xor_b32 v47, 0, v46
    v_lshl_add_u32 v52, v47, 4, v45
    v_xor_b32 v47, 2, v46
    v_lshl_add_u32 v53, v47, 4, v45
    v_xor_b32 v47, 4, v46
    v_lshl_add_u32 v54, v47, 4, v45
    v_xor_b32 v47, 6, v46
    v_lshl_add_u32 v55, v47, 4, v45
    s_waitcnt vmcnt(9)
    s_barrier
    ds_read_b128 v[64:67], v52 offset:0
    ds_read_b128 v[68:71], v53 offset:0
    ds_read_b128 v[72:75], v54 offset:0
    ds_read_b128 v[76:79], v55 offset:0
    ds_read_b64_tr_b16 v[208:209], v20 offset:16384
    ds_read_b64_tr_b16 v[210:211], v20 offset:17408
    ds_read_b64_tr_b16 v[212:213], v21 offset:16384
    ds_read_b64_tr_b16 v[214:215], v21 offset:17408
    ds_read_b64_tr_b16 v[216:217], v22 offset:16384
    ds_read_b64_tr_b16 v[218:219], v22 offset:17408
    ds_read_b64_tr_b16 v[220:221], v23 offset:16384
    ds_read_b64_tr_b16 v[222:223], v23 offset:17408
    ds_read_b64_tr_b16 v[224:225], v20 offset:20480
    ds_read_b64_tr_b16 v[226:227], v20 offset:21504
    s_waitcnt lgkmcnt(10)
    s_waitcnt lgkmcnt(8)
    v_mfma_f32_32x32x16_bf16 v[128:143], v[208:211], v[64:67], 0
    ds_read_b64_tr_b16 v[228:229], v21 offset:20480
    ds_read_b64_tr_b16 v[230:231], v21 offset:21504
    s_add_u32 m0, s40, 49152
    s_nop 0
    buffer_load_dwordx4 v27, s[24:27], s41 offen offset:0 lds
    s_waitcnt lgkmcnt(8)
    v_mfma_f32_32x32x16_bf16 v[144:159], v[212:215], v[64:67], 0
    ds_read_b64_tr_b16 v[208:209], v22 offset:20480
    ds_read_b64_tr_b16 v[210:211], v22 offset:21504
    s_waitcnt lgkmcnt(8)
    v_mfma_f32_32x32x16_bf16 v[160:175], v[216:219], v[64:67], 0
    ds_read_b64_tr_b16 v[212:213], v23 offset:20480
    ds_read_b64_tr_b16 v[214:215], v23 offset:21504
    buffer_load_dwordx4 v28, s[24:27], s41 offen offset:1024 lds
    s_add_u32 s41, s41, 524288
    s_and_b32 s41, s41, 0x3fffff
    s_waitcnt lgkmcnt(8)
    v_mfma_f32_32x32x16_bf16 v[176:191], v[220:223], v[64:67], 0
    ds_read_b64_tr_b16 v[216:217], v20 offset:24576
    ds_read_b64_tr_b16 v[218:219], v20 offset:25600
    s_waitcnt lgkmcnt(8)
    v_mfma_f32_32x32x16_bf16 v[128:143], v[224:227], v[68:71], v[128:143]
    ds_read_b64_tr_b16 v[220:221], v21 offset:24576
    ds_read_b64_tr_b16 v[222:223], v21 offset:25600
    s_add_u32 m0, s63, 32768
    s_nop 0
    buffer_load_dwordx4 v48, s[12:15], s43 offen offset:0 lds
    s_waitcnt lgkmcnt(8)
    v_mfma_f32_32x32x16_bf16 v[144:159], v[228:231], v[68:71], v[144:159]
    ds_read_b64_tr_b16 v[224:225], v22 offset:24576
    ds_read_b64_tr_b16 v[226:227], v22 offset:25600
    s_waitcnt lgkmcnt(8)
    v_mfma_f32_32x32x16_bf16 v[160:175], v[208:211], v[68:71], v[160:175]
    ds_read_b64_tr_b16 v[228:229], v23 offset:24576
    ds_read_b64_tr_b16 v[230:231], v23 offset:25600
    buffer_load_dwordx4 v49, s[12:15], s43 offen offset:1024 lds
    s_waitcnt lgkmcnt(8)
    v_mfma_f32_32x32x16_bf16 v[176:191], v[212:215], v[68:71], v[176:191]
    ds_read_b64_tr_b16 v[208:209], v20 offset:28672
    ds_read_b64_tr_b16 v[210:211], v20 offset:29696
    s_waitcnt lgkmcnt(8)
    v_mfma_f32_32x32x16_bf16 v[128:143], v[216:219], v[72:75], v[128:143]
    ds_read_b64_tr_b16 v[212:213], v21 offset:28672
    ds_read_b64_tr_b16 v[214:215], v21 offset:29696
    buffer_load_dwordx4 v50, s[12:15], s43 offen offset:2048 lds
    s_waitcnt lgkmcnt(8)
    v_mfma_f32_32x32x16_bf16 v[144:159], v[220:223], v[72:75], v[144:159]
    ds_read_b64_tr_b16 v[216:217], v22 offset:28672
    ds_read_b64_tr_b16 v[218:219], v22 offset:29696
    s_waitcnt lgkmcnt(8)
    v_mfma_f32_32x32x16_bf16 v[160:175], v[224:227], v[72:75], v[160:175]
    ds_read_b64_tr_b16 v[220:221], v23 offset:28672
    ds_read_b64_tr_b16 v[222:223], v23 offset:29696
    buffer_load_dwordx4 v51, s[12:15], s43 offen offset:3072 lds
    s_add_u32 s43, s43, 128
    s_and_b32 s43, s43, 1023
    s_waitcnt lgkmcnt(8)
    v_mfma_f32_32x32x16_bf16 v[176:191], v[228:231], v[72:75], v[176:191]
    s_waitcnt lgkmcnt(6)
    v_mfma_f32_32x32x16_bf16 v[128:143], v[208:211], v[76:79], v[128:143]
    s_waitcnt lgkmcnt(4)
    v_mfma_f32_32x32x16_bf16 v[144:159], v[212:215], v[76:79], v[144:159]
    s_waitcnt lgkmcnt(2)
    v_mfma_f32_32x32x16_bf16 v[160:175], v[216:219], v[76:79], v[160:175]
    s_waitcnt lgkmcnt(0)
    v_mfma_f32_32x32x16_bf16 v[176:191], v[220:223], v[76:79], v[176:191]
    s_waitcnt vmcnt(9)
    s_barrier
    ds_read_b128 v[64:67], v52 offset:49152
    ds_read_b128 v[68:71], v53 offset:49152
    ds_read_b128 v[72:75], v54 offset:49152
    ds_read_b128 v[76:79], v55 offset:49152
    ds_read_b64_tr_b16 v[224:225], v20 offset:32768
    ds_read_b64_tr_b16 v[226:227], v20 offset:33792
    ds_read_b64_tr_b16 v[228:229], v21 offset:32768
    ds_read_b64_tr_b16 v[230:231], v21 offset:33792
    ds_read_b64_tr_b16 v[208:209], v22 offset:32768
    ds_read_b64_tr_b16 v[210:211], v22 offset:33792
    ds_read_b64_tr_b16 v[212:213], v23 offset:32768
    ds_read_b64_tr_b16 v[214:215], v23 offset:33792
    ds_read_b64_tr_b16 v[216:217], v20 offset:36864
    ds_read_b64_tr_b16 v[218:219], v20 offset:37888
    s_waitcnt lgkmcnt(10)
    s_waitcnt lgkmcnt(8)
    v_mfma_f32_32x32x16_bf16 v[128:143], v[224:227], v[64:67], v[128:143]
    ds_read_b64_tr_b16 v[220:221], v21 offset:36864
    ds_read_b64_tr_b16 v[222:223], v21 offset:37888
    s_add_u32 m0, s40, 16384
    s_nop 0
    buffer_load_dwordx4 v27, s[24:27], s41 offen offset:0 lds
    s_waitcnt lgkmcnt(8)
    v_mfma_f32_32x32x16_bf16 v[144:159], v[228:231], v[64:67], v[144:159]
    ds_read_b64_tr_b16 v[224:225], v22 offset:36864
    ds_read_b64_tr_b16 v[226:227], v22 offset:37888
    s_waitcnt lgkmcnt(8)
    v_mfma_f32_32x32x16_bf16 v[160:175], v[208:211], v[64:67], v[160:175]
    ds_read_b64_tr_b16 v[228:229], v23 offset:36864
    ds_read_b64_tr_b16 v[230:231], v23 offset:37888
    buffer_load_dwordx4 v28, s[24:27], s41 offen offset:1024 lds
    s_add_u32 s41, s41, 524288
    s_and_b32 s41, s41, 0x3fffff
    s_waitcnt lgkmcnt(8)
    v_mfma_f32_32x32x16_bf16 v[176:191], v[212:215], v[64:67], v[176:191]
    ds_read_b64_tr_b16 v[208:209], v20 offset:40960
    ds_read_b64_tr_b16 v[210:211], v20 offset:41984
    s_waitcnt lgkmcnt(8)
    v_mfma_f32_32x32x16_bf16 v[128:143], v[216:219], v[68:71], v[128:143]
    ds_read_b64_tr_b16 v[212:213], v21 offset:40960
    ds_read_b64_tr_b16 v[214:215], v21 offset:41984
    s_add_u32 m0, s63, 81920
    s_nop 0
    buffer_load_dwordx4 v48, s[12:15], s43 offen offset:0 lds
    s_waitcnt lgkmcnt(8)
    v_mfma_f32_32x32x16_bf16 v[144:159], v[220:223], v[68:71], v[144:159]
    ds_read_b64_tr_b16 v[216:217], v22 offset:40960
    ds_read_b64_tr_b16 v[218:219], v22 offset:41984
    s_waitcnt lgkmcnt(8)
    v_mfma_f32_32x32x16_bf16 v[160:175], v[224:227], v[68:71], v[160:175]
    ds_read_b64_tr_b16 v[220:221], v23 offset:40960
    ds_read_b64_tr_b16 v[222:223], v23 offset:41984
    buffer_load_dwordx4 v49, s[12:15], s43 offen offset:1024 lds
    s_waitcnt lgkmcnt(8)
    v_mfma_f32_32x32x16_bf16 v[176:191], v[228:231], v[68:71], v[176:191]
    ds_read_b64_tr_b16 v[224:225], v20 offset:45056
    ds_read_b64_tr_b16 v[226:227], v20 offset:46080
    s_waitcnt lgkmcnt(8)
    v_mfma_f32_32x32x16_bf16 v[128:143], v[208:211], v[72:75], v[128:143]
    ds_read_b64_tr_b16 v[228:229], v21 offset:45056
    ds_read_b64_tr_b16 v[230:231], v21 offset:46080
    buffer_load_dwordx4 v50, s[12:15], s43 offen offset:2048 lds
    s_waitcnt lgkmcnt(8)
    v_mfma_f32_32x32x16_bf16 v[144:159], v[212:215], v[72:75], v[144:159]
    ds_read_b64_tr_b16 v[208:209], v22 offset:45056
    ds_read_b64_tr_b16 v[210:211], v22 offset:46080
    s_waitcnt lgkmcnt(8)
    v_mfma_f32_32x32x16_bf16 v[160:175], v[216:219], v[72:75], v[160:175]
    ds_read_b64_tr_b16 v[212:213], v23 offset:45056
    ds_read_b64_tr_b16 v[214:215], v23 offset:46080
    buffer_load_dwordx4 v51, s[12:15], s43 offen offset:3072 lds
    s_add_u32 s43, s43, 128
    s_and_b32 s43, s43, 1023
    s_waitcnt lgkmcnt(8)
    v_mfma_f32_32x32x16_bf16 v[176:191], v[220:223], v[72:75], v[176:191]
    s_waitcnt lgkmcnt(6)
    v_mfma_f32_32x32x16_bf16 v[128:143], v[224:227], v[76:79], v[128:143]
    s_add_u32 m0, s38, 0
    s_nop 0
    buffer_load_dwordx4 v24, s[16:19], s36 offen offset:0 nt lds
    s_waitcnt lgkmcnt(4)
    v_mfma_f32_32x32x16_bf16 v[144:159], v[228:231], v[76:79], v[144:159]
    s_waitcnt lgkmcnt(2)
    v_mfma_f32_32x32x16_bf16 v[160:175], v[208:211], v[76:79], v[160:175]
    buffer_load_dwordx4 v25, s[16:19], s36 offen offset:1024 nt lds
    s_add_u32 s36, s36, 16384
    s_waitcnt lgkmcnt(0)
    v_mfma_f32_32x32x16_bf16 v[176:191], v[212:215], v[76:79], v[176:191]
    s_waitcnt vmcnt(8)
    s_barrier
    ds_read_b128 v[64:67], v52 offset:0
    ds_read_b128 v[68:71], v53 offset:0
    ds_read_b128 v[72:75], v54 offset:0
    ds_read_b128 v[76:79], v55 offset:0
    ds_read_b64_tr_b16 v[216:217], v20 offset:49152
    ds_read_b64_tr_b16 v[218:219], v20 offset:50176
    ds_read_b64_tr_b16 v[220:221], v21 offset:49152
    ds_read_b64_tr_b16 v[222:223], v21 offset:50176
    ds_read_b64_tr_b16 v[224:225], v22 offset:49152
    ds_read_b64_tr_b16 v[226:227], v22 offset:50176
    ds_read_b64_tr_b16 v[228:229], v23 offset:49152
    ds_read_b64_tr_b16 v[230:231], v23 offset:50176
    ds_read_b64_tr_b16 v[208:209], v20 offset:53248
    ds_read_b64_tr_b16 v[210:211], v20 offset:54272
    s_waitcnt lgkmcnt(10)
    s_waitcnt lgkmcnt(8)
    v_mfma_f32_32x32x16_bf16 v[128:143], v[216:219], v[64:67], v[128:143]
    ds_read_b64_tr_b16 v[212:213], v21 offset:53248
    ds_read_b64_tr_b16 v[214:215], v21 offset:54272
    s_add_u32 m0, s40, 32768
    s_nop 0
    buffer_load_dwordx4 v27, s[24:27], s41 offen offset:0 lds
    s_waitcnt lgkmcnt(8)
    v_mfma_f32_32x32x16_bf16 v[144:159], v[220:223], v[64:67], v[144:159]
    ds_read_b64_tr_b16 v[216:217], v22 offset:53248
    ds_read_b64_tr_b16 v[218:219], v22 offset:54272
    s_waitcnt lgkmcnt(8)
    v_mfma_f32_32x32x16_bf16 v[160:175], v[224:227], v[64:67], v[160:175]
    ds_read_b64_tr_b16 v[220:221], v23 offset:53248
    ds_read_b64_tr_b16 v[222:223], v23 offset:54272
    buffer_load_dwordx4 v28, s[24:27], s41 offen offset:1024 lds
    s_add_u32 s41, s41, 524288
    s_and_b32 s41, s41, 0x3fffff
    s_waitcnt lgkmcnt(8)
    v_mfma_f32_32x32x16_bf16 v[176:191], v[228:231], v[64:67], v[176:191]
    ds_read_b64_tr_b16 v[224:225], v20 offset:57344
    ds_read_b64_tr_b16 v[226:227], v20 offset:58368
    s_waitcnt lgkmcnt(8)
    v_mfma_f32_32x32x16_bf16 v[128:143], v[208:211], v[68:71], v[128:143]
    ds_read_b64_tr_b16 v[228:229], v21 offset:57344
    ds_read_b64_tr_b16 v[230:231], v21 offset:58368
    s_add_u32 m0, s63, 32768
    s_nop 0
    buffer_load_dwordx4 v48, s[12:15], s43 offen offset:0 lds
    s_waitcnt lgkmcnt(8)
    v_mfma_f32_32x32x16_bf16 v[144:159], v[212:215], v[68:71], v[144:159]
    ds_read_b64_tr_b16 v[208:209], v22 offset:57344
    ds_read_b64_tr_b16 v[210:211], v22 offset:58368
    s_waitcnt lgkmcnt(8)
    v_mfma_f32_32x32x16_bf16 v[160:175], v[216:219], v[68:71], v[160:175]
    ds_read_b64_tr_b16 v[212:213], v23 offset:57344
    ds_read_b64_tr_b16 v[214:215], v23 offset:58368
    buffer_load_dwordx4 v49, s[12:15], s43 offen offset:1024 lds
    s_waitcnt lgkmcnt(8)
    v_mfma_f32_32x32x16_bf16 v[176:191], v[220:223], v[68:71], v[176:191]
    ds_read_b64_tr_b16 v[216:217], v20 offset:61440
    ds_read_b64_tr_b16 v[218:219], v20 offset:62464
    s_waitcnt lgkmcnt(8)
    v_mfma_f32_32x32x16_bf16 v[128:143], v[224:227], v[72:75], v[128:143]
    ds_read_b64_tr_b16 v[220:221], v21 offset:61440
    ds_read_b64_tr_b16 v[222:223], v21 offset:62464
    buffer_load_dwordx4 v50, s[12:15], s43 offen offset:2048 lds
    s_waitcnt lgkmcnt(8)
    v_mfma_f32_32x32x16_bf16 v[144:159], v[228:231], v[72:75], v[144:159]
    ds_read_b64_tr_b16 v[224:225], v22 offset:61440
    ds_read_b64_tr_b16 v[226:227], v22 offset:62464
    s_waitcnt lgkmcnt(8)
    v_mfma_f32_32x32x16_bf16 v[160:175], v[208:211], v[72:75], v[160:175]
    ds_read_b64_tr_b16 v[228:229], v23 offset:61440
    ds_read_b64_tr_b16 v[230:231], v23 offset:62464
    buffer_load_dwordx4 v51, s[12:15], s43 offen offset:3072 lds
    s_add_u32 s43, s43, 128
    s_and_b32 s43, s43, 1023
    s_waitcnt lgkmcnt(8)
    v_mfma_f32_32x32x16_bf16 v[176:191], v[212:215], v[72:75], v[176:191]
    s_waitcnt lgkmcnt(6)
    v_mfma_f32_32x32x16_bf16 v[128:143], v[216:219], v[76:79], v[128:143]
    s_waitcnt lgkmcnt(4)
    v_mfma_f32_32x32x16_bf16 v[144:159], v[220:223], v[76:79], v[144:159]
    s_waitcnt lgkmcnt(2)
    v_mfma_f32_32x32x16_bf16 v[160:175], v[224:227], v[76:79], v[160:175]
    s_waitcnt lgkmcnt(0)
    v_mfma_f32_32x32x16_bf16 v[176:191], v[228:231], v[76:79], v[176:191]
    s_waitcnt vmcnt(8)
    s_barrier
    ds_read_b128 v[64:67], v52 offset:49152
    ds_read_b128 v[68:71], v53 offset:49152
    ds_read_b128 v[72:75], v54 offset:49152
    ds_read_b128 v[76:79], v55 offset:49152
    ds_read_b64_tr_b16 v[208:209], v20 offset:16384
    ds_read_b64_tr_b16 v[210:211], v20 offset:17408
    ds_read_b64_tr_b16 v[212:213], v21 offset:16384
    ds_read_b64_tr_b16 v[214:215], v21 offset:17408
    ds_read_b64_tr_b16 v[216:217], v22 offset:16384
    ds_read_b64_tr_b16 v[218:219], v22 offset:17408
    ds_read_b64_tr_b16 v[220:221], v23 offset:16384
    ds_read_b64_tr_b16 v[222:223], v23 offset:17408
    ds_read_b64_tr_b16 v[224:225], v20 offset:20480
    ds_read_b64_tr_b16 v[226:227], v20 offset:21504
    s_waitcnt lgkmcnt(10)
    s_waitcnt lgkmcnt(8)
    v_mfma_f32_32x32x16_bf16 v[128:143], v[208:211], v[64:67], v[128:143]
    ds_read_b64_tr_b16 v[228:229], v21 offset:20480
    ds_read_b64_tr_b16 v[230:231], v21 offset:21504
    s_add_u32 m0, s40, 49152
    s_nop 0
    buffer_load_dwordx4 v27, s[24:27], s41 offen offset:0 lds
    s_waitcnt lgkmcnt(8)
    v_mfma_f32_32x32x16_bf16 v[144:159], v[212:215], v[64:67], v[144:159]
    ds_read_b64_tr_b16 v[208:209], v22 offset:20480
    ds_read_b64_tr_b16 v[210:211], v22 offset:21504
    s_waitcnt lgkmcnt(8)
    v_mfma_f32_32x32x16_bf16 v[160:175], v[216:219], v[64:67], v[160:175]
    ds_read_b64_tr_b16 v[212:213], v23 offset:20480
    ds_read_b64_tr_b16 v[214:215], v23 offset:21504
    buffer_load_dwordx4 v28, s[24:27], s41 offen offset:1024 lds
    s_add_u32 s41, s41, 524288
    s_and_b32 s41, s41, 0x3fffff
    s_waitcnt lgkmcnt(8)
    v_mfma_f32_32x32x16_bf16 v[176:191], v[220:223], v[64:67], v[176:191]
    ds_read_b64_tr_b16 v[216:217], v20 offset:24576
    ds_read_b64_tr_b16 v[218:219], v20 offset:25600
    s_waitcnt lgkmcnt(8)
    v_mfma_f32_32x32x16_bf16 v[128:143], v[224:227], v[68:71], v[128:143]
    ds_read_b64_tr_b16 v[220:221], v21 offset:24576
    ds_read_b64_tr_b16 v[222:223], v21 offset:25600
    s_add_u32 m0, s63, 81920
    s_nop 0
    buffer_load_dwordx4 v48, s[12:15], s43 offen offset:0 lds
    s_waitcnt lgkmcnt(8)
    v_mfma_f32_32x32x16_bf16 v[144:159], v[228:231], v[68:71], v[144:159]
    ds_read_b64_tr_b16 v[224:225], v22 offset:24576
    ds_read_b64_tr_b16 v[226:227], v22 offset:25600
    s_waitcnt lgkmcnt(8)
    v_mfma_f32_32x32x16_bf16 v[160:175], v[208:211], v[68:71], v[160:175]
    ds_read_b64_tr_b16 v[228:229], v23 offset:24576
    ds_read_b64_tr_b16 v[230:231], v23 offset:25600
    buffer_load_dwordx4 v49, s[12:15], s43 offen offset:1024 lds
    s_waitcnt lgkmcnt(8)
    v_mfma_f32_32x32x16_bf16 v[176:191], v[212:215], v[68:71], v[176:191]
    ds_read_b64_tr_b16 v[208:209], v20 offset:28672
    ds_read_b64_tr_b16 v[210:211], v20 offset:29696
    s_waitcnt lgkmcnt(8)
    v_mfma_f32_32x32x16_bf16 v[128:143], v[216:219], v[72:75], v[128:143]
    ds_read_b64_tr_b16 v[212:213], v21 offset:28672
    ds_read_b64_tr_b16 v[214:215], v21 offset:29696
    buffer_load_dwordx4 v50, s[12:15], s43 offen offset:2048 lds
    s_waitcnt lgkmcnt(8)
    v_mfma_f32_32x32x16_bf16 v[144:159], v[220:223], v[72:75], v[144:159]
    ds_read_b64_tr_b16 v[216:217], v22 offset:28672
    ds_read_b64_tr_b16 v[218:219], v22 offset:29696
    s_waitcnt lgkmcnt(8)
    v_mfma_f32_32x32x16_bf16 v[160:175], v[224:227], v[72:75], v[160:175]
    ds_read_b64_tr_b16 v[220:221], v23 offset:28672
    ds_read_b64_tr_b16 v[222:223], v23 offset:29696
    buffer_load_dwordx4 v51, s[12:15], s43 offen offset:3072 lds
    s_add_u32 s43, s43, 128
    s_and_b32 s43, s43, 1023
    s_waitcnt lgkmcnt(8)
    v_mfma_f32_32x32x16_bf16 v[176:191], v[228:231], v[72:75], v[176:191]
    s_waitcnt lgkmcnt(6)
    v_mfma_f32_32x32x16_bf16 v[128:143], v[208:211], v[76:79], v[128:143]
    s_add_u32 m0, s38, 16384
    s_nop 0
    buffer_load_dwordx4 v24, s[16:19], s36 offen offset:0 nt lds
    s_waitcnt lgkmcnt(4)
    v_mfma_f32_32x32x16_bf16 v[144:159], v[212:215], v[76:79], v[144:159]
    s_waitcnt lgkmcnt(2)
    v_mfma_f32_32x32x16_bf16 v[160:175], v[216:219], v[76:79], v[160:175]
    buffer_load_dwordx4 v25, s[16:19], s36 offen offset:1024 nt lds
    s_add_u32 s36, s36, 16384
    s_waitcnt lgkmcnt(0)
    v_mfma_f32_32x32x16_bf16 v[176:191], v[220:223], v[76:79], v[176:191]
    s_waitcnt vmcnt(8)
    s_barrier
    ds_read_b128 v[64:67], v52 offset:0
    ds_read_b128 v[68:71], v53 offset:0
    ds_read_b128 v[72:75], v54 offset:0
    ds_read_b128 v[76:79], v55 offset:0
    ds_read_b64_tr_b16 v[224:225], v20 offset:32768
    ds_read_b64_tr_b16 v[226:227], v20 offset:33792
    ds_read_b64_tr_b16 v[228:229], v21 offset:32768
    ds_read_b64_tr_b16 v[230:231], v21 offset:33792
    ds_read_b64_tr_b16 v[208:209], v22 offset:32768
    ds_read_b64_tr_b16 v[210:211], v22 offset:33792
    ds_read_b64_tr_b16 v[212:213], v23 offset:32768
    ds_read_b64_tr_b16 v[214:215], v23 offset:33792
    ds_read_b64_tr_b16 v[216:217], v20 offset:36864
    ds_read_b64_tr_b16 v[218:219], v20 offset:37888
    s_waitcnt lgkmcnt(10)
    s_waitcnt lgkmcnt(8)
    v_mfma_f32_32x32x16_bf16 v[128:143], v[224:227], v[64:67], v[128:143]
    ds_read_b64_tr_b16 v[220:221], v21 offset:36864
    ds_read_b64_tr_b16 v[222:223], v21 offset:37888
    s_add_u32 m0, s40, 16384
    s_nop 0
    buffer_load_dwordx4 v27, s[24:27], s41 offen offset:0 lds
    s_waitcnt lgkmcnt(8)
    v_mfma_f32_32x32x16_bf16 v[144:159], v[228:231], v[64:67], v[144:159]
    ds_read_b64_tr_b16 v[224:225], v22 offset:36864
    ds_read_b64_tr_b16 v[226:227], v22 offset:37888
    s_waitcnt lgkmcnt(8)
    v_mfma_f32_32x32x16_bf16 v[160:175], v[208:211], v[64:67], v[160:175]
    ds_read_b64_tr_b16 v[228:229], v23 offset:36864
    ds_read_b64_tr_b16 v[230:231], v23 offset:37888
    buffer_load_dwordx4 v28, s[24:27], s41 offen offset:1024 lds
    s_add_u32 s41, s41, 524288
    s_and_b32 s41, s41, 0x3fffff
    s_waitcnt lgkmcnt(8)
    v_mfma_f32_32x32x16_bf16 v[176:191], v[212:215], v[64:67], v[176:191]
    ds_read_b64_tr_b16 v[208:209], v20 offset:40960
    ds_read_b64_tr_b16 v[210:211], v20 offset:41984
    s_waitcnt lgkmcnt(8)
    v_mfma_f32_32x32x16_bf16 v[128:143], v[216:219], v[68:71], v[128:143]
    ds_read_b64_tr_b16 v[212:213], v21 offset:40960
    ds_read_b64_tr_b16 v[214:215], v21 offset:41984
    s_add_u32 m0, s63, 32768
    s_nop 0
    buffer_load_dwordx4 v48, s[12:15], s43 offen offset:0 lds
    s_waitcnt lgkmcnt(8)
    v_mfma_f32_32x32x16_bf16 v[144:159], v[220:223], v[68:71], v[144:159]
    ds_read_b64_tr_b16 v[216:217], v22 offset:40960
    ds_read_b64_tr_b16 v[218:219], v22 offset:41984
    s_waitcnt lgkmcnt(8)
    v_mfma_f32_32x32x16_bf16 v[160:175], v[224:227], v[68:71], v[160:175]
    ds_read_b64_tr_b16 v[220:221], v23 offset:40960
    ds_read_b64_tr_b16 v[222:223], v23 offset:41984
    buffer_load_dwordx4 v49, s[12:15], s43 offen offset:1024 lds
    s_waitcnt lgkmcnt(8)
    v_mfma_f32_32x32x16_bf16 v[176:191], v[228:231], v[68:71], v[176:191]
    ds_read_b64_tr_b16 v[224:225], v20 offset:45056
    ds_read_b64_tr_b16 v[226:227], v20 offset:46080
    s_waitcnt lgkmcnt(8)
    v_mfma_f32_32x32x16_bf16 v[128:143], v[208:211], v[72:75], v[128:143]
    ds_read_b64_tr_b16 v[228:229], v21 offset:45056
    ds_read_b64_tr_b16 v[230:231], v21 offset:46080
    buffer_load_dwordx4 v50, s[12:15], s43 offen offset:2048 lds
    s_waitcnt lgkmcnt(8)
    v_mfma_f32_32x32x16_bf16 v[144:159], v[212:215], v[72:75], v[144:159]
    ds_read_b64_tr_b16 v[208:209], v22 offset:45056
    ds_read_b64_tr_b16 v[210:211], v22 offset:46080
    s_waitcnt lgkmcnt(8)
    v_mfma_f32_32x32x16_bf16 v[160:175], v[216:219], v[72:75], v[160:175]
    ds_read_b64_tr_b16 v[212:213], v23 offset:45056
    ds_read_b64_tr_b16 v[214:215], v23 offset:46080
    buffer_load_dwordx4 v51, s[12:15], s43 offen offset:3072 lds
    s_add_u32 s43, s43, 128
    s_and_b32 s43, s43, 1023
    s_waitcnt lgkmcnt(8)
    v_mfma_f32_32x32x16_bf16 v[176:191], v[220:223], v[72:75], v[176:191]
    s_waitcnt lgkmcnt(6)
    v_mfma_f32_32x32x16_bf16 v[128:143], v[224:227], v[76:79], v[128:143]
    s_waitcnt lgkmcnt(4)
    v_mfma_f32_32x32x16_bf16 v[144:159], v[228:231], v[76:79], v[144:159]
    s_waitcnt lgkmcnt(2)
    v_mfma_f32_32x32x16_bf16 v[160:175], v[208:211], v[76:79], v[160:175]
    s_waitcnt lgkmcnt(0)
    v_mfma_f32_32x32x16_bf16 v[176:191], v[212:215], v[76:79], v[176:191]
    s_waitcnt vmcnt(8)
    s_barrier
    ds_read_b128 v[64:67], v52 offset:49152
    ds_read_b128 v[68:71], v53 offset:49152
    ds_read_b128 v[72:75], v54 offset:49152
    ds_read_b128 v[76:79], v55 offset:49152
    ds_read_b64_tr_b16 v[216:217], v20 offset:49152
    ds_read_b64_tr_b16 v[218:219], v20 offset:50176
    ds_read_b64_tr_b16 v[220:221], v21 offset:49152
    ds_read_b64_tr_b16 v[222:223], v21 offset:50176
    ds_read_b64_tr_b16 v[224:225], v22 offset:49152
    ds_read_b64_tr_b16 v[226:227], v22 offset:50176
    ds_read_b64_tr_b16 v[228:229], v23 offset:49152
    ds_read_b64_tr_b16 v[230:231], v23 offset:50176
    ds_read_b64_tr_b16 v[208:209], v20 offset:53248
    ds_read_b64_tr_b16 v[210:211], v20 offset:54272
    s_waitcnt lgkmcnt(10)
    s_waitcnt lgkmcnt(8)
    v_mfma_f32_32x32x16_bf16 v[128:143], v[216:219], v[64:67], v[128:143]
    ds_read_b64_tr_b16 v[212:213], v21 offset:53248
    ds_read_b64_tr_b16 v[214:215], v21 offset:54272
    s_add_u32 m0, s40, 32768
    s_nop 0
    buffer_load_dwordx4 v27, s[24:27], s41 offen offset:0 lds
    s_waitcnt lgkmcnt(8)
    v_mfma_f32_32x32x16_bf16 v[144:159], v[220:223], v[64:67], v[144:159]
    ds_read_b64_tr_b16 v[216:217], v22 offset:53248
    ds_read_b64_tr_b16 v[218:219], v22 offset:54272
    s_waitcnt lgkmcnt(8)
    v_mfma_f32_32x32x16_bf16 v[160:175], v[224:227], v[64:67], v[160:175]
    ds_read_b64_tr_b16 v[220:221], v23 offset:53248
    ds_read_b64_tr_b16 v[222:223], v23 offset:54272
    buffer_load_dwordx4 v28, s[24:27], s41 offen offset:1024 lds
    s_add_u32 s41, s41, 524288
    s_and_b32 s41, s41, 0x3fffff
    s_waitcnt lgkmcnt(8)
    v_mfma_f32_32x32x16_bf16 v[176:191], v[228:231], v[64:67], v[176:191]
    ds_read_b64_tr_b16 v[224:225], v20 offset:57344
    ds_read_b64_tr_b16 v[226:227], v20 offset:58368
    s_waitcnt lgkmcnt(8)
    v_mfma_f32_32x32x16_bf16 v[128:143], v[208:211], v[68:71], v[128:143]
    ds_read_b64_tr_b16 v[228:229], v21 offset:57344
    ds_read_b64_tr_b16 v[230:231], v21 offset:58368
    s_add_u32 m0, s63, 81920
    s_nop 0
    buffer_load_dwordx4 v48, s[12:15], s43 offen offset:0 lds
    s_waitcnt lgkmcnt(8)
    v_mfma_f32_32x32x16_bf16 v[144:159], v[212:215], v[68:71], v[144:159]
    ds_read_b64_tr_b16 v[208:209], v22 offset:57344
    ds_read_b64_tr_b16 v[210:211], v22 offset:58368
    s_waitcnt lgkmcnt(8)
    v_mfma_f32_32x32x16_bf16 v[160:175], v[216:219], v[68:71], v[160:175]
    ds_read_b64_tr_b16 v[212:213], v23 offset:57344
    ds_read_b64_tr_b16 v[214:215], v23 offset:58368
    buffer_load_dwordx4 v49, s[12:15], s43 offen offset:1024 lds
    s_waitcnt lgkmcnt(8)
    v_mfma_f32_32x32x16_bf16 v[176:191], v[220:223], v[68:71], v[176:191]
    ds_read_b64_tr_b16 v[216:217], v20 offset:61440
    ds_read_b64_tr_b16 v[218:219], v20 offset:62464
    s_waitcnt lgkmcnt(8)
    v_mfma_f32_32x32x16_bf16 v[128:143], v[224:227], v[72:75], v[128:143]
    ds_read_b64_tr_b16 v[220:221], v21 offset:61440
    ds_read_b64_tr_b16 v[222:223], v21 offset:62464
    buffer_load_dwordx4 v50, s[12:15], s43 offen offset:2048 lds
    s_waitcnt lgkmcnt(8)
    v_mfma_f32_32x32x16_bf16 v[144:159], v[228:231], v[72:75], v[144:159]
    ds_read_b64_tr_b16 v[224:225], v22 offset:61440
    ds_read_b64_tr_b16 v[226:227], v22 offset:62464
    s_waitcnt lgkmcnt(8)
    v_mfma_f32_32x32x16_bf16 v[160:175], v[208:211], v[72:75], v[160:175]
    ds_read_b64_tr_b16 v[228:229], v23 offset:61440
    ds_read_b64_tr_b16 v[230:231], v23 offset:62464
    buffer_load_dwordx4 v51, s[12:15], s43 offen offset:3072 lds
    s_add_u32 s43, s43, 128
    s_and_b32 s43, s43, 1023
    s_waitcnt lgkmcnt(8)
    v_mfma_f32_32x32x16_bf16 v[176:191], v[212:215], v[72:75], v[176:191]
    s_waitcnt lgkmcnt(6)
    v_mfma_f32_32x32x16_bf16 v[128:143], v[216:219], v[76:79], v[128:143]
    s_add_u32 m0, s39, 0
    s_nop 0
    buffer_load_dwordx4 v26, s[20:23], s37 offen offset:0 nt lds
    s_waitcnt lgkmcnt(4)
    v_mfma_f32_32x32x16_bf16 v[144:159], v[220:223], v[76:79], v[144:159]
    s_waitcnt lgkmcnt(2)
    v_mfma_f32_32x32x16_bf16 v[160:175], v[224:227], v[76:79], v[160:175]
    buffer_load_dwordx4 v26, s[20:23], s37 offen offset:1024 nt lds
    s_add_u32 s37, s37, 16384
    s_waitcnt lgkmcnt(0)
    v_mfma_f32_32x32x16_bf16 v[176:191], v[228:231], v[76:79], v[176:191]
    s_waitcnt vmcnt(8)
    s_barrier
    ds_read_b128 v[64:67], v52 offset:0
    ds_read_b128 v[68:71], v53 offset:0
    ds_read_b128 v[72:75], v54 offset:0
    ds_read_b128 v[76:79], v55 offset:0
    ds_read_b64_tr_b16 v[208:209], v20 offset:16384
    ds_read_b64_tr_b16 v[210:211], v20 offset:17408
    ds_read_b64_tr_b16 v[212:213], v21 offset:16384
    ds_read_b64_tr_b16 v[214:215], v21 offset:17408
    ds_read_b64_tr_b16 v[216:217], v22 offset:16384
    ds_read_b64_tr_b16 v[218:219], v22 offset:17408
    ds_read_b64_tr_b16 v[220:221], v23 offset:16384
    ds_read_b64_tr_b16 v[222:223], v23 offset:17408
    ds_read_b64_tr_b16 v[224:225], v20 offset:20480
    ds_read_b64_tr_b16 v[226:227], v20 offset:21504
    s_waitcnt lgkmcnt(10)
    s_waitcnt lgkmcnt(8)
    v_mfma_f32_32x32x16_bf16 v[128:143], v[208:211], v[64:67], v[128:143]
    ds_read_b64_tr_b16 v[228:229], v21 offset:20480
    ds_read_b64_tr_b16 v[230:231], v21 offset:21504
    s_waitcnt lgkmcnt(8)
    v_mfma_f32_32x32x16_bf16 v[144:159], v[212:215], v[64:67], v[144:159]
    ds_read_b64_tr_b16 v[208:209], v22 offset:20480
    ds_read_b64_tr_b16 v[210:211], v22 offset:21504
    s_waitcnt lgkmcnt(8)
    v_mfma_f32_32x32x16_bf16 v[160:175], v[216:219], v[64:67], v[160:175]
    ds_read_b64_tr_b16 v[212:213], v23 offset:20480
    ds_read_b64_tr_b16 v[214:215], v23 offset:21504
    s_waitcnt lgkmcnt(8)
    v_mfma_f32_32x32x16_bf16 v[176:191], v[220:223], v[64:67], v[176:191]
    ds_read_b64_tr_b16 v[216:217], v20 offset:24576
    ds_read_b64_tr_b16 v[218:219], v20 offset:25600
    s_waitcnt lgkmcnt(8)
    v_mfma_f32_32x32x16_bf16 v[128:143], v[224:227], v[68:71], v[128:143]
    ds_read_b64_tr_b16 v[220:221], v21 offset:24576
    ds_read_b64_tr_b16 v[222:223], v21 offset:25600
    s_waitcnt lgkmcnt(8)
    v_mfma_f32_32x32x16_bf16 v[144:159], v[228:231], v[68:71], v[144:159]
    ds_read_b64_tr_b16 v[224:225], v22 offset:24576
    ds_read_b64_tr_b16 v[226:227], v22 offset:25600
    s_waitcnt lgkmcnt(8)
    v_mfma_f32_32x32x16_bf16 v[160:175], v[208:211], v[68:71], v[160:175]
    ds_read_b64_tr_b16 v[228:229], v23 offset:24576
    ds_read_b64_tr_b16 v[230:231], v23 offset:25600
    s_waitcnt lgkmcnt(8)
    v_mfma_f32_32x32x16_bf16 v[176:191], v[212:215], v[68:71], v[176:191]
    ds_read_b64_tr_b16 v[208:209], v20 offset:28672
    ds_read_b64_tr_b16 v[210:211], v20 offset:29696
    s_waitcnt lgkmcnt(8)
    v_mfma_f32_32x32x16_bf16 v[128:143], v[216:219], v[72:75], v[128:143]
    ds_read_b64_tr_b16 v[212:213], v21 offset:28672
    ds_read_b64_tr_b16 v[214:215], v21 offset:29696
    s_waitcnt lgkmcnt(8)
    v_mfma_f32_32x32x16_bf16 v[144:159], v[220:223], v[72:75], v[144:159]
    ds_read_b64_tr_b16 v[216:217], v22 offset:28672
    ds_read_b64_tr_b16 v[218:219], v22 offset:29696
    s_waitcnt lgkmcnt(8)
    v_mfma_f32_32x32x16_bf16 v[160:175], v[224:227], v[72:75], v[160:175]
    ds_read_b64_tr_b16 v[220:221], v23 offset:28672
    ds_read_b64_tr_b16 v[222:223], v23 offset:29696
    s_waitcnt lgkmcnt(8)
    v_mfma_f32_32x32x16_bf16 v[176:191], v[228:231], v[72:75], v[176:191]
    s_waitcnt lgkmcnt(6)
    v_mfma_f32_32x32x16_bf16 v[128:143], v[208:211], v[76:79], v[128:143]
    s_waitcnt lgkmcnt(4)
    v_mfma_f32_32x32x16_bf16 v[144:159], v[212:215], v[76:79], v[144:159]
    s_waitcnt lgkmcnt(2)
    v_mfma_f32_32x32x16_bf16 v[160:175], v[216:219], v[76:79], v[160:175]
    s_waitcnt lgkmcnt(0)
    v_mfma_f32_32x32x16_bf16 v[176:191], v[220:223], v[76:79], v[176:191]
    s_waitcnt vmcnt(2)
    s_barrier
    ds_read_b128 v[64:67], v52 offset:49152
    ds_read_b128 v[68:71], v53 offset:49152
    ds_read_b128 v[72:75], v54 offset:49152
    ds_read_b128 v[76:79], v55 offset:49152
    ds_read_b64_tr_b16 v[224:225], v20 offset:32768
    ds_read_b64_tr_b16 v[226:227], v20 offset:33792
    ds_read_b64_tr_b16 v[228:229], v21 offset:32768
    ds_read_b64_tr_b16 v[230:231], v21 offset:33792
    ds_read_b64_tr_b16 v[208:209], v22 offset:32768
    ds_read_b64_tr_b16 v[210:211], v22 offset:33792
    ds_read_b64_tr_b16 v[212:213], v23 offset:32768
    ds_read_b64_tr_b16 v[214:215], v23 offset:33792
    ds_read_b64_tr_b16 v[216:217], v20 offset:36864
    ds_read_b64_tr_b16 v[218:219], v20 offset:37888
    s_waitcnt lgkmcnt(10)
    s_waitcnt lgkmcnt(8)
    v_mfma_f32_32x32x16_bf16 v[128:143], v[224:227], v[64:67], v[128:143]
    ds_read_b64_tr_b16 v[220:221], v21 offset:36864
    ds_read_b64_tr_b16 v[222:223], v21 offset:37888
    s_add_u32 m0, s38, 32768
    s_nop 0
    buffer_load_dwordx4 v24, s[16:19], s36 offen offset:0 nt lds
    s_waitcnt lgkmcnt(8)
    v_mfma_f32_32x32x16_bf16 v[144:159], v[228:231], v[64:67], v[144:159]
    ds_read_b64_tr_b16 v[224:225], v22 offset:36864
    ds_read_b64_tr_b16 v[226:227], v22 offset:37888
    s_waitcnt lgkmcnt(8)
    v_mfma_f32_32x32x16_bf16 v[160:175], v[208:211], v[64:67], v[160:175]
    ds_read_b64_tr_b16 v[228:229], v23 offset:36864
    ds_read_b64_tr_b16 v[230:231], v23 offset:37888
    buffer_load_dwordx4 v25, s[16:19], s36 offen offset:1024 nt lds
    s_add_u32 s36, s36, 16384
    s_waitcnt lgkmcnt(8)
    v_mfma_f32_32x32x16_bf16 v[176:191], v[212:215], v[64:67], v[176:191]
    ds_read_b64_tr_b16 v[208:209], v20 offset:40960
    ds_read_b64_tr_b16 v[210:211], v20 offset:41984
    s_waitcnt lgkmcnt(8)
    v_mfma_f32_32x32x16_bf16 v[128:143], v[216:219], v[68:71], v[128:143]
    ds_read_b64_tr_b16 v[212:213], v21 offset:40960
    ds_read_b64_tr_b16 v[214:215], v21 offset:41984
    s_waitcnt lgkmcnt(8)
    v_mfma_f32_32x32x16_bf16 v[144:159], v[220:223], v[68:71], v[144:159]
    ds_read_b64_tr_b16 v[216:217], v22 offset:40960
    ds_read_b64_tr_b16 v[218:219], v22 offset:41984
    s_waitcnt lgkmcnt(8)
    v_mfma_f32_32x32x16_bf16 v[160:175], v[224:227], v[68:71], v[160:175]
    ds_read_b64_tr_b16 v[220:221], v23 offset:40960
    ds_read_b64_tr_b16 v[222:223], v23 offset:41984
    s_waitcnt lgkmcnt(8)
    v_mfma_f32_32x32x16_bf16 v[176:191], v[228:231], v[68:71], v[176:191]
    ds_read_b64_tr_b16 v[224:225], v20 offset:45056
    ds_read_b64_tr_b16 v[226:227], v20 offset:46080
    s_waitcnt lgkmcnt(8)
    v_mfma_f32_32x32x16_bf16 v[128:143], v[208:211], v[72:75], v[128:143]
    ds_read_b64_tr_b16 v[228:229], v21 offset:45056
    ds_read_b64_tr_b16 v[230:231], v21 offset:46080
    s_waitcnt lgkmcnt(8)
    v_mfma_f32_32x32x16_bf16 v[144:159], v[212:215], v[72:75], v[144:159]
    ds_read_b64_tr_b16 v[208:209], v22 offset:45056
    ds_read_b64_tr_b16 v[210:211], v22 offset:46080
    s_waitcnt lgkmcnt(8)
    v_mfma_f32_32x32x16_bf16 v[160:175], v[216:219], v[72:75], v[160:175]
    ds_read_b64_tr_b16 v[212:213], v23 offset:45056
    ds_read_b64_tr_b16 v[214:215], v23 offset:46080
    s_waitcnt lgkmcnt(8)
    v_mfma_f32_32x32x16_bf16 v[176:191], v[220:223], v[72:75], v[176:191]
    s_waitcnt lgkmcnt(6)
    v_mfma_f32_32x32x16_bf16 v[128:143], v[224:227], v[76:79], v[128:143]
    s_waitcnt lgkmcnt(4)
    v_mfma_f32_32x32x16_bf16 v[144:159], v[228:231], v[76:79], v[144:159]
    s_waitcnt lgkmcnt(2)
    v_mfma_f32_32x32x16_bf16 v[160:175], v[208:211], v[76:79], v[160:175]
    s_waitcnt lgkmcnt(0)
    v_mfma_f32_32x32x16_bf16 v[176:191], v[212:215], v[76:79], v[176:191]
    s_nop 7
    s_nop 7
    v_cvt_pk_bf16_f32 v32, v128, v129
    v_cvt_pk_bf16_f32 v33, v130, v131
    v_cvt_pk_bf16_f32 v34, v132, v133
    v_cvt_pk_bf16_f32 v35, v134, v135
    v_cvt_pk_bf16_f32 v36, v136, v137
    v_cvt_pk_bf16_f32 v37, v138, v139
    v_cvt_pk_bf16_f32 v38, v140, v141
    v_cvt_pk_bf16_f32 v39, v142, v143
    v_cvt_pk_bf16_f32 v40, v144, v145
    v_cvt_pk_bf16_f32 v41, v146, v147
    v_cvt_pk_bf16_f32 v42, v148, v149
    v_cvt_pk_bf16_f32 v43, v150, v151
    v_cvt_pk_bf16_f32 v44, v152, v153
    v_cvt_pk_bf16_f32 v45, v154, v155
    v_cvt_pk_bf16_f32 v46, v156, v157
    v_cvt_pk_bf16_f32 v47, v158, v159
    v_cvt_pk_bf16_f32 v48, v160, v161
    v_cvt_pk_bf16_f32 v49, v162, v163
    v_cvt_pk_bf16_f32 v50, v164, v165
    v_cvt_pk_bf16_f32 v51, v166, v167
    v_cvt_pk_bf16_f32 v52, v168, v169
    v_cvt_pk_bf16_f32 v53, v170, v171
    v_cvt_pk_bf16_f32 v54, v172, v173
    v_cvt_pk_bf16_f32 v55, v174, v175
    v_cvt_pk_bf16_f32 v56, v176, v177
    v_cvt_pk_bf16_f32 v57, v178, v179
    v_cvt_pk_bf16_f32 v58, v180, v181
    v_cvt_pk_bf16_f32 v59, v182, v183
    v_cvt_pk_bf16_f32 v60, v184, v185
    v_cvt_pk_bf16_f32 v61, v186, v187
    v_cvt_pk_bf16_f32 v62, v188, v189
    v_cvt_pk_bf16_f32 v63, v190, v191
    v_mov_b32 v30, 0xff800000
    s_mov_b32 s62, 0x427af233
    s_mov_b32 s61, 0
    v_mov_b32 v31, 0
    s_waitcnt vmcnt(30)
    s_barrier
    s_add_u32 m0, s39, 16384
    s_nop 0
    buffer_load_dwordx4 v26, s[20:23], s37 offen offset:0 nt lds
    buffer_load_dwordx4 v26, s[20:23], s37 offen offset:1024 nt lds
    s_add_u32 s37, s37, 16384
    s_add_u32 m0, s39, 32768
    s_nop 0
    buffer_load_dwordx4 v26, s[20:23], s37 offen offset:0 nt lds
    buffer_load_dwordx4 v26, s[20:23], s37 offen offset:1024 nt lds
    s_add_u32 s37, s37, 16384
    s_add_u32 m0, s38, 49152
    s_nop 0
    buffer_load_dwordx4 v24, s[16:19], s36 offen offset:0 nt lds
    buffer_load_dwordx4 v25, s[16:19], s36 offen offset:1024 nt lds
    s_add_u32 s36, s36, 16384
    ds_read_b128 v[216:219], v8 offset:0
    ds_read_b128 v[220:223], v9 offset:0
    ds_read_b128 v[224:227], v10 offset:0
    ds_read_b128 v[228:231], v11 offset:0
    ds_read_b128 v[208:211], v12 offset:0
    s_waitcnt lgkmcnt(4)
    v_mfma_f32_32x32x16_bf16 v[128:143], v[216:219], v[32:35], 0
    ds_read_b128 v[212:215], v13 offset:0
    s_waitcnt lgkmcnt(4)
    v_mfma_f32_32x32x16_bf16 v[128:143], v[220:223], v[36:39], v[128:143]
    ds_read_b128 v[216:219], v14 offset:0
    s_waitcnt lgkmcnt(4)
    v_mfma_f32_32x32x16_bf16 v[128:143], v[224:227], v[40:43], v[128:143]
    ds_read_b128 v[220:223], v15 offset:0
    s_waitcnt lgkmcnt(4)
    v_mfma_f32_32x32x16_bf16 v[128:143], v[228:231], v[44:47], v[128:143]
    ds_read_b128 v[224:227], v8 offset:8192
    s_waitcnt lgkmcnt(4)
    v_mfma_f32_32x32x16_bf16 v[128:143], v[208:211], v[48:51], v[128:143]
    ds_read_b128 v[228:231], v9 offset:8192
    s_waitcnt lgkmcnt(4)
    v_mfma_f32_32x32x16_bf16 v[128:143], v[212:215], v[52:55], v[128:143]
    ds_read_b128 v[208:211], v10 offset:8192
    s_waitcnt lgkmcnt(4)
    v_mfma_f32_32x32x16_bf16 v[128:143], v[216:219], v[56:59], v[128:143]
    ds_read_b128 v[212:215], v11 offset:8192
    s_waitcnt lgkmcnt(4)
    v_mfma_f32_32x32x16_bf16 v[128:143], v[220:223], v[60:63], v[128:143]
    ds_read_b128 v[216:219], v12 offset:8192
    s_waitcnt lgkmcnt(4)
    v_mfma_f32_32x32x16_bf16 v[144:159], v[224:227], v[32:35], 0
    ds_read_b128 v[220:223], v13 offset:8192
    s_waitcnt lgkmcnt(4)
    v_mfma_f32_32x32x16_bf16 v[144:159], v[228:231], v[36:39], v[144:159]
    ds_read_b128 v[224:227], v14 offset:8192
    s_waitcnt lgkmcnt(4)
    v_mfma_f32_32x32x16_bf16 v[144:159], v[208:211], v[40:43], v[144:159]
    ds_read_b128 v[228:231], v15 offset:8192
    s_waitcnt lgkmcnt(4)
    v_mfma_f32_32x32x16_bf16 v[144:159], v[212:215], v[44:47], v[144:159]
    s_waitcnt lgkmcnt(3)
    v_mfma_f32_32x32x16_bf16 v[144:159], v[216:219], v[48:51], v[144:159]
    s_waitcnt lgkmcnt(2)
    v_mfma_f32_32x32x16_bf16 v[144:159], v[220:223], v[52:55], v[144:159]
    s_waitcnt lgkmcnt(1)
    v_mfma_f32_32x32x16_bf16 v[144:159], v[224:227], v[56:59], v[144:159]
    s_waitcnt lgkmcnt(0)
    v_mfma_f32_32x32x16_bf16 v[144:159], v[228:231], v[60:63], v[144:159]
    s_waitcnt vmcnt(8)
    s_barrier
    ds_read_b128 v[208:211], v8 offset:16384
    ds_read_b128 v[212:215], v9 offset:16384
    ds_read_b128 v[216:219], v10 offset:16384
    ds_read_b128 v[220:223], v11 offset:16384
    ds_read_b128 v[224:227], v12 offset:16384
    s_waitcnt lgkmcnt(4)
    v_mfma_f32_32x32x16_bf16 v[160:175], v[208:211], v[32:35], 0
    ds_read_b128 v[228:231], v13 offset:16384
    v_max3_f32 v2, v128, v129, v130
    v_max3_f32 v3, v131, v132, v133
    v_max3_f32 v4, v134, v135, v136
    v_max3_f32 v5, v137, v138, v139
    v_max3_f32 v2, v2, v140, v141
    v_max3_f32 v3, v3, v142, v143
    v_max3_f32 v4, v4, v144, v145
    v_max3_f32 v5, v5, v146, v147
    v_max3_f32 v2, v2, v148, v149
    v_max3_f32 v3, v3, v150, v151
    v_max3_f32 v4, v4, v152, v153
    s_waitcnt lgkmcnt(4)
    v_mfma_f32_32x32x16_bf16 v[160:175], v[212:215], v[36:39], v[160:175]
    ds_read_b128 v[208:211], v14 offset:16384
    s_add_u32 m0, s38, 0
    s_nop 0
    buffer_load_dwordx4 v24, s[16:19], s36 offen offset:0 nt lds
    v_max3_f32 v5, v5, v154, v155
    v_max3_f32 v2, v2, v156, v157
    v_max3_f32 v3, v3, v158, v159
    v_max3_f32 v2, v2, v3, v4
    v_max_f32 v2, v2, v5
    v_mov_b32 v3, v2
    s_nop 1
    v_permlane32_swap_b32 v2, v3
    v_max_f32 v2, v2, v3
    v_sub_f32 v3, v2, v30
    s_waitcnt lgkmcnt(4)
    v_mfma_f32_32x32x16_bf16 v[160:175], v[216:219], v[40:43], v[160:175]
    ds_read_b128 v[212:215], v15 offset:16384
    v_cmp_lt_f32 vcc, s62, v3
    s_cbranch_vccnz L_rs1_0
    L_bk1_0:
    v_fma_f32 v128, v128, s35, -v233
    v_fma_f32 v129, v129, s35, -v233
    v_exp_f32 v128, v128
    v_fma_f32 v130, v130, s35, -v233
    v_exp_f32 v129, v129
    v_add_f32 v31, v31, v128
    s_waitcnt lgkmcnt(4)
    v_mfma_f32_32x32x16_bf16 v[160:175], v[220:223], v[44:47], v[160:175]
    ds_read_b128 v[216:219], v8 offset:24576
    buffer_load_dwordx4 v25, s[16:19], s36 offen offset:1024 nt lds
    s_add_u32 s36, s36, 16384
    v_cvt_pk_bf16_f32 v192, v128, v129
    v_fma_f32 v131, v131, s35, -v233
    v_exp_f32 v130, v130
    v_add_f32 v31, v31, v129
    v_fma_f32 v132, v132, s35, -v233
    v_exp_f32 v131, v131
    v_add_f32 v31, v31, v130
    v_cvt_pk_bf16_f32 v193, v130, v131
    s_waitcnt lgkmcnt(4)
    v_mfma_f32_32x32x16_bf16 v[160:175], v[224:227], v[48:51], v[160:175]
    ds_read_b128 v[220:223], v9 offset:24576
    v_fma_f32 v133, v133, s35, -v233
    v_exp_f32 v132, v132
    v_add_f32 v31, v31, v131
    v_fma_f32 v134, v134, s35, -v233
    v_exp_f32 v133, v133
    v_add_f32 v31, v31, v132
    v_cvt_pk_bf16_f32 v194, v132, v133
    v_fma_f32 v135, v135, s35, -v233
    v_exp_f32 v134, v134
    s_waitcnt lgkmcnt(4)
    v_mfma_f32_32x32x16_bf16 v[160:175], v[228:231], v[52:55], v[160:175]
    ds_read_b128 v[224:227], v10 offset:24576
    s_add_u32 m0, s39, 49152
    s_nop 0
    buffer_load_dwordx4 v26, s[20:23], s37 offen offset:0 nt lds
    v_add_f32 v31, v31, v133
    v_fma_f32 v136, v136, s35, -v233
    v_exp_f32 v135, v135
    v_add_f32 v31, v31, v134
    v_cvt_pk_bf16_f32 v195, v134, v135
    v_fma_f32 v137, v137, s35, -v233
    v_exp_f32 v136, v136
    s_waitcnt lgkmcnt(4)
    v_mfma_f32_32x32x16_bf16 v[160:175], v[208:211], v[56:59], v[160:175]
    ds_read_b128 v[228:231], v11 offset:24576
    v_add_f32 v31, v31, v135
    v_fma_f32 v138, v138, s35, -v233
    v_exp_f32 v137, v137
    v_add_f32 v31, v31, v136
    v_cvt_pk_bf16_f32 v196, v136, v137
    v_fma_f32 v139, v139, s35, -v233
    v_exp_f32 v138, v138
    v_add_f32 v31, v31, v137
    v_fma_f32 v140, v140, s35, -v233
    s_waitcnt lgkmcnt(4)
    v_mfma_f32_32x32x16_bf16 v[160:175], v[212:215], v[60:63], v[160:175]
    ds_read_b128 v[208:211], v12 offset:24576
    buffer_load_dwordx4 v26, s[20:23], s37 offen offset:1024 nt lds
    s_add_u32 s37, s37, 16384
    v_exp_f32 v139, v139
    v_add_f32 v31, v31, v138
    v_cvt_pk_bf16_f32 v197, v138, v139
    v_fma_f32 v141, v141, s35, -v233
    v_exp_f32 v140, v140
    v_add_f32 v31, v31, v139
    v_fma_f32 v142, v142, s35, -v233
    v_exp_f32 v141, v141
    s_waitcnt lgkmcnt(4)
    v_mfma_f32_32x32x16_bf16 v[176:191], v[216:219], v[32:35], 0
    ds_read_b128 v[212:215], v13 offset:24576
    v_add_f32 v31, v31, v140
    v_cvt_pk_bf16_f32 v198, v140, v141
    v_fma_f32 v143, v143, s35, -v233
    v_exp_f32 v142, v142
    v_add_f32 v31, v31, v141
    v_fma_f32 v144, v144, s35, -v233
    v_exp_f32 v143, v143
    v_add_f32 v31, v31, v142
    s_waitcnt lgkmcnt(4)
    v_mfma_f32_32x32x16_bf16 v[176:191], v[220:223], v[36:39], v[176:191]
    ds_read_b128 v[216:219], v14 offset:24576
    v_cvt_pk_bf16_f32 v199, v142, v143
    v_fma_f32 v145, v145, s35, -v233
    v_exp_f32 v144, v144
    v_add_f32 v31, v31, v143
    v_fma_f32 v146, v146, s35, -v233
    v_exp_f32 v145, v145
    v_add_f32 v31, v31, v144
    v_cvt_pk_bf16_f32 v200, v144, v145
    s_waitcnt lgkmcnt(4)
    v_mfma_f32_32x32x16_bf16 v[176:191], v[224:227], v[40:43], v[176:191]
    ds_read_b128 v[220:223], v15 offset:24576
    v_fma_f32 v147, v147, s35, -v233
    v_exp_f32 v146, v146
    v_add_f32 v31, v31, v145
    v_fma_f32 v148, v148, s35, -v233
    v_exp_f32 v147, v147
    v_add_f32 v31, v31, v146
    v_cvt_pk_bf16_f32 v201, v146, v147
    v_fma_f32 v149, v149, s35, -v233
    v_exp_f32 v148, v148
    s_waitcnt lgkmcnt(4)
    v_mfma_f32_32x32x16_bf16 v[176:191], v[228:231], v[44:47], v[176:191]
    ds_read_b64_tr_b16 v[224:225], v16 offset:0
    ds_read_b64_tr_b16 v[226:227], v16 offset:2048
    v_add_f32 v31, v31, v147
    v_fma_f32 v150, v150, s35, -v233
    v_exp_f32 v149, v149
    v_add_f32 v31, v31, v148
    v_cvt_pk_bf16_f32 v202, v148, v149
    v_fma_f32 v151, v151, s35, -v233
    v_exp_f32 v150, v150
    s_waitcnt lgkmcnt(5)
    v_mfma_f32_32x32x16_bf16 v[176:191], v[208:211], v[48:51], v[176:191]
    ds_read_b64_tr_b16 v[228:229], v16 offset:4096
    ds_read_b64_tr_b16 v[230:231], v16 offset:6144
    v_add_f32 v31, v31, v149
    v_fma_f32 v152, v152, s35, -v233
    v_exp_f32 v151, v151
    v_add_f32 v31, v31, v150
    v_cvt_pk_bf16_f32 v203, v150, v151
    v_fma_f32 v153, v153, s35, -v233
    v_exp_f32 v152, v152
    v_add_f32 v31, v31, v151
    v_fma_f32 v154, v154, s35, -v233
    s_waitcnt lgkmcnt(6)
    v_mfma_f32_32x32x16_bf16 v[176:191], v[212:215], v[52:55], v[176:191]
    ds_read_b64_tr_b16 v[208:209], v16 offset:8192
    ds_read_b64_tr_b16 v[210:211], v16 offset:10240
    v_exp_f32 v153, v153
    v_add_f32 v31, v31, v152
    v_cvt_pk_bf16_f32 v204, v152, v153
    v_fma_f32 v155, v155, s35, -v233
    v_exp_f32 v154, v154
    v_add_f32 v31, v31, v153
    v_fma_f32 v156, v156, s35, -v233
    v_exp_f32 v155, v155
    s_waitcnt lgkmcnt(7)
    v_mfma_f32_32x32x16_bf16 v[176:191], v[216:219], v[56:59], v[176:191]
    ds_read_b64_tr_b16 v[212:213], v16 offset:12288
    ds_read_b64_tr_b16 v[214:215], v16 offset:14336
    v_add_f32 v31, v31, v154
    v_cvt_pk_bf16_f32 v205, v154, v155
    v_fma_f32 v157, v157, s35, -v233
    v_exp_f32 v156, v156
    v_add_f32 v31, v31, v155
    v_fma_f32 v158, v158, s35, -v233
    v_exp_f32 v157, v157
    v_add_f32 v31, v31, v156
    s_waitcnt lgkmcnt(8)
    v_mfma_f32_32x32x16_bf16 v[176:191], v[220:223], v[60:63], v[176:191]
    ds_read_b64_tr_b16 v[216:217], v17 offset:0
    ds_read_b64_tr_b16 v[218:219], v17 offset:2048
    v_cvt_pk_bf16_f32 v206, v156, v157
    v_fma_f32 v159, v159, s35, -v233
    v_exp_f32 v158, v158
    v_add_f32 v31, v31, v157
    v_exp_f32 v159, v159
    v_add_f32 v31, v31, v158
    v_cvt_pk_bf16_f32 v207, v158, v159
    v_add_f32 v31, v31, v159
    s_nop 0
    s_mov_b32 s61, 0
    s_waitcnt vmcnt(8)
    s_barrier
    s_waitcnt lgkmcnt(8)
    v_mfma_f32_32x32x16_bf16 v[64:79], v[224:227], v[192:195], 0
    ds_read_b64_tr_b16 v[220:221], v17 offset:4096
    ds_read_b64_tr_b16 v[222:223], v17 offset:6144
    v_max3_f32 v2, v160, v161, v162
    v_max3_f32 v3, v163, v164, v165
    v_max3_f32 v4, v166, v167, v168
    v_max3_f32 v5, v169, v170, v171
    v_max3_f32 v2, v2, v172, v173
    v_max3_f32 v3, v3, v174, v175
    s_waitcnt lgkmcnt(8)
    v_mfma_f32_32x32x16_bf16 v[64:79], v[228:231], v[196:199], v[64:79]
    ds_read_b64_tr_b16 v[224:225], v17 offset:8192
    ds_read_b64_tr_b16 v[226:227], v17 offset:10240
    s_add_u32 m0, s38, 16384
    s_nop 0
    buffer_load_dwordx4 v24, s[16:19], s36 offen offset:0 nt lds
    v_max3_f32 v4, v4, v176, v177
    v_max3_f32 v5, v5, v178, v179
    v_max3_f32 v2, v2, v180, v181
    v_max3_f32 v3, v3, v182, v183
    v_max3_f32 v4, v4, v184, v185
    s_waitcnt lgkmcnt(8)
    v_mfma_f32_32x32x16_bf16 v[64:79], v[208:211], v[200:203], v[64:79]
    ds_read_b64_tr_b16 v[228:229], v17 offset:12288
    ds_read_b64_tr_b16 v[230:231], v17 offset:14336
    v_max3_f32 v5, v5, v186, v187
    v_max3_f32 v2, v2, v188, v189
    v_max3_f32 v3, v3, v190, v191
    v_max3_f32 v2, v2, v3, v4
    v_max_f32 v2, v2, v5
    s_waitcnt lgkmcnt(8)
    v_mfma_f32_32x32x16_bf16 v[64:79], v[212:215], v[204:207], v[64:79]
    ds_read_b64_tr_b16 v[208:209], v18 offset:0
    ds_read_b64_tr_b16 v[210:211], v18 offset:2048
    buffer_load_dwordx4 v25, s[16:19], s36 offen offset:1024 nt lds
    s_add_u32 s36, s36, 16384
    v_mov_b32 v3, v2
    s_nop 1
    v_permlane32_swap_b32 v2, v3
    v_max_f32 v2, v2, v3
    v_sub_f32 v3, v2, v30
    s_waitcnt lgkmcnt(8)
    v_mfma_f32_32x32x16_bf16 v[80:95], v[216:219], v[192:195], 0
    ds_read_b64_tr_b16 v[212:213], v18 offset:4096
    ds_read_b64_tr_b16 v[214:215], v18 offset:6144
    v_cmp_lt_f32 vcc, s62, v3
    s_cbranch_vccnz L_rs1_1
    L_bk1_1:
    v_fma_f32 v160, v160, s35, -v233
    v_fma_f32 v161, v161, s35, -v233
    v_exp_f32 v160, v160
    s_waitcnt lgkmcnt(8)
    v_mfma_f32_32x32x16_bf16 v[80:95], v[220:223], v[196:199], v[80:95]
    ds_read_b64_tr_b16 v[216:217], v18 offset:8192
    ds_read_b64_tr_b16 v[218:219], v18 offset:10240
    s_add_u32 m0, s39, 65536
    s_nop 0
    buffer_load_dwordx4 v26, s[20:23], s37 offen offset:0 nt lds
    v_fma_f32 v162, v162, s35, -v233
    v_exp_f32 v161, v161
    v_add_f32 v31, v31, v160
    s_waitcnt lgkmcnt(8)
    v_mfma_f32_32x32x16_bf16 v[80:95], v[224:227], v[200:203], v[80:95]
    ds_read_b64_tr_b16 v[220:221], v18 offset:12288
    ds_read_b64_tr_b16 v[222:223], v18 offset:14336
    v_fma_f32 v163, v163, s35, -v233
    v_exp_f32 v162, v162
    v_add_f32 v31, v31, v161
    v_fma_f32 v164, v164, s35, -v233
    s_waitcnt lgkmcnt(8)
    v_mfma_f32_32x32x16_bf16 v[80:95], v[228:231], v[204:207], v[80:95]
    ds_read_b64_tr_b16 v[224:225], v19 offset:0
    ds_read_b64_tr_b16 v[226:227], v19 offset:2048
    buffer_load_dwordx4 v26, s[20:23], s37 offen offset:1024 nt lds
    s_add_u32 s37, s37, 16384
    v_exp_f32 v163, v163
    v_add_f32 v31, v31, v162
    v_fma_f32 v165, v165, s35, -v233
    v_exp_f32 v164, v164
    s_waitcnt lgkmcnt(8)
    v_mfma_f32_32x32x16_bf16 v[96:111], v[208:211], v[192:195], 0
    ds_read_b64_tr_b16 v[228:229], v19 offset:4096
    ds_read_b64_tr_b16 v[230:231], v19 offset:6144
    v_add_f32 v31, v31, v163
    v_fma_f32 v166, v166, s35, -v233
    v_exp_f32 v165, v165
    v_add_f32 v31, v31, v164
    s_waitcnt lgkmcnt(8)
    v_mfma_f32_32x32x16_bf16 v[96:111], v[212:215], v[196:199], v[96:111]
    ds_read_b64_tr_b16 v[208:209], v19 offset:8192
    ds_read_b64_tr_b16 v[210:211], v19 offset:10240
    v_fma_f32 v167, v167, s35, -v233
    v_exp_f32 v166, v166
    v_add_f32 v31, v31, v165
    v_fma_f32 v168, v168, s35, -v233
    s_waitcnt lgkmcnt(8)
    v_mfma_f32_32x32x16_bf16 v[96:111], v[216:219], v[200:203], v[96:111]
    ds_read_b64_tr_b16 v[212:213], v19 offset:12288
    ds_read_b64_tr_b16 v[214:215], v19 offset:14336
    v_exp_f32 v167, v167
    v_add_f32 v31, v31, v166
    v_fma_f32 v169, v169, s35, -v233
    v_exp_f32 v168, v168
    s_waitcnt lgkmcnt(8)
    v_mfma_f32_32x32x16_bf16 v[96:111], v[220:223], v[204:207], v[96:111]
    ds_read_b128 v[216:219], v8 offset:32768
    v_add_f32 v31, v31, v167
    v_fma_f32 v170, v170, s35, -v233
    v_exp_f32 v169, v169
    s_waitcnt lgkmcnt(7)
    v_mfma_f32_32x32x16_bf16 v[112:127], v[224:227], v[192:195], 0
    ds_read_b128 v[220:223], v9 offset:32768
    v_add_f32 v31, v31, v168
    v_fma_f32 v171, v171, s35, -v233
    v_exp_f32 v170, v170
    v_add_f32 v31, v31, v169
    v_fma_f32 v172, v172, s35, -v233
    s_waitcnt lgkmcnt(6)
    v_mfma_f32_32x32x16_bf16 v[112:127], v[228:231], v[196:199], v[112:127]
    ds_read_b128 v[224:227], v10 offset:32768
    v_exp_f32 v171, v171
    v_add_f32 v31, v31, v170
    v_fma_f32 v173, v173, s35, -v233
    v_exp_f32 v172, v172
    s_waitcnt lgkmcnt(5)
    v_mfma_f32_32x32x16_bf16 v[112:127], v[208:211], v[200:203], v[112:127]
    ds_read_b128 v[228:231], v11 offset:32768
    v_add_f32 v31, v31, v171
    v_fma_f32 v174, v174, s35, -v233
    v_exp_f32 v173, v173
    s_waitcnt lgkmcnt(4)
    v_mfma_f32_32x32x16_bf16 v[112:127], v[212:215], v[204:207], v[112:127]
    ds_read_b128 v[208:211], v12 offset:32768
    s_cmp_lg_u32 s61, 0
    s_cbranch_scc1 L_rs2_1
L_bk2_1:
    v_cvt_pk_bf16_f32 v192, v160, v161
    v_cvt_pk_bf16_f32 v193, v162, v163
    v_cvt_pk_bf16_f32 v194, v164, v165
    v_cvt_pk_bf16_f32 v195, v166, v167
    v_cvt_pk_bf16_f32 v196, v168, v169
    s_waitcnt lgkmcnt(4)
    v_mfma_f32_32x32x16_bf16 v[128:143], v[216:219], v[32:35], 0
    ds_read_b128 v[212:215], v13 offset:32768
    v_cvt_pk_bf16_f32 v197, v170, v171
    v_cvt_pk_bf16_f32 v198, v172, v173
    v_add_f32 v31, v31, v172
    v_fma_f32 v175, v175, s35, -v233
    v_exp_f32 v174, v174
    s_waitcnt lgkmcnt(4)
    v_mfma_f32_32x32x16_bf16 v[128:143], v[220:223], v[36:39], v[128:143]
    ds_read_b128 v[216:219], v14 offset:32768
    v_add_f32 v31, v31, v173
    v_fma_f32 v176, v176, s35, -v233
    v_exp_f32 v175, v175
    v_add_f32 v31, v31, v174
    s_waitcnt lgkmcnt(4)
    v_mfma_f32_32x32x16_bf16 v[128:143], v[224:227], v[40:43], v[128:143]
    ds_read_b128 v[220:223], v15 offset:32768
    v_cvt_pk_bf16_f32 v199, v174, v175
    v_fma_f32 v177, v177, s35, -v233
    v_exp_f32 v176, v176
    v_add_f32 v31, v31, v175
    s_waitcnt lgkmcnt(4)
    v_mfma_f32_32x32x16_bf16 v[128:143], v[228:231], v[44:47], v[128:143]
    ds_read_b128 v[224:227], v8 offset:40960
    v_fma_f32 v178, v178, s35, -v233
    v_exp_f32 v177, v177
    v_add_f32 v31, v31, v176
    v_cvt_pk_bf16_f32 v200, v176, v177
    s_waitcnt lgkmcnt(4)
    v_mfma_f32_32x32x16_bf16 v[128:143], v[208:211], v[48:51], v[128:143]
    ds_read_b128 v[228:231], v9 offset:40960
    v_fma_f32 v179, v179, s35, -v233
    v_exp_f32 v178, v178
    v_add_f32 v31, v31, v177
    v_fma_f32 v180, v180, s35, -v233
    v_exp_f32 v179, v179
    s_waitcnt lgkmcnt(4)
    v_mfma_f32_32x32x16_bf16 v[128:143], v[212:215], v[52:55], v[128:143]
    ds_read_b128 v[208:211], v10 offset:40960
    v_add_f32 v31, v31, v178
    v_cvt_pk_bf16_f32 v201, v178, v179
    v_fma_f32 v181, v181, s35, -v233
    v_exp_f32 v180, v180
    s_waitcnt lgkmcnt(4)
    v_mfma_f32_32x32x16_bf16 v[128:143], v[216:219], v[56:59], v[128:143]
    ds_read_b128 v[212:215], v11 offset:40960
    v_add_f32 v31, v31, v179
    v_fma_f32 v182, v182, s35, -v233
    v_exp_f32 v181, v181
    s_waitcnt lgkmcnt(4)
    v_mfma_f32_32x32x16_bf16 v[128:143], v[220:223], v[60:63], v[128:143]
    ds_read_b128 v[216:219], v12 offset:40960
    v_add_f32 v31, v31, v180
    v_cvt_pk_bf16_f32 v202, v180, v181
    v_fma_f32 v183, v183, s35, -v233
    v_exp_f32 v182, v182
    s_waitcnt lgkmcnt(4)
    v_mfma_f32_32x32x16_bf16 v[144:159], v[224:227], v[32:35], 0
    ds_read_b128 v[220:223], v13 offset:40960
    v_add_f32 v31, v31, v181
    v_fma_f32 v184, v184, s35, -v233
    v_exp_f32 v183, v183
    v_add_f32 v31, v31, v182
    v_cvt_pk_bf16_f32 v203, v182, v183
    s_waitcnt lgkmcnt(4)
    v_mfma_f32_32x32x16_bf16 v[144:159], v[228:231], v[36:39], v[144:159]
    ds_read_b128 v[224:227], v14 offset:40960
    v_fma_f32 v185, v185, s35, -v233
    v_exp_f32 v184, v184
    v_add_f32 v31, v31, v183
    v_fma_f32 v186, v186, s35, -v233
    s_waitcnt lgkmcnt(4)
    v_mfma_f32_32x32x16_bf16 v[144:159], v[208:211], v[40:43], v[144:159]
    ds_read_b128 v[228:231], v15 offset:40960
    v_exp_f32 v185, v185
    v_add_f32 v31, v31, v184
    v_cvt_pk_bf16_f32 v204, v184, v185
    v_fma_f32 v187, v187, s35, -v233
    s_waitcnt lgkmcnt(4)
    v_mfma_f32_32x32x16_bf16 v[144:159], v[212:215], v[44:47], v[144:159]
    ds_read_b64_tr_b16 v[208:209], v16 offset:16384
    ds_read_b64_tr_b16 v[210:211], v16 offset:18432
    v_exp_f32 v186, v186
    v_add_f32 v31, v31, v185
    v_fma_f32 v188, v188, s35, -v233
    v_exp_f32 v187, v187
    s_waitcnt lgkmcnt(5)
    v_mfma_f32_32x32x16_bf16 v[144:159], v[216:219], v[48:51], v[144:159]
    ds_read_b64_tr_b16 v[212:213], v16 offset:20480
    ds_read_b64_tr_b16 v[214:215], v16 offset:22528
    v_add_f32 v31, v31, v186
    v_cvt_pk_bf16_f32 v205, v186, v187
    v_fma_f32 v189, v189, s35, -v233
    v_exp_f32 v188, v188
    s_waitcnt lgkmcnt(6)
    v_mfma_f32_32x32x16_bf16 v[144:159], v[220:223], v[52:55], v[144:159]
    ds_read_b64_tr_b16 v[216:217], v16 offset:24576
    ds_read_b64_tr_b16 v[218:219], v16 offset:26624
    v_add_f32 v31, v31, v187
    v_fma_f32 v190, v190, s35, -v233
    v_exp_f32 v189, v189
    v_add_f32 v31, v31, v188
    s_waitcnt lgkmcnt(7)
    v_mfma_f32_32x32x16_bf16 v[144:159], v[224:227], v[56:59], v[144:159]
    ds_read_b64_tr_b16 v[220:221], v16 offset:28672
    ds_read_b64_tr_b16 v[222:223], v16 offset:30720
    v_cvt_pk_bf16_f32 v206, v188, v189
    v_fma_f32 v191, v191, s35, -v233
    v_exp_f32 v190, v190
    v_add_f32 v31, v31, v189
    s_waitcnt lgkmcnt(8)
    v_mfma_f32_32x32x16_bf16 v[144:159], v[228:231], v[60:63], v[144:159]
    ds_read_b64_tr_b16 v[224:225], v17 offset:16384
    ds_read_b64_tr_b16 v[226:227], v17 offset:18432
    v_exp_f32 v191, v191
    v_add_f32 v31, v31, v190
    v_cvt_pk_bf16_f32 v207, v190, v191
    v_add_f32 v31, v31, v191
    s_nop 0
    s_waitcnt vmcnt(8)
    s_barrier
    s_waitcnt lgkmcnt(8)
    v_mfma_f32_32x32x16_bf16 v[64:79], v[208:211], v[192:195], v[64:79]
    ds_read_b64_tr_b16 v[228:229], v17 offset:20480
    ds_read_b64_tr_b16 v[230:231], v17 offset:22528
    v_max3_f32 v2, v128, v129, v130
    v_max3_f32 v3, v131, v132, v133
    v_max3_f32 v4, v134, v135, v136
    v_max3_f32 v5, v137, v138, v139
    v_max3_f32 v2, v2, v140, v141
    v_max3_f32 v3, v3, v142, v143
    s_waitcnt lgkmcnt(8)
    v_mfma_f32_32x32x16_bf16 v[64:79], v[212:215], v[196:199], v[64:79]
    ds_read_b64_tr_b16 v[208:209], v17 offset:24576
    ds_read_b64_tr_b16 v[210:211], v17 offset:26624
    s_add_u32 m0, s38, 32768
    s_nop 0
    buffer_load_dwordx4 v24, s[16:19], s36 offen offset:0 nt lds
    v_max3_f32 v4, v4, v144, v145
    v_max3_f32 v5, v5, v146, v147
    v_max3_f32 v2, v2, v148, v149
    v_max3_f32 v3, v3, v150, v151
    v_max3_f32 v4, v4, v152, v153
    s_waitcnt lgkmcnt(8)
    v_mfma_f32_32x32x16_bf16 v[64:79], v[216:219], v[200:203], v[64:79]
    ds_read_b64_tr_b16 v[212:213], v17 offset:28672
    ds_read_b64_tr_b16 v[214:215], v17 offset:30720
    v_max3_f32 v5, v5, v154, v155
    v_max3_f32 v2, v2, v156, v157
    v_max3_f32 v3, v3, v158, v159
    v_max3_f32 v2, v2, v3, v4
    v_max_f32 v2, v2, v5
    s_waitcnt lgkmcnt(8)
    v_mfma_f32_32x32x16_bf16 v[64:79], v[220:223], v[204:207], v[64:79]
    ds_read_b64_tr_b16 v[216:217], v18 offset:16384
    ds_read_b64_tr_b16 v[218:219], v18 offset:18432
    buffer_load_dwordx4 v25, s[16:19], s36 offen offset:1024 nt lds
    s_add_u32 s36, s36, 16384
    v_mov_b32 v3, v2
    s_nop 1
    v_permlane32_swap_b32 v2, v3
    v_max_f32 v2, v2, v3
    v_sub_f32 v3, v2, v30
    s_waitcnt lgkmcnt(8)
    v_mfma_f32_32x32x16_bf16 v[80:95], v[224:227], v[192:195], v[80:95]
    ds_read_b64_tr_b16 v[220:221], v18 offset:20480
    ds_read_b64_tr_b16 v[222:223], v18 offset:22528
    v_cmp_lt_f32 vcc, s62, v3
    s_cbranch_vccnz L_rs1_2
    L_bk1_2:
    v_fma_f32 v128, v128, s35, -v233
    v_fma_f32 v129, v129, s35, -v233
    v_exp_f32 v128, v128
    s_waitcnt lgkmcnt(8)
    v_mfma_f32_32x32x16_bf16 v[80:95], v[228:231], v[196:199], v[80:95]
    ds_read_b64_tr_b16 v[224:225], v18 offset:24576
    ds_read_b64_tr_b16 v[226:227], v18 offset:26624
    s_add_u32 m0, s39, 0
    s_nop 0
    buffer_load_dwordx4 v26, s[20:23], s37 offen offset:0 nt lds
    v_fma_f32 v130, v130, s35, -v233
    v_exp_f32 v129, v129
    v_add_f32 v31, v31, v128
    s_waitcnt lgkmcnt(8)
    v_mfma_f32_32x32x16_bf16 v[80:95], v[208:211], v[200:203], v[80:95]
    ds_read_b64_tr_b16 v[228:229], v18 offset:28672
    ds_read_b64_tr_b16 v[230:231], v18 offset:30720
    v_fma_f32 v131, v131, s35, -v233
    v_exp_f32 v130, v130
    v_add_f32 v31, v31, v129
    v_fma_f32 v132, v132, s35, -v233
    s_waitcnt lgkmcnt(8)
    v_mfma_f32_32x32x16_bf16 v[80:95], v[212:215], v[204:207], v[80:95]
    ds_read_b64_tr_b16 v[208:209], v19 offset:16384
    ds_read_b64_tr_b16 v[210:211], v19 offset:18432
    buffer_load_dwordx4 v26, s[20:23], s37 offen offset:1024 nt lds
    s_add_u32 s37, s37, 16384
    v_exp_f32 v131, v131
    v_add_f32 v31, v31, v130
    v_fma_f32 v133, v133, s35, -v233
    v_exp_f32 v132, v132
    s_waitcnt lgkmcnt(8)
    v_mfma_f32_32x32x16_bf16 v[96:111], v[216:219], v[192:195], v[96:111]
    ds_read_b64_tr_b16 v[212:213], v19 offset:20480
    ds_read_b64_tr_b16 v[214:215], v19 offset:22528
    v_add_f32 v31, v31, v131
    v_fma_f32 v134, v134, s35, -v233
    v_exp_f32 v133, v133
    v_add_f32 v31, v31, v132
    s_waitcnt lgkmcnt(8)
    v_mfma_f32_32x32x16_bf16 v[96:111], v[220:223], v[196:199], v[96:111]
    ds_read_b64_tr_b16 v[216:217], v19 offset:24576
    ds_read_b64_tr_b16 v[218:219], v19 offset:26624
    v_fma_f32 v135, v135, s35, -v233
    v_exp_f32 v134, v134
    v_add_f32 v31, v31, v133
    v_fma_f32 v136, v136, s35, -v233
    s_waitcnt lgkmcnt(8)
    v_mfma_f32_32x32x16_bf16 v[96:111], v[224:227], v[200:203], v[96:111]
    ds_read_b64_tr_b16 v[220:221], v19 offset:28672
    ds_read_b64_tr_b16 v[222:223], v19 offset:30720
    v_exp_f32 v135, v135
    v_add_f32 v31, v31, v134
    v_fma_f32 v137, v137, s35, -v233
    v_exp_f32 v136, v136
    s_waitcnt lgkmcnt(8)
    v_mfma_f32_32x32x16_bf16 v[96:111], v[228:231], v[204:207], v[96:111]
    ds_read_b128 v[224:227], v8 offset:49152
    v_add_f32 v31, v31, v135
    v_fma_f32 v138, v138, s35, -v233
    v_exp_f32 v137, v137
    s_waitcnt lgkmcnt(7)
    v_mfma_f32_32x32x16_bf16 v[112:127], v[208:211], v[192:195], v[112:127]
    ds_read_b128 v[228:231], v9 offset:49152
    v_add_f32 v31, v31, v136
    v_fma_f32 v139, v139, s35, -v233
    v_exp_f32 v138, v138
    v_add_f32 v31, v31, v137
    v_fma_f32 v140, v140, s35, -v233
    s_waitcnt lgkmcnt(6)
    v_mfma_f32_32x32x16_bf16 v[112:127], v[212:215], v[196:199], v[112:127]
    ds_read_b128 v[208:211], v10 offset:49152
    v_exp_f32 v139, v139
    v_add_f32 v31, v31, v138
    v_fma_f32 v141, v141, s35, -v233
    v_exp_f32 v140, v140
    s_waitcnt lgkmcnt(5)
    v_mfma_f32_32x32x16_bf16 v[112:127], v[216:219], v[200:203], v[112:127]
    ds_read_b128 v[212:215], v11 offset:49152
    v_add_f32 v31, v31, v139
    v_fma_f32 v142, v142, s35, -v233
    v_exp_f32 v141, v141
    s_waitcnt lgkmcnt(4)
    v_mfma_f32_32x32x16_bf16 v[112:127], v[220:223], v[204:207], v[112:127]
    ds_read_b128 v[216:219], v12 offset:49152
    s_cmp_lg_u32 s61, 0
    s_cbranch_scc1 L_rs2_2
L_bk2_2:
    v_cvt_pk_bf16_f32 v192, v128, v129
    v_cvt_pk_bf16_f32 v193, v130, v131
    v_cvt_pk_bf16_f32 v194, v132, v133
    v_cvt_pk_bf16_f32 v195, v134, v135
    v_cvt_pk_bf16_f32 v196, v136, v137
    s_waitcnt lgkmcnt(4)
    v_mfma_f32_32x32x16_bf16 v[160:175], v[224:227], v[32:35], 0
    ds_read_b128 v[220:223], v13 offset:49152
    v_cvt_pk_bf16_f32 v197, v138, v139
    v_cvt_pk_bf16_f32 v198, v140, v141
    v_add_f32 v31, v31, v140
    v_fma_f32 v143, v143, s35, -v233
    v_exp_f32 v142, v142
    s_waitcnt lgkmcnt(4)
    v_mfma_f32_32x32x16_bf16 v[160:175], v[228:231], v[36:39], v[160:175]
    ds_read_b128 v[224:227], v14 offset:49152
    v_add_f32 v31, v31, v141
    v_fma_f32 v144, v144, s35, -v233
    v_exp_f32 v143, v143
    v_add_f32 v31, v31, v142
    s_waitcnt lgkmcnt(4)
    v_mfma_f32_32x32x16_bf16 v[160:175], v[208:211], v[40:43], v[160:175]
    ds_read_b128 v[228:231], v15 offset:49152
    v_cvt_pk_bf16_f32 v199, v142, v143
    v_fma_f32 v145, v145, s35, -v233
    v_exp_f32 v144, v144
    v_add_f32 v31, v31, v143
    s_waitcnt lgkmcnt(4)
    v_mfma_f32_32x32x16_bf16 v[160:175], v[212:215], v[44:47], v[160:175]
    ds_read_b128 v[208:211], v8 offset:57344
    v_fma_f32 v146, v146, s35, -v233
    v_exp_f32 v145, v145
    v_add_f32 v31, v31, v144
    v_cvt_pk_bf16_f32 v200, v144, v145
    s_waitcnt lgkmcnt(4)
    v_mfma_f32_32x32x16_bf16 v[160:175], v[216:219], v[48:51], v[160:175]
    ds_read_b128 v[212:215], v9 offset:57344
    v_fma_f32 v147, v147, s35, -v233
    v_exp_f32 v146, v146
    v_add_f32 v31, v31, v145
    v_fma_f32 v148, v148, s35, -v233
    v_exp_f32 v147, v147
    s_waitcnt lgkmcnt(4)
    v_mfma_f32_32x32x16_bf16 v[160:175], v[220:223], v[52:55], v[160:175]
    ds_read_b128 v[216:219], v10 offset:57344
    v_add_f32 v31, v31, v146
    v_cvt_pk_bf16_f32 v201, v146, v147
    v_fma_f32 v149, v149, s35, -v233
    v_exp_f32 v148, v148
    s_waitcnt lgkmcnt(4)
    v_mfma_f32_32x32x16_bf16 v[160:175], v[224:227], v[56:59], v[160:175]
    ds_read_b128 v[220:223], v11 offset:57344
    v_add_f32 v31, v31, v147
    v_fma_f32 v150, v150, s35, -v233
    v_exp_f32 v149, v149
    s_waitcnt lgkmcnt(4)
    v_mfma_f32_32x32x16_bf16 v[160:175], v[228:231], v[60:63], v[160:175]
    ds_read_b128 v[224:227], v12 offset:57344
    v_add_f32 v31, v31, v148
    v_cvt_pk_bf16_f32 v202, v148, v149
    v_fma_f32 v151, v151, s35, -v233
    v_exp_f32 v150, v150
    s_waitcnt lgkmcnt(4)
    v_mfma_f32_32x32x16_bf16 v[176:191], v[208:211], v[32:35], 0
    ds_read_b128 v[228:231], v13 offset:57344
    v_add_f32 v31, v31, v149
    v_fma_f32 v152, v152, s35, -v233
    v_exp_f32 v151, v151
    v_add_f32 v31, v31, v150
    v_cvt_pk_bf16_f32 v203, v150, v151
    s_waitcnt lgkmcnt(4)
    v_mfma_f32_32x32x16_bf16 v[176:191], v[212:215], v[36:39], v[176:191]
    ds_read_b128 v[208:211], v14 offset:57344
    v_fma_f32 v153, v153, s35, -v233
    v_exp_f32 v152, v152
    v_add_f32 v31, v31, v151
    v_fma_f32 v154, v154, s35, -v233
    s_waitcnt lgkmcnt(4)
    v_mfma_f32_32x32x16_bf16 v[176:191], v[216:219], v[40:43], v[176:191]
    ds_read_b128 v[212:215], v15 offset:57344
    v_exp_f32 v153, v153
    v_add_f32 v31, v31, v152
    v_cvt_pk_bf16_f32 v204, v152, v153
    v_fma_f32 v155, v155, s35, -v233
    s_waitcnt lgkmcnt(4)
    v_mfma_f32_32x32x16_bf16 v[176:191], v[220:223], v[44:47], v[176:191]
    ds_read_b64_tr_b16 v[216:217], v16 offset:32768
    ds_read_b64_tr_b16 v[218:219], v16 offset:34816
    v_exp_f32 v154, v154
    v_add_f32 v31, v31, v153
    v_fma_f32 v156, v156, s35, -v233
    v_exp_f32 v155, v155
    s_waitcnt lgkmcnt(5)
    v_mfma_f32_32x32x16_bf16 v[176:191], v[224:227], v[48:51], v[176:191]
    ds_read_b64_tr_b16 v[220:221], v16 offset:36864
    ds_read_b64_tr_b16 v[222:223], v16 offset:38912
    v_add_f32 v31, v31, v154
    v_cvt_pk_bf16_f32 v205, v154, v155
    v_fma_f32 v157, v157, s35, -v233
    v_exp_f32 v156, v156
    s_waitcnt lgkmcnt(6)
    v_mfma_f32_32x32x16_bf16 v[176:191], v[228:231], v[52:55], v[176:191]
    ds_read_b64_tr_b16 v[224:225], v16 offset:40960
    ds_read_b64_tr_b16 v[226:227], v16 offset:43008
    v_add_f32 v31, v31, v155
    v_fma_f32 v158, v158, s35, -v233
    v_exp_f32 v157, v157
    v_add_f32 v31, v31, v156
    s_waitcnt lgkmcnt(7)
    v_mfma_f32_32x32x16_bf16 v[176:191], v[208:211], v[56:59], v[176:191]
    ds_read_b64_tr_b16 v[228:229], v16 offset:45056
    ds_read_b64_tr_b16 v[230:231], v16 offset:47104
    v_cvt_pk_bf16_f32 v206, v156, v157
    v_fma_f32 v159, v159, s35, -v233
    v_exp_f32 v158, v158
    v_add_f32 v31, v31, v157
    s_waitcnt lgkmcnt(8)
    v_mfma_f32_32x32x16_bf16 v[176:191], v[212:215], v[60:63], v[176:191]
    ds_read_b64_tr_b16 v[208:209], v17 offset:32768
    ds_read_b64_tr_b16 v[210:211], v17 offset:34816
    v_exp_f32 v159, v159
    v_add_f32 v31, v31, v158
    v_cvt_pk_bf16_f32 v207, v158, v159
    v_add_f32 v31, v31, v159
    s_nop 0
    s_waitcnt vmcnt(8)
    s_barrier
    s_waitcnt lgkmcnt(8)
    v_mfma_f32_32x32x16_bf16 v[64:79], v[216:219], v[192:195], v[64:79]
    ds_read_b64_tr_b16 v[212:213], v17 offset:36864
    ds_read_b64_tr_b16 v[214:215], v17 offset:38912
    v_max3_f32 v2, v160, v161, v162
    v_max3_f32 v3, v163, v164, v165
    v_max3_f32 v4, v166, v167, v168
    v_max3_f32 v5, v169, v170, v171
    v_max3_f32 v2, v2, v172, v173
    v_max3_f32 v3, v3, v174, v175
    s_waitcnt lgkmcnt(8)
    v_mfma_f32_32x32x16_bf16 v[64:79], v[220:223], v[196:199], v[64:79]
    ds_read_b64_tr_b16 v[216:217], v17 offset:40960
    ds_read_b64_tr_b16 v[218:219], v17 offset:43008
    s_add_u32 m0, s38, 49152
    s_nop 0
    buffer_load_dwordx4 v24, s[16:19], s36 offen offset:0 nt lds
    v_max3_f32 v4, v4, v176, v177
    v_max3_f32 v5, v5, v178, v179
    v_max3_f32 v2, v2, v180, v181
    v_max3_f32 v3, v3, v182, v183
    v_max3_f32 v4, v4, v184, v185
    s_waitcnt lgkmcnt(8)
    v_mfma_f32_32x32x16_bf16 v[64:79], v[224:227], v[200:203], v[64:79]
    ds_read_b64_tr_b16 v[220:221], v17 offset:45056
    ds_read_b64_tr_b16 v[222:223], v17 offset:47104
    v_max3_f32 v5, v5, v186, v187
    v_max3_f32 v2, v2, v188, v189
    v_max3_f32 v3, v3, v190, v191
    v_max3_f32 v2, v2, v3, v4
    v_max_f32 v2, v2, v5
    s_waitcnt lgkmcnt(8)
    v_mfma_f32_32x32x16_bf16 v[64:79], v[228:231], v[204:207], v[64:79]
    ds_read_b64_tr_b16 v[224:225], v18 offset:32768
    ds_read_b64_tr_b16 v[226:227], v18 offset:34816
    buffer_load_dwordx4 v25, s[16:19], s36 offen offset:1024 nt lds
    s_add_u32 s36, s36, 16384
    v_mov_b32 v3, v2
    s_nop 1
    v_permlane32_swap_b32 v2, v3
    v_max_f32 v2, v2, v3
    v_sub_f32 v3, v2, v30
    s_waitcnt lgkmcnt(8)
    v_mfma_f32_32x32x16_bf16 v[80:95], v[208:211], v[192:195], v[80:95]
    ds_read_b64_tr_b16 v[228:229], v18 offset:36864
    ds_read_b64_tr_b16 v[230:231], v18 offset:38912
    v_cmp_lt_f32 vcc, s62, v3
    s_cbranch_vccnz L_rs1_3
    L_bk1_3:
    v_fma_f32 v160, v160, s35, -v233
    v_fma_f32 v161, v161, s35, -v233
    v_exp_f32 v160, v160
    s_waitcnt lgkmcnt(8)
    v_mfma_f32_32x32x16_bf16 v[80:95], v[212:215], v[196:199], v[80:95]
    ds_read_b64_tr_b16 v[208:209], v18 offset:40960
    ds_read_b64_tr_b16 v[210:211], v18 offset:43008
    s_add_u32 m0, s39, 16384
    s_nop 0
    buffer_load_dwordx4 v26, s[20:23], s37 offen offset:0 nt lds
    v_fma_f32 v162, v162, s35, -v233
    v_exp_f32 v161, v161
    v_add_f32 v31, v31, v160
    s_waitcnt lgkmcnt(8)
    v_mfma_f32_32x32x16_bf16 v[80:95], v[216:219], v[200:203], v[80:95]
    ds_read_b64_tr_b16 v[212:213], v18 offset:45056
    ds_read_b64_tr_b16 v[214:215], v18 offset:47104
    v_fma_f32 v163, v163, s35, -v233
    v_exp_f32 v162, v162
    v_add_f32 v31, v31, v161
    v_fma_f32 v164, v164, s35, -v233
    s_waitcnt lgkmcnt(8)
    v_mfma_f32_32x32x16_bf16 v[80:95], v[220:223], v[204:207], v[80:95]
    ds_read_b64_tr_b16 v[216:217], v19 offset:32768
    ds_read_b64_tr_b16 v[218:219], v19 offset:34816
    buffer_load_dwordx4 v26, s[20:23], s37 offen offset:1024 nt lds
    s_add_u32 s37, s37, 16384
    v_exp_f32 v163, v163
    v_add_f32 v31, v31, v162
    v_fma_f32 v165, v165, s35, -v233
    v_exp_f32 v164, v164
    s_waitcnt lgkmcnt(8)
    v_mfma_f32_32x32x16_bf16 v[96:111], v[224:227], v[192:195], v[96:111]
    ds_read_b64_tr_b16 v[220:221], v19 offset:36864
    ds_read_b64_tr_b16 v[222:223], v19 offset:38912
    v_add_f32 v31, v31, v163
    v_fma_f32 v166, v166, s35, -v233
    v_exp_f32 v165, v165
    v_add_f32 v31, v31, v164
    s_waitcnt lgkmcnt(8)
    v_mfma_f32_32x32x16_bf16 v[96:111], v[228:231], v[196:199], v[96:111]
    ds_read_b64_tr_b16 v[224:225], v19 offset:40960
    ds_read_b64_tr_b16 v[226:227], v19 offset:43008
    v_fma_f32 v167, v167, s35, -v233
    v_exp_f32 v166, v166
    v_add_f32 v31, v31, v165
    v_fma_f32 v168, v168, s35, -v233
    s_waitcnt lgkmcnt(8)
    v_mfma_f32_32x32x16_bf16 v[96:111], v[208:211], v[200:203], v[96:111]
    ds_read_b64_tr_b16 v[228:229], v19 offset:45056
    ds_read_b64_tr_b16 v[230:231], v19 offset:47104
    v_exp_f32 v167, v167
    v_add_f32 v31, v31, v166
    v_fma_f32 v169, v169, s35, -v233
    v_exp_f32 v168, v168
    s_waitcnt lgkmcnt(8)
    v_mfma_f32_32x32x16_bf16 v[96:111], v[212:215], v[204:207], v[96:111]
    ds_read_b128 v[208:211], v8 offset:0
    v_add_f32 v31, v31, v167
    v_fma_f32 v170, v170, s35, -v233
    v_exp_f32 v169, v169
    s_waitcnt lgkmcnt(7)
    v_mfma_f32_32x32x16_bf16 v[112:127], v[216:219], v[192:195], v[112:127]
    ds_read_b128 v[212:215], v9 offset:0
    v_add_f32 v31, v31, v168
    v_fma_f32 v171, v171, s35, -v233
    v_exp_f32 v170, v170
    v_add_f32 v31, v31, v169
    v_fma_f32 v172, v172, s35, -v233
    s_waitcnt lgkmcnt(6)
    v_mfma_f32_32x32x16_bf16 v[112:127], v[220:223], v[196:199], v[112:127]
    ds_read_b128 v[216:219], v10 offset:0
    v_exp_f32 v171, v171
    v_add_f32 v31, v31, v170
    v_fma_f32 v173, v173, s35, -v233
    v_exp_f32 v172, v172
    s_waitcnt lgkmcnt(5)
    v_mfma_f32_32x32x16_bf16 v[112:127], v[224:227], v[200:203], v[112:127]
    ds_read_b128 v[220:223], v11 offset:0
    v_add_f32 v31, v31, v171
    v_fma_f32 v174, v174, s35, -v233
    v_exp_f32 v173, v173
    s_waitcnt lgkmcnt(4)
    v_mfma_f32_32x32x16_bf16 v[112:127], v[228:231], v[204:207], v[112:127]
    ds_read_b128 v[224:227], v12 offset:0
    s_cmp_lg_u32 s61, 0
    s_cbranch_scc1 L_rs2_3
L_bk2_3:
    v_cvt_pk_bf16_f32 v192, v160, v161
    v_cvt_pk_bf16_f32 v193, v162, v163
    v_cvt_pk_bf16_f32 v194, v164, v165
    v_cvt_pk_bf16_f32 v195, v166, v167
    v_cvt_pk_bf16_f32 v196, v168, v169
    s_waitcnt lgkmcnt(4)
    v_mfma_f32_32x32x16_bf16 v[128:143], v[208:211], v[32:35], 0
    ds_read_b128 v[228:231], v13 offset:0
    v_cvt_pk_bf16_f32 v197, v170, v171
    v_cvt_pk_bf16_f32 v198, v172, v173
    v_add_f32 v31, v31, v172
    v_fma_f32 v175, v175, s35, -v233
    v_exp_f32 v174, v174
    s_waitcnt lgkmcnt(4)
    v_mfma_f32_32x32x16_bf16 v[128:143], v[212:215], v[36:39], v[128:143]
    ds_read_b128 v[208:211], v14 offset:0
    v_add_f32 v31, v31, v173
    v_fma_f32 v176, v176, s35, -v233
    v_exp_f32 v175, v175
    v_add_f32 v31, v31, v174
    s_waitcnt lgkmcnt(4)
    v_mfma_f32_32x32x16_bf16 v[128:143], v[216:219], v[40:43], v[128:143]
    ds_read_b128 v[212:215], v15 offset:0
    v_cvt_pk_bf16_f32 v199, v174, v175
    v_fma_f32 v177, v177, s35, -v233
    v_exp_f32 v176, v176
    v_add_f32 v31, v31, v175
    s_waitcnt lgkmcnt(4)
    v_mfma_f32_32x32x16_bf16 v[128:143], v[220:223], v[44:47], v[128:143]
    ds_read_b128 v[216:219], v8 offset:8192
    v_fma_f32 v178, v178, s35, -v233
    v_exp_f32 v177, v177
    v_add_f32 v31, v31, v176
    v_cvt_pk_bf16_f32 v200, v176, v177
    s_waitcnt lgkmcnt(4)
    v_mfma_f32_32x32x16_bf16 v[128:143], v[224:227], v[48:51], v[128:143]
    ds_read_b128 v[220:223], v9 offset:8192
    v_fma_f32 v179, v179, s35, -v233
    v_exp_f32 v178, v178
    v_add_f32 v31, v31, v177
    v_fma_f32 v180, v180, s35, -v233
    v_exp_f32 v179, v179
    s_waitcnt lgkmcnt(4)
    v_mfma_f32_32x32x16_bf16 v[128:143], v[228:231], v[52:55], v[128:143]
    ds_read_b128 v[224:227], v10 offset:8192
    v_add_f32 v31, v31, v178
    v_cvt_pk_bf16_f32 v201, v178, v179
    v_fma_f32 v181, v181, s35, -v233
    v_exp_f32 v180, v180
    s_waitcnt lgkmcnt(4)
    v_mfma_f32_32x32x16_bf16 v[128:143], v[208:211], v[56:59], v[128:143]
    ds_read_b128 v[228:231], v11 offset:8192
    v_add_f32 v31, v31, v179
    v_fma_f32 v182, v182, s35, -v233
    v_exp_f32 v181, v181
    s_waitcnt lgkmcnt(4)
    v_mfma_f32_32x32x16_bf16 v[128:143], v[212:215], v[60:63], v[128:143]
    ds_read_b128 v[208:211], v12 offset:8192
    v_add_f32 v31, v31, v180
    v_cvt_pk_bf16_f32 v202, v180, v181
    v_fma_f32 v183, v183, s35, -v233
    v_exp_f32 v182, v182
    s_waitcnt lgkmcnt(4)
    v_mfma_f32_32x32x16_bf16 v[144:159], v[216:219], v[32:35], 0
    ds_read_b128 v[212:215], v13 offset:8192
    v_add_f32 v31, v31, v181
    v_fma_f32 v184, v184, s35, -v233
    v_exp_f32 v183, v183
    v_add_f32 v31, v31, v182
    v_cvt_pk_bf16_f32 v203, v182, v183
    s_waitcnt lgkmcnt(4)
    v_mfma_f32_32x32x16_bf16 v[144:159], v[220:223], v[36:39], v[144:159]
    ds_read_b128 v[216:219], v14 offset:8192
    v_fma_f32 v185, v185, s35, -v233
    v_exp_f32 v184, v184
    v_add_f32 v31, v31, v183
    v_fma_f32 v186, v186, s35, -v233
    s_waitcnt lgkmcnt(4)
    v_mfma_f32_32x32x16_bf16 v[144:159], v[224:227], v[40:43], v[144:159]
    ds_read_b128 v[220:223], v15 offset:8192
    v_exp_f32 v185, v185
    v_add_f32 v31, v31, v184
    v_cvt_pk_bf16_f32 v204, v184, v185
    v_fma_f32 v187, v187, s35, -v233
    s_waitcnt lgkmcnt(4)
    v_mfma_f32_32x32x16_bf16 v[144:159], v[228:231], v[44:47], v[144:159]
    ds_read_b64_tr_b16 v[224:225], v16 offset:49152
    ds_read_b64_tr_b16 v[226:227], v16 offset:51200
    v_exp_f32 v186, v186
    v_add_f32 v31, v31, v185
    v_fma_f32 v188, v188, s35, -v233
    v_exp_f32 v187, v187
    s_waitcnt lgkmcnt(5)
    v_mfma_f32_32x32x16_bf16 v[144:159], v[208:211], v[48:51], v[144:159]
    ds_read_b64_tr_b16 v[228:229], v16 offset:53248
    ds_read_b64_tr_b16 v[230:231], v16 offset:55296
    v_add_f32 v31, v31, v186
    v_cvt_pk_bf16_f32 v205, v186, v187
    v_fma_f32 v189, v189, s35, -v233
    v_exp_f32 v188, v188
    s_waitcnt lgkmcnt(6)
    v_mfma_f32_32x32x16_bf16 v[144:159], v[212:215], v[52:55], v[144:159]
    ds_read_b64_tr_b16 v[208:209], v16 offset:57344
    ds_read_b64_tr_b16 v[210:211], v16 offset:59392
    v_add_f32 v31, v31, v187
    v_fma_f32 v190, v190, s35, -v233
    v_exp_f32 v189, v189
    v_add_f32 v31, v31, v188
    s_waitcnt lgkmcnt(7)
    v_mfma_f32_32x32x16_bf16 v[144:159], v[216:219], v[56:59], v[144:159]
    ds_read_b64_tr_b16 v[212:213], v16 offset:61440
    ds_read_b64_tr_b16 v[214:215], v16 offset:63488
    v_cvt_pk_bf16_f32 v206, v188, v189
    v_fma_f32 v191, v191, s35, -v233
    v_exp_f32 v190, v190
    v_add_f32 v31, v31, v189
    s_waitcnt lgkmcnt(8)
    v_mfma_f32_32x32x16_bf16 v[144:159], v[220:223], v[60:63], v[144:159]
    ds_read_b64_tr_b16 v[216:217], v17 offset:49152
    ds_read_b64_tr_b16 v[218:219], v17 offset:51200
    v_exp_f32 v191, v191
    v_add_f32 v31, v31, v190
    v_cvt_pk_bf16_f32 v207, v190, v191
    v_add_f32 v31, v31, v191
    s_nop 0
    s_waitcnt vmcnt(8)
    s_barrier
    s_waitcnt lgkmcnt(8)
    v_mfma_f32_32x32x16_bf16 v[64:79], v[224:227], v[192:195], v[64:79]
    ds_read_b64_tr_b16 v[220:221], v17 offset:53248
    ds_read_b64_tr_b16 v[222:223], v17 offset:55296
    v_max3_f32 v2, v128, v129, v130
    v_max3_f32 v3, v131, v132, v133
    v_max3_f32 v4, v134, v135, v136
    v_max3_f32 v5, v137, v138, v139
    v_max3_f32 v2, v2, v140, v141
    v_max3_f32 v3, v3, v142, v143
    s_waitcnt lgkmcnt(8)
    v_mfma_f32_32x32x16_bf16 v[64:79], v[228:231], v[196:199], v[64:79]
    ds_read_b64_tr_b16 v[224:225], v17 offset:57344
    ds_read_b64_tr_b16 v[226:227], v17 offset:59392
    s_add_u32 m0, s38, 0
    s_nop 0
    buffer_load_dwordx4 v24, s[16:19], s36 offen offset:0 nt lds
    v_max3_f32 v4, v4, v144, v145
    v_max3_f32 v5, v5, v146, v147
    v_max3_f32 v2, v2, v148, v149
    v_max3_f32 v3, v3, v150, v151
    v_max3_f32 v4, v4, v152, v153
    s_waitcnt lgkmcnt(8)
    v_mfma_f32_32x32x16_bf16 v[64:79], v[208:211], v[200:203], v[64:79]
    ds_read_b64_tr_b16 v[228:229], v17 offset:61440
    ds_read_b64_tr_b16 v[230:231], v17 offset:63488
    v_max3_f32 v5, v5, v154, v155
    v_max3_f32 v2, v2, v156, v157
    v_max3_f32 v3, v3, v158, v159
    v_max3_f32 v2, v2, v3, v4
    v_max_f32 v2, v2, v5
    s_waitcnt lgkmcnt(8)
    v_mfma_f32_32x32x16_bf16 v[64:79], v[212:215], v[204:207], v[64:79]
    ds_read_b64_tr_b16 v[208:209], v18 offset:49152
    ds_read_b64_tr_b16 v[210:211], v18 offset:51200
    buffer_load_dwordx4 v25, s[16:19], s36 offen offset:1024 nt lds
    s_add_u32 s36, s36, 16384
    v_mov_b32 v3, v2
    s_nop 1
    v_permlane32_swap_b32 v2, v3
    v_max_f32 v2, v2, v3
    v_sub_f32 v3, v2, v30
    s_waitcnt lgkmcnt(8)
    v_mfma_f32_32x32x16_bf16 v[80:95], v[216:219], v[192:195], v[80:95]
    ds_read_b64_tr_b16 v[212:213], v18 offset:53248
    ds_read_b64_tr_b16 v[214:215], v18 offset:55296
    v_cmp_lt_f32 vcc, s62, v3
    s_cbranch_vccnz L_rs1_4
    L_bk1_4:
    v_fma_f32 v128, v128, s35, -v233
    v_fma_f32 v129, v129, s35, -v233
    v_exp_f32 v128, v128
    s_waitcnt lgkmcnt(8)
    v_mfma_f32_32x32x16_bf16 v[80:95], v[220:223], v[196:199], v[80:95]
    ds_read_b64_tr_b16 v[216:217], v18 offset:57344
    ds_read_b64_tr_b16 v[218:219], v18 offset:59392
    s_add_u32 m0, s39, 32768
    s_nop 0
    buffer_load_dwordx4 v26, s[20:23], s37 offen offset:0 nt lds
    v_fma_f32 v130, v130, s35, -v233
    v_exp_f32 v129, v129
    v_add_f32 v31, v31, v128
    s_waitcnt lgkmcnt(8)
    v_mfma_f32_32x32x16_bf16 v[80:95], v[224:227], v[200:203], v[80:95]
    ds_read_b64_tr_b16 v[220:221], v18 offset:61440
    ds_read_b64_tr_b16 v[222:223], v18 offset:63488
    v_fma_f32 v131, v131, s35, -v233
    v_exp_f32 v130, v130
    v_add_f32 v31, v31, v129
    v_fma_f32 v132, v132, s35, -v233
    s_waitcnt lgkmcnt(8)
    v_mfma_f32_32x32x16_bf16 v[80:95], v[228:231], v[204:207], v[80:95]
    ds_read_b64_tr_b16 v[224:225], v19 offset:49152
    ds_read_b64_tr_b16 v[226:227], v19 offset:51200
    buffer_load_dwordx4 v26, s[20:23], s37 offen offset:1024 nt lds
    s_add_u32 s37, s37, 16384
    v_exp_f32 v131, v131
    v_add_f32 v31, v31, v130
    v_fma_f32 v133, v133, s35, -v233
    v_exp_f32 v132, v132
    s_waitcnt lgkmcnt(8)
    v_mfma_f32_32x32x16_bf16 v[96:111], v[208:211], v[192:195], v[96:111]
    ds_read_b64_tr_b16 v[228:229], v19 offset:53248
    ds_read_b64_tr_b16 v[230:231], v19 offset:55296
    v_add_f32 v31, v31, v131
    v_fma_f32 v134, v134, s35, -v233
    v_exp_f32 v133, v133
    v_add_f32 v31, v31, v132
    s_waitcnt lgkmcnt(8)
    v_mfma_f32_32x32x16_bf16 v[96:111], v[212:215], v[196:199], v[96:111]
    ds_read_b64_tr_b16 v[208:209], v19 offset:57344
    ds_read_b64_tr_b16 v[210:211], v19 offset:59392
    v_fma_f32 v135, v135, s35, -v233
    v_exp_f32 v134, v134
    v_add_f32 v31, v31, v133
    v_fma_f32 v136, v136, s35, -v233
    s_waitcnt lgkmcnt(8)
    v_mfma_f32_32x32x16_bf16 v[96:111], v[216:219], v[200:203], v[96:111]
    ds_read_b64_tr_b16 v[212:213], v19 offset:61440
    ds_read_b64_tr_b16 v[214:215], v19 offset:63488
    v_exp_f32 v135, v135
    v_add_f32 v31, v31, v134
    v_fma_f32 v137, v137, s35, -v233
    v_exp_f32 v136, v136
    s_waitcnt lgkmcnt(8)
    v_mfma_f32_32x32x16_bf16 v[96:111], v[220:223], v[204:207], v[96:111]
    ds_read_b128 v[216:219], v8 offset:16384
    v_add_f32 v31, v31, v135
    v_fma_f32 v138, v138, s35, -v233
    v_exp_f32 v137, v137
    s_waitcnt lgkmcnt(7)
    v_mfma_f32_32x32x16_bf16 v[112:127], v[224:227], v[192:195], v[112:127]
    ds_read_b128 v[220:223], v9 offset:16384
    v_add_f32 v31, v31, v136
    v_fma_f32 v139, v139, s35, -v233
    v_exp_f32 v138, v138
    v_add_f32 v31, v31, v137
    v_fma_f32 v140, v140, s35, -v233
    s_waitcnt lgkmcnt(6)
    v_mfma_f32_32x32x16_bf16 v[112:127], v[228:231], v[196:199], v[112:127]
    ds_read_b128 v[224:227], v10 offset:16384
    v_exp_f32 v139, v139
    v_add_f32 v31, v31, v138
    v_fma_f32 v141, v141, s35, -v233
    v_exp_f32 v140, v140
    s_waitcnt lgkmcnt(5)
    v_mfma_f32_32x32x16_bf16 v[112:127], v[208:211], v[200:203], v[112:127]
    ds_read_b128 v[228:231], v11 offset:16384
    v_add_f32 v31, v31, v139
    v_fma_f32 v142, v142, s35, -v233
    v_exp_f32 v141, v141
    s_waitcnt lgkmcnt(4)
    v_mfma_f32_32x32x16_bf16 v[112:127], v[212:215], v[204:207], v[112:127]
    ds_read_b128 v[208:211], v12 offset:16384
    s_cmp_lg_u32 s61, 0
    s_cbranch_scc1 L_rs2_4
L_bk2_4:
    v_cvt_pk_bf16_f32 v192, v128, v129
    v_cvt_pk_bf16_f32 v193, v130, v131
    v_cvt_pk_bf16_f32 v194, v132, v133
    v_cvt_pk_bf16_f32 v195, v134, v135
    v_cvt_pk_bf16_f32 v196, v136, v137
    s_waitcnt lgkmcnt(4)
    v_mfma_f32_32x32x16_bf16 v[160:175], v[216:219], v[32:35], 0
    ds_read_b128 v[212:215], v13 offset:16384
    v_cvt_pk_bf16_f32 v197, v138, v139
    v_cvt_pk_bf16_f32 v198, v140, v141
    v_add_f32 v31, v31, v140
    v_fma_f32 v143, v143, s35, -v233
    v_exp_f32 v142, v142
    s_waitcnt lgkmcnt(4)
    v_mfma_f32_32x32x16_bf16 v[160:175], v[220:223], v[36:39], v[160:175]
    ds_read_b128 v[216:219], v14 offset:16384
    v_add_f32 v31, v31, v141
    v_fma_f32 v144, v144, s35, -v233
    v_exp_f32 v143, v143
    v_add_f32 v31, v31, v142
    s_waitcnt lgkmcnt(4)
    v_mfma_f32_32x32x16_bf16 v[160:175], v[224:227], v[40:43], v[160:175]
    ds_read_b128 v[220:223], v15 offset:16384
    v_cvt_pk_bf16_f32 v199, v142, v143
    v_fma_f32 v145, v145, s35, -v233
    v_exp_f32 v144, v144
    v_add_f32 v31, v31, v143
    s_waitcnt lgkmcnt(4)
    v_mfma_f32_32x32x16_bf16 v[160:175], v[228:231], v[44:47], v[160:175]
    ds_read_b128 v[224:227], v8 offset:24576
    v_fma_f32 v146, v146, s35, -v233
    v_exp_f32 v145, v145
    v_add_f32 v31, v31, v144
    v_cvt_pk_bf16_f32 v200, v144, v145
    s_waitcnt lgkmcnt(4)
    v_mfma_f32_32x32x16_bf16 v[160:175], v[208:211], v[48:51], v[160:175]
    ds_read_b128 v[228:231], v9 offset:24576
    v_fma_f32 v147, v147, s35, -v233
    v_exp_f32 v146, v146
    v_add_f32 v31, v31, v145
    v_fma_f32 v148, v148, s35, -v233
    v_exp_f32 v147, v147
    s_waitcnt lgkmcnt(4)
    v_mfma_f32_32x32x16_bf16 v[160:175], v[212:215], v[52:55], v[160:175]
    ds_read_b128 v[208:211], v10 offset:24576
    v_add_f32 v31, v31, v146
    v_cvt_pk_bf16_f32 v201, v146, v147
    v_fma_f32 v149, v149, s35, -v233
    v_exp_f32 v148, v148
    s_waitcnt lgkmcnt(4)
    v_mfma_f32_32x32x16_bf16 v[160:175], v[216:219], v[56:59], v[160:175]
    ds_read_b128 v[212:215], v11 offset:24576
    v_add_f32 v31, v31, v147
    v_fma_f32 v150, v150, s35, -v233
    v_exp_f32 v149, v149
    s_waitcnt lgkmcnt(4)
    v_mfma_f32_32x32x16_bf16 v[160:175], v[220:223], v[60:63], v[160:175]
    ds_read_b128 v[216:219], v12 offset:24576
    v_add_f32 v31, v31, v148
    v_cvt_pk_bf16_f32 v202, v148, v149
    v_fma_f32 v151, v151, s35, -v233
    v_exp_f32 v150, v150
    s_waitcnt lgkmcnt(4)
    v_mfma_f32_32x32x16_bf16 v[176:191], v[224:227], v[32:35], 0
    ds_read_b128 v[220:223], v13 offset:24576
    v_add_f32 v31, v31, v149
    v_fma_f32 v152, v152, s35, -v233
    v_exp_f32 v151, v151
    v_add_f32 v31, v31, v150
    v_cvt_pk_bf16_f32 v203, v150, v151
    s_waitcnt lgkmcnt(4)
    v_mfma_f32_32x32x16_bf16 v[176:191], v[228:231], v[36:39], v[176:191]
    ds_read_b128 v[224:227], v14 offset:24576
    v_fma_f32 v153, v153, s35, -v233
    v_exp_f32 v152, v152
    v_add_f32 v31, v31, v151
    v_fma_f32 v154, v154, s35, -v233
    s_waitcnt lgkmcnt(4)
    v_mfma_f32_32x32x16_bf16 v[176:191], v[208:211], v[40:43], v[176:191]
    ds_read_b128 v[228:231], v15 offset:24576
    v_exp_f32 v153, v153
    v_add_f32 v31, v31, v152
    v_cvt_pk_bf16_f32 v204, v152, v153
    v_fma_f32 v155, v155, s35, -v233
    s_waitcnt lgkmcnt(4)
    v_mfma_f32_32x32x16_bf16 v[176:191], v[212:215], v[44:47], v[176:191]
    ds_read_b64_tr_b16 v[208:209], v235 offset:0
    ds_read_b64_tr_b16 v[210:211], v235 offset:2048
    v_exp_f32 v154, v154
    v_add_f32 v31, v31, v153
    v_fma_f32 v156, v156, s35, -v233
    v_exp_f32 v155, v155
    s_waitcnt lgkmcnt(5)
    v_mfma_f32_32x32x16_bf16 v[176:191], v[216:219], v[48:51], v[176:191]
    ds_read_b64_tr_b16 v[212:213], v235 offset:4096
    ds_read_b64_tr_b16 v[214:215], v235 offset:6144
    v_add_f32 v31, v31, v154
    v_cvt_pk_bf16_f32 v205, v154, v155
    v_fma_f32 v157, v157, s35, -v233
    v_exp_f32 v156, v156
    s_waitcnt lgkmcnt(6)
    v_mfma_f32_32x32x16_bf16 v[176:191], v[220:223], v[52:55], v[176:191]
    ds_read_b64_tr_b16 v[216:217], v235 offset:8192
    ds_read_b64_tr_b16 v[218:219], v235 offset:10240
    v_add_f32 v31, v31, v155
    v_fma_f32 v158, v158, s35, -v233
    v_exp_f32 v157, v157
    v_add_f32 v31, v31, v156
    s_waitcnt lgkmcnt(7)
    v_mfma_f32_32x32x16_bf16 v[176:191], v[224:227], v[56:59], v[176:191]
    ds_read_b64_tr_b16 v[220:221], v235 offset:12288
    ds_read_b64_tr_b16 v[222:223], v235 offset:14336
    v_cvt_pk_bf16_f32 v206, v156, v157
    v_fma_f32 v159, v159, s35, -v233
    v_exp_f32 v158, v158
    v_add_f32 v31, v31, v157
    s_waitcnt lgkmcnt(8)
    v_mfma_f32_32x32x16_bf16 v[176:191], v[228:231], v[60:63], v[176:191]
    ds_read_b64_tr_b16 v[224:225], v236 offset:0
    ds_read_b64_tr_b16 v[226:227], v236 offset:2048
    v_exp_f32 v159, v159
    v_add_f32 v31, v31, v158
    v_cvt_pk_bf16_f32 v207, v158, v159
    v_add_f32 v31, v31, v159
    s_nop 0
    s_waitcnt vmcnt(8)
    s_barrier
    s_waitcnt lgkmcnt(8)
    v_mfma_f32_32x32x16_bf16 v[64:79], v[208:211], v[192:195], v[64:79]
    ds_read_b64_tr_b16 v[228:229], v236 offset:4096
    ds_read_b64_tr_b16 v[230:231], v236 offset:6144
    v_max3_f32 v2, v160, v161, v162
    v_max3_f32 v3, v163, v164, v165
    v_max3_f32 v4, v166, v167, v168
    v_max3_f32 v5, v169, v170, v171
    v_max3_f32 v2, v2, v172, v173
    v_max3_f32 v3, v3, v174, v175
    s_waitcnt lgkmcnt(8)
    v_mfma_f32_32x32x16_bf16 v[64:79], v[212:215], v[196:199], v[64:79]
    ds_read_b64_tr_b16 v[208:209], v236 offset:8192
    ds_read_b64_tr_b16 v[210:211], v236 offset:10240
    s_add_u32 m0, s38, 16384
    s_nop 0
    buffer_load_dwordx4 v24, s[16:19], s36 offen offset:0 nt lds
    v_max3_f32 v4, v4, v176, v177
    v_max3_f32 v5, v5, v178, v179
    v_max3_f32 v2, v2, v180, v181
    v_max3_f32 v3, v3, v182, v183
    v_max3_f32 v4, v4, v184, v185
    s_waitcnt lgkmcnt(8)
    v_mfma_f32_32x32x16_bf16 v[64:79], v[216:219], v[200:203], v[64:79]
    ds_read_b64_tr_b16 v[212:213], v236 offset:12288
    ds_read_b64_tr_b16 v[214:215], v236 offset:14336
    v_max3_f32 v5, v5, v186, v187
    v_max3_f32 v2, v2, v188, v189
    v_max3_f32 v3, v3, v190, v191
    v_max3_f32 v2, v2, v3, v4
    v_max_f32 v2, v2, v5
    s_waitcnt lgkmcnt(8)
    v_mfma_f32_32x32x16_bf16 v[64:79], v[220:223], v[204:207], v[64:79]
    ds_read_b64_tr_b16 v[216:217], v237 offset:0
    ds_read_b64_tr_b16 v[218:219], v237 offset:2048
    buffer_load_dwordx4 v25, s[16:19], s36 offen offset:1024 nt lds
    s_add_u32 s36, s36, 16384
    v_mov_b32 v3, v2
    s_nop 1
    v_permlane32_swap_b32 v2, v3
    v_max_f32 v2, v2, v3
    v_sub_f32 v3, v2, v30
    s_waitcnt lgkmcnt(8)
    v_mfma_f32_32x32x16_bf16 v[80:95], v[224:227], v[192:195], v[80:95]
    ds_read_b64_tr_b16 v[220:221], v237 offset:4096
    ds_read_b64_tr_b16 v[222:223], v237 offset:6144
    v_cmp_lt_f32 vcc, s62, v3
    s_cbranch_vccnz L_rs1_5
    L_bk1_5:
    v_fma_f32 v160, v160, s35, -v233
    v_fma_f32 v161, v161, s35, -v233
    v_exp_f32 v160, v160
    s_waitcnt lgkmcnt(8)
    v_mfma_f32_32x32x16_bf16 v[80:95], v[228:231], v[196:199], v[80:95]
    ds_read_b64_tr_b16 v[224:225], v237 offset:8192
    ds_read_b64_tr_b16 v[226:227], v237 offset:10240
    s_add_u32 m0, s39, 49152
    s_nop 0
    buffer_load_dwordx4 v26, s[20:23], s37 offen offset:0 nt lds
    v_fma_f32 v162, v162, s35, -v233
    v_exp_f32 v161, v161
    v_add_f32 v31, v31, v160
    s_waitcnt lgkmcnt(8)
    v_mfma_f32_32x32x16_bf16 v[80:95], v[208:211], v[200:203], v[80:95]
    ds_read_b64_tr_b16 v[228:229], v237 offset:12288
    ds_read_b64_tr_b16 v[230:231], v237 offset:14336
    v_fma_f32 v163, v163, s35, -v233
    v_exp_f32 v162, v162
    v_add_f32 v31, v31, v161
    v_fma_f32 v164, v164, s35, -v233
    s_waitcnt lgkmcnt(8)
    v_mfma_f32_32x32x16_bf16 v[80:95], v[212:215], v[204:207], v[80:95]
    ds_read_b64_tr_b16 v[208:209], v238 offset:0
    ds_read_b64_tr_b16 v[210:211], v238 offset:2048
    buffer_load_dwordx4 v26, s[20:23], s37 offen offset:1024 nt lds
    s_add_u32 s37, s37, 16384
    v_exp_f32 v163, v163
    v_add_f32 v31, v31, v162
    v_fma_f32 v165, v165, s35, -v233
    v_exp_f32 v164, v164
    s_waitcnt lgkmcnt(8)
    v_mfma_f32_32x32x16_bf16 v[96:111], v[216:219], v[192:195], v[96:111]
    ds_read_b64_tr_b16 v[212:213], v238 offset:4096
    ds_read_b64_tr_b16 v[214:215], v238 offset:6144
    v_add_f32 v31, v31, v163
    v_fma_f32 v166, v166, s35, -v233
    v_exp_f32 v165, v165
    v_add_f32 v31, v31, v164
    s_waitcnt lgkmcnt(8)
    v_mfma_f32_32x32x16_bf16 v[96:111], v[220:223], v[196:199], v[96:111]
    ds_read_b64_tr_b16 v[216:217], v238 offset:8192
    ds_read_b64_tr_b16 v[218:219], v238 offset:10240
    v_fma_f32 v167, v167, s35, -v233
    v_exp_f32 v166, v166
    v_add_f32 v31, v31, v165
    v_fma_f32 v168, v168, s35, -v233
    s_waitcnt lgkmcnt(8)
    v_mfma_f32_32x32x16_bf16 v[96:111], v[224:227], v[200:203], v[96:111]
    ds_read_b64_tr_b16 v[220:221], v238 offset:12288
    ds_read_b64_tr_b16 v[222:223], v238 offset:14336
    v_exp_f32 v167, v167
    v_add_f32 v31, v31, v166
    v_fma_f32 v169, v169, s35, -v233
    v_exp_f32 v168, v168
    s_waitcnt lgkmcnt(8)
    v_mfma_f32_32x32x16_bf16 v[96:111], v[228:231], v[204:207], v[96:111]
    ds_read_b128 v[224:227], v8 offset:32768
    v_add_f32 v31, v31, v167
    v_fma_f32 v170, v170, s35, -v233
    v_exp_f32 v169, v169
    s_waitcnt lgkmcnt(7)
    v_mfma_f32_32x32x16_bf16 v[112:127], v[208:211], v[192:195], v[112:127]
    ds_read_b128 v[228:231], v9 offset:32768
    v_add_f32 v31, v31, v168
    v_fma_f32 v171, v171, s35, -v233
    v_exp_f32 v170, v170
    v_add_f32 v31, v31, v169
    v_fma_f32 v172, v172, s35, -v233
    s_waitcnt lgkmcnt(6)
    v_mfma_f32_32x32x16_bf16 v[112:127], v[212:215], v[196:199], v[112:127]
    ds_read_b128 v[208:211], v10 offset:32768
    v_exp_f32 v171, v171
    v_add_f32 v31, v31, v170
    v_fma_f32 v173, v173, s35, -v233
    v_exp_f32 v172, v172
    s_waitcnt lgkmcnt(5)
    v_mfma_f32_32x32x16_bf16 v[112:127], v[216:219], v[200:203], v[112:127]
    ds_read_b128 v[212:215], v11 offset:32768
    v_add_f32 v31, v31, v171
    v_fma_f32 v174, v174, s35, -v233
    v_exp_f32 v173, v173
    s_waitcnt lgkmcnt(4)
    v_mfma_f32_32x32x16_bf16 v[112:127], v[220:223], v[204:207], v[112:127]
    ds_read_b128 v[216:219], v12 offset:32768
    s_cmp_lg_u32 s61, 0
    s_cbranch_scc1 L_rs2_5
L_bk2_5:
    v_cvt_pk_bf16_f32 v192, v160, v161
    v_cvt_pk_bf16_f32 v193, v162, v163
    v_cvt_pk_bf16_f32 v194, v164, v165
    v_cvt_pk_bf16_f32 v195, v166, v167
    v_cvt_pk_bf16_f32 v196, v168, v169
    s_waitcnt lgkmcnt(4)
    v_mfma_f32_32x32x16_bf16 v[128:143], v[224:227], v[32:35], 0
    ds_read_b128 v[220:223], v13 offset:32768
    v_cvt_pk_bf16_f32 v197, v170, v171
    v_cvt_pk_bf16_f32 v198, v172, v173
    v_add_f32 v31, v31, v172
    v_fma_f32 v175, v175, s35, -v233
    v_exp_f32 v174, v174
    s_waitcnt lgkmcnt(4)
    v_mfma_f32_32x32x16_bf16 v[128:143], v[228:231], v[36:39], v[128:143]
    ds_read_b128 v[224:227], v14 offset:32768
    v_add_f32 v31, v31, v173
    v_fma_f32 v176, v176, s35, -v233
    v_exp_f32 v175, v175
    v_add_f32 v31, v31, v174
    s_waitcnt lgkmcnt(4)
    v_mfma_f32_32x32x16_bf16 v[128:143], v[208:211], v[40:43], v[128:143]
    ds_read_b128 v[228:231], v15 offset:32768
    v_cvt_pk_bf16_f32 v199, v174, v175
    v_fma_f32 v177, v177, s35, -v233
    v_exp_f32 v176, v176
    v_add_f32 v31, v31, v175
    s_waitcnt lgkmcnt(4)
    v_mfma_f32_32x32x16_bf16 v[128:143], v[212:215], v[44:47], v[128:143]
    ds_read_b128 v[208:211], v8 offset:40960
    v_fma_f32 v178, v178, s35, -v233
    v_exp_f32 v177, v177
    v_add_f32 v31, v31, v176
    v_cvt_pk_bf16_f32 v200, v176, v177
    s_waitcnt lgkmcnt(4)
    v_mfma_f32_32x32x16_bf16 v[128:143], v[216:219], v[48:51], v[128:143]
    ds_read_b128 v[212:215], v9 offset:40960
    v_fma_f32 v179, v179, s35, -v233
    v_exp_f32 v178, v178
    v_add_f32 v31, v31, v177
    v_fma_f32 v180, v180, s35, -v233
    v_exp_f32 v179, v179
    s_waitcnt lgkmcnt(4)
    v_mfma_f32_32x32x16_bf16 v[128:143], v[220:223], v[52:55], v[128:143]
    ds_read_b128 v[216:219], v10 offset:40960
    v_add_f32 v31, v31, v178
    v_cvt_pk_bf16_f32 v201, v178, v179
    v_fma_f32 v181, v181, s35, -v233
    v_exp_f32 v180, v180
    s_waitcnt lgkmcnt(4)
    v_mfma_f32_32x32x16_bf16 v[128:143], v[224:227], v[56:59], v[128:143]
    ds_read_b128 v[220:223], v11 offset:40960
    v_add_f32 v31, v31, v179
    v_fma_f32 v182, v182, s35, -v233
    v_exp_f32 v181, v181
    s_waitcnt lgkmcnt(4)
    v_mfma_f32_32x32x16_bf16 v[128:143], v[228:231], v[60:63], v[128:143]
    ds_read_b128 v[224:227], v12 offset:40960
    v_add_f32 v31, v31, v180
    v_cvt_pk_bf16_f32 v202, v180, v181
    v_fma_f32 v183, v183, s35, -v233
    v_exp_f32 v182, v182
    s_waitcnt lgkmcnt(4)
    v_mfma_f32_32x32x16_bf16 v[144:159], v[208:211], v[32:35], 0
    ds_read_b128 v[228:231], v13 offset:40960
    v_add_f32 v31, v31, v181
    v_fma_f32 v184, v184, s35, -v233
    v_exp_f32 v183, v183
    v_add_f32 v31, v31, v182
    v_cvt_pk_bf16_f32 v203, v182, v183
    s_waitcnt lgkmcnt(4)
    v_mfma_f32_32x32x16_bf16 v[144:159], v[212:215], v[36:39], v[144:159]
    ds_read_b128 v[208:211], v14 offset:40960
    v_fma_f32 v185, v185, s35, -v233
    v_exp_f32 v184, v184
    v_add_f32 v31, v31, v183
    v_fma_f32 v186, v186, s35, -v233
    s_waitcnt lgkmcnt(4)
    v_mfma_f32_32x32x16_bf16 v[144:159], v[216:219], v[40:43], v[144:159]
    ds_read_b128 v[212:215], v15 offset:40960
    v_exp_f32 v185, v185
    v_add_f32 v31, v31, v184
    v_cvt_pk_bf16_f32 v204, v184, v185
    v_fma_f32 v187, v187, s35, -v233
    s_waitcnt lgkmcnt(4)
    v_mfma_f32_32x32x16_bf16 v[144:159], v[220:223], v[44:47], v[144:159]
    ds_read_b64_tr_b16 v[216:217], v16 offset:0
    ds_read_b64_tr_b16 v[218:219], v16 offset:2048
    v_exp_f32 v186, v186
    v_add_f32 v31, v31, v185
    v_fma_f32 v188, v188, s35, -v233
    v_exp_f32 v187, v187
    s_waitcnt lgkmcnt(5)
    v_mfma_f32_32x32x16_bf16 v[144:159], v[224:227], v[48:51], v[144:159]
    ds_read_b64_tr_b16 v[220:221], v16 offset:4096
    ds_read_b64_tr_b16 v[222:223], v16 offset:6144
    v_add_f32 v31, v31, v186
    v_cvt_pk_bf16_f32 v205, v186, v187
    v_fma_f32 v189, v189, s35, -v233
    v_exp_f32 v188, v188
    s_waitcnt lgkmcnt(6)
    v_mfma_f32_32x32x16_bf16 v[144:159], v[228:231], v[52:55], v[144:159]
    ds_read_b64_tr_b16 v[224:225], v16 offset:8192
    ds_read_b64_tr_b16 v[226:227], v16 offset:10240
    v_add_f32 v31, v31, v187
    v_fma_f32 v190, v190, s35, -v233
    v_exp_f32 v189, v189
    v_add_f32 v31, v31, v188
    s_waitcnt lgkmcnt(7)
    v_mfma_f32_32x32x16_bf16 v[144:159], v[208:211], v[56:59], v[144:159]
    ds_read_b64_tr_b16 v[228:229], v16 offset:12288
    ds_read_b64_tr_b16 v[230:231], v16 offset:14336
    v_cvt_pk_bf16_f32 v206, v188, v189
    v_fma_f32 v191, v191, s35, -v233
    v_exp_f32 v190, v190
    v_add_f32 v31, v31, v189
    s_waitcnt lgkmcnt(8)
    v_mfma_f32_32x32x16_bf16 v[144:159], v[212:215], v[60:63], v[144:159]
    ds_read_b64_tr_b16 v[208:209], v17 offset:0
    ds_read_b64_tr_b16 v[210:211], v17 offset:2048
    v_exp_f32 v191, v191
    v_add_f32 v31, v31, v190
    v_cvt_pk_bf16_f32 v207, v190, v191
    v_add_f32 v31, v31, v191
    s_nop 0
    s_waitcnt vmcnt(8)
    s_barrier
    s_waitcnt lgkmcnt(8)
    v_mfma_f32_32x32x16_bf16 v[64:79], v[216:219], v[192:195], v[64:79]
    ds_read_b64_tr_b16 v[212:213], v17 offset:4096
    ds_read_b64_tr_b16 v[214:215], v17 offset:6144
    v_max3_f32 v2, v128, v129, v130
    v_max3_f32 v3, v131, v132, v133
    v_max3_f32 v4, v134, v135, v136
    v_max3_f32 v5, v137, v138, v139
    v_max3_f32 v2, v2, v140, v141
    v_max3_f32 v3, v3, v142, v143
    s_waitcnt lgkmcnt(8)
    v_mfma_f32_32x32x16_bf16 v[64:79], v[220:223], v[196:199], v[64:79]
    ds_read_b64_tr_b16 v[216:217], v17 offset:8192
    ds_read_b64_tr_b16 v[218:219], v17 offset:10240
    s_add_u32 m0, s38, 32768
    s_nop 0
    buffer_load_dwordx4 v24, s[16:19], s36 offen offset:0 nt lds
    v_max3_f32 v4, v4, v144, v145
    v_max3_f32 v5, v5, v146, v147
    v_max3_f32 v2, v2, v148, v149
    v_max3_f32 v3, v3, v150, v151
    v_max3_f32 v4, v4, v152, v153
    s_waitcnt lgkmcnt(8)
    v_mfma_f32_32x32x16_bf16 v[64:79], v[224:227], v[200:203], v[64:79]
    ds_read_b64_tr_b16 v[220:221], v17 offset:12288
    ds_read_b64_tr_b16 v[222:223], v17 offset:14336
    v_max3_f32 v5, v5, v154, v155
    v_max3_f32 v2, v2, v156, v157
    v_max3_f32 v3, v3, v158, v159
    v_max3_f32 v2, v2, v3, v4
    v_max_f32 v2, v2, v5
    s_waitcnt lgkmcnt(8)
    v_mfma_f32_32x32x16_bf16 v[64:79], v[228:231], v[204:207], v[64:79]
    ds_read_b64_tr_b16 v[224:225], v18 offset:0
    ds_read_b64_tr_b16 v[226:227], v18 offset:2048
    buffer_load_dwordx4 v25, s[16:19], s36 offen offset:1024 nt lds
    s_add_u32 s36, s36, 16384
    v_mov_b32 v3, v2
    s_nop 1
    v_permlane32_swap_b32 v2, v3
    v_max_f32 v2, v2, v3
    v_sub_f32 v3, v2, v30
    s_waitcnt lgkmcnt(8)
    v_mfma_f32_32x32x16_bf16 v[80:95], v[208:211], v[192:195], v[80:95]
    ds_read_b64_tr_b16 v[228:229], v18 offset:4096
    ds_read_b64_tr_b16 v[230:231], v18 offset:6144
    v_cmp_lt_f32 vcc, s62, v3
    s_cbranch_vccnz L_rs1_6
    L_bk1_6:
    v_fma_f32 v128, v128, s35, -v233
    v_fma_f32 v129, v129, s35, -v233
    v_exp_f32 v128, v128
    s_waitcnt lgkmcnt(8)
    v_mfma_f32_32x32x16_bf16 v[80:95], v[212:215], v[196:199], v[80:95]
    ds_read_b64_tr_b16 v[208:209], v18 offset:8192
    ds_read_b64_tr_b16 v[210:211], v18 offset:10240
    s_add_u32 m0, s39, 65536
    s_nop 0
    buffer_load_dwordx4 v26, s[20:23], s37 offen offset:0 nt lds
    v_fma_f32 v130, v130, s35, -v233
    v_exp_f32 v129, v129
    v_add_f32 v31, v31, v128
    s_waitcnt lgkmcnt(8)
    v_mfma_f32_32x32x16_bf16 v[80:95], v[216:219], v[200:203], v[80:95]
    ds_read_b64_tr_b16 v[212:213], v18 offset:12288
    ds_read_b64_tr_b16 v[214:215], v18 offset:14336
    v_fma_f32 v131, v131, s35, -v233
    v_exp_f32 v130, v130
    v_add_f32 v31, v31, v129
    v_fma_f32 v132, v132, s35, -v233
    s_waitcnt lgkmcnt(8)
    v_mfma_f32_32x32x16_bf16 v[80:95], v[220:223], v[204:207], v[80:95]
    ds_read_b64_tr_b16 v[216:217], v19 offset:0
    ds_read_b64_tr_b16 v[218:219], v19 offset:2048
    buffer_load_dwordx4 v26, s[20:23], s37 offen offset:1024 nt lds
    s_add_u32 s37, s37, 16384
    v_exp_f32 v131, v131
    v_add_f32 v31, v31, v130
    v_fma_f32 v133, v133, s35, -v233
    v_exp_f32 v132, v132
    s_waitcnt lgkmcnt(8)
    v_mfma_f32_32x32x16_bf16 v[96:111], v[224:227], v[192:195], v[96:111]
    ds_read_b64_tr_b16 v[220:221], v19 offset:4096
    ds_read_b64_tr_b16 v[222:223], v19 offset:6144
    v_add_f32 v31, v31, v131
    v_fma_f32 v134, v134, s35, -v233
    v_exp_f32 v133, v133
    v_add_f32 v31, v31, v132
    s_waitcnt lgkmcnt(8)
    v_mfma_f32_32x32x16_bf16 v[96:111], v[228:231], v[196:199], v[96:111]
    ds_read_b64_tr_b16 v[224:225], v19 offset:8192
    ds_read_b64_tr_b16 v[226:227], v19 offset:10240
    v_fma_f32 v135, v135, s35, -v233
    v_exp_f32 v134, v134
    v_add_f32 v31, v31, v133
    v_fma_f32 v136, v136, s35, -v233
    s_waitcnt lgkmcnt(8)
    v_mfma_f32_32x32x16_bf16 v[96:111], v[208:211], v[200:203], v[96:111]
    ds_read_b64_tr_b16 v[228:229], v19 offset:12288
    ds_read_b64_tr_b16 v[230:231], v19 offset:14336
    v_exp_f32 v135, v135
    v_add_f32 v31, v31, v134
    v_fma_f32 v137, v137, s35, -v233
    v_exp_f32 v136, v136
    s_waitcnt lgkmcnt(8)
    v_mfma_f32_32x32x16_bf16 v[96:111], v[212:215], v[204:207], v[96:111]
    ds_read_b128 v[208:211], v8 offset:49152
    v_add_f32 v31, v31, v135
    v_fma_f32 v138, v138, s35, -v233
    v_exp_f32 v137, v137
    s_waitcnt lgkmcnt(7)
    v_mfma_f32_32x32x16_bf16 v[112:127], v[216:219], v[192:195], v[112:127]
    ds_read_b128 v[212:215], v9 offset:49152
    v_add_f32 v31, v31, v136
    v_fma_f32 v139, v139, s35, -v233
    v_exp_f32 v138, v138
    v_add_f32 v31, v31, v137
    v_fma_f32 v140, v140, s35, -v233
    s_waitcnt lgkmcnt(6)
    v_mfma_f32_32x32x16_bf16 v[112:127], v[220:223], v[196:199], v[112:127]
    ds_read_b128 v[216:219], v10 offset:49152
    v_exp_f32 v139, v139
    v_add_f32 v31, v31, v138
    v_fma_f32 v141, v141, s35, -v233
    v_exp_f32 v140, v140
    s_waitcnt lgkmcnt(5)
    v_mfma_f32_32x32x16_bf16 v[112:127], v[224:227], v[200:203], v[112:127]
    ds_read_b128 v[220:223], v11 offset:49152
    v_add_f32 v31, v31, v139
    v_fma_f32 v142, v142, s35, -v233
    v_exp_f32 v141, v141
    s_waitcnt lgkmcnt(4)
    v_mfma_f32_32x32x16_bf16 v[112:127], v[228:231], v[204:207], v[112:127]
    ds_read_b128 v[224:227], v12 offset:49152
    s_cmp_lg_u32 s61, 0
    s_cbranch_scc1 L_rs2_6
L_bk2_6:
    v_cvt_pk_bf16_f32 v192, v128, v129
    v_cvt_pk_bf16_f32 v193, v130, v131
    v_cvt_pk_bf16_f32 v194, v132, v133
    v_cvt_pk_bf16_f32 v195, v134, v135
    v_cvt_pk_bf16_f32 v196, v136, v137
    s_waitcnt lgkmcnt(4)
    v_mfma_f32_32x32x16_bf16 v[160:175], v[208:211], v[32:35], 0
    ds_read_b128 v[228:231], v13 offset:49152
    v_cvt_pk_bf16_f32 v197, v138, v139
    v_cvt_pk_bf16_f32 v198, v140, v141
    v_add_f32 v31, v31, v140
    v_fma_f32 v143, v143, s35, -v233
    v_exp_f32 v142, v142
    s_waitcnt lgkmcnt(4)
    v_mfma_f32_32x32x16_bf16 v[160:175], v[212:215], v[36:39], v[160:175]
    ds_read_b128 v[208:211], v14 offset:49152
    v_add_f32 v31, v31, v141
    v_fma_f32 v144, v144, s35, -v233
    v_exp_f32 v143, v143
    v_add_f32 v31, v31, v142
    s_waitcnt lgkmcnt(4)
    v_mfma_f32_32x32x16_bf16 v[160:175], v[216:219], v[40:43], v[160:175]
    ds_read_b128 v[212:215], v15 offset:49152
    v_cvt_pk_bf16_f32 v199, v142, v143
    v_fma_f32 v145, v145, s35, -v233
    v_exp_f32 v144, v144
    v_add_f32 v31, v31, v143
    s_waitcnt lgkmcnt(4)
    v_mfma_f32_32x32x16_bf16 v[160:175], v[220:223], v[44:47], v[160:175]
    ds_read_b128 v[216:219], v8 offset:57344
    v_fma_f32 v146, v146, s35, -v233
    v_exp_f32 v145, v145
    v_add_f32 v31, v31, v144
    v_cvt_pk_bf16_f32 v200, v144, v145
    s_waitcnt lgkmcnt(4)
    v_mfma_f32_32x32x16_bf16 v[160:175], v[224:227], v[48:51], v[160:175]
    ds_read_b128 v[220:223], v9 offset:57344
    v_fma_f32 v147, v147, s35, -v233
    v_exp_f32 v146, v146
    v_add_f32 v31, v31, v145
    v_fma_f32 v148, v148, s35, -v233
    v_exp_f32 v147, v147
    s_waitcnt lgkmcnt(4)
    v_mfma_f32_32x32x16_bf16 v[160:175], v[228:231], v[52:55], v[160:175]
    ds_read_b128 v[224:227], v10 offset:57344
    v_add_f32 v31, v31, v146
    v_cvt_pk_bf16_f32 v201, v146, v147
    v_fma_f32 v149, v149, s35, -v233
    v_exp_f32 v148, v148
    s_waitcnt lgkmcnt(4)
    v_mfma_f32_32x32x16_bf16 v[160:175], v[208:211], v[56:59], v[160:175]
    ds_read_b128 v[228:231], v11 offset:57344
    v_add_f32 v31, v31, v147
    v_fma_f32 v150, v150, s35, -v233
    v_exp_f32 v149, v149
    s_waitcnt lgkmcnt(4)
    v_mfma_f32_32x32x16_bf16 v[160:175], v[212:215], v[60:63], v[160:175]
    ds_read_b128 v[208:211], v12 offset:57344
    v_add_f32 v31, v31, v148
    v_cvt_pk_bf16_f32 v202, v148, v149
    v_fma_f32 v151, v151, s35, -v233
    v_exp_f32 v150, v150
    s_waitcnt lgkmcnt(4)
    v_mfma_f32_32x32x16_bf16 v[176:191], v[216:219], v[32:35], 0
    ds_read_b128 v[212:215], v13 offset:57344
    v_add_f32 v31, v31, v149
    v_fma_f32 v152, v152, s35, -v233
    v_exp_f32 v151, v151
    v_add_f32 v31, v31, v150
    v_cvt_pk_bf16_f32 v203, v150, v151
    s_waitcnt lgkmcnt(4)
    v_mfma_f32_32x32x16_bf16 v[176:191], v[220:223], v[36:39], v[176:191]
    ds_read_b128 v[216:219], v14 offset:57344
    v_fma_f32 v153, v153, s35, -v233
    v_exp_f32 v152, v152
    v_add_f32 v31, v31, v151
    v_fma_f32 v154, v154, s35, -v233
    s_waitcnt lgkmcnt(4)
    v_mfma_f32_32x32x16_bf16 v[176:191], v[224:227], v[40:43], v[176:191]
    ds_read_b128 v[220:223], v15 offset:57344
    v_exp_f32 v153, v153
    v_add_f32 v31, v31, v152
    v_cvt_pk_bf16_f32 v204, v152, v153
    v_fma_f32 v155, v155, s35, -v233
    s_waitcnt lgkmcnt(4)
    v_mfma_f32_32x32x16_bf16 v[176:191], v[228:231], v[44:47], v[176:191]
    ds_read_b64_tr_b16 v[224:225], v16 offset:16384
    ds_read_b64_tr_b16 v[226:227], v16 offset:18432
    v_exp_f32 v154, v154
    v_add_f32 v31, v31, v153
    v_fma_f32 v156, v156, s35, -v233
    v_exp_f32 v155, v155
    s_waitcnt lgkmcnt(5)
    v_mfma_f32_32x32x16_bf16 v[176:191], v[208:211], v[48:51], v[176:191]
    ds_read_b64_tr_b16 v[228:229], v16 offset:20480
    ds_read_b64_tr_b16 v[230:231], v16 offset:22528
    v_add_f32 v31, v31, v154
    v_cvt_pk_bf16_f32 v205, v154, v155
    v_fma_f32 v157, v157, s35, -v233
    v_exp_f32 v156, v156
    s_waitcnt lgkmcnt(6)
    v_mfma_f32_32x32x16_bf16 v[176:191], v[212:215], v[52:55], v[176:191]
    ds_read_b64_tr_b16 v[208:209], v16 offset:24576
    ds_read_b64_tr_b16 v[210:211], v16 offset:26624
    v_add_f32 v31, v31, v155
    v_fma_f32 v158, v158, s35, -v233
    v_exp_f32 v157, v157
    v_add_f32 v31, v31, v156
    s_waitcnt lgkmcnt(7)
    v_mfma_f32_32x32x16_bf16 v[176:191], v[216:219], v[56:59], v[176:191]
    ds_read_b64_tr_b16 v[212:213], v16 offset:28672
    ds_read_b64_tr_b16 v[214:215], v16 offset:30720
    v_cvt_pk_bf16_f32 v206, v156, v157
    v_fma_f32 v159, v159, s35, -v233
    v_exp_f32 v158, v158
    v_add_f32 v31, v31, v157
    s_waitcnt lgkmcnt(8)
    v_mfma_f32_32x32x16_bf16 v[176:191], v[220:223], v[60:63], v[176:191]
    ds_read_b64_tr_b16 v[216:217], v17 offset:16384
    ds_read_b64_tr_b16 v[218:219], v17 offset:18432
    v_exp_f32 v159, v159
    v_add_f32 v31, v31, v158
    v_cvt_pk_bf16_f32 v207, v158, v159
    v_add_f32 v31, v31, v159
    s_nop 0
    s_waitcnt vmcnt(8)
    s_barrier
    s_waitcnt lgkmcnt(8)
    v_mfma_f32_32x32x16_bf16 v[64:79], v[224:227], v[192:195], v[64:79]
    ds_read_b64_tr_b16 v[220:221], v17 offset:20480
    ds_read_b64_tr_b16 v[222:223], v17 offset:22528
    v_max3_f32 v2, v160, v161, v162
    v_max3_f32 v3, v163, v164, v165
    v_max3_f32 v4, v166, v167, v168
    v_max3_f32 v5, v169, v170, v171
    v_max3_f32 v2, v2, v172, v173
    v_max3_f32 v3, v3, v174, v175
    s_waitcnt lgkmcnt(8)
    v_mfma_f32_32x32x16_bf16 v[64:79], v[228:231], v[196:199], v[64:79]
    ds_read_b64_tr_b16 v[224:225], v17 offset:24576
    ds_read_b64_tr_b16 v[226:227], v17 offset:26624
    s_add_u32 m0, s38, 49152
    s_nop 0
    buffer_load_dwordx4 v24, s[16:19], s36 offen offset:0 nt lds
    v_max3_f32 v4, v4, v176, v177
    v_max3_f32 v5, v5, v178, v179
    v_max3_f32 v2, v2, v180, v181
    v_max3_f32 v3, v3, v182, v183
    v_max3_f32 v4, v4, v184, v185
    s_waitcnt lgkmcnt(8)
    v_mfma_f32_32x32x16_bf16 v[64:79], v[208:211], v[200:203], v[64:79]
    ds_read_b64_tr_b16 v[228:229], v17 offset:28672
    ds_read_b64_tr_b16 v[230:231], v17 offset:30720
    v_max3_f32 v5, v5, v186, v187
    v_max3_f32 v2, v2, v188, v189
    v_max3_f32 v3, v3, v190, v191
    v_max3_f32 v2, v2, v3, v4
    v_max_f32 v2, v2, v5
    s_waitcnt lgkmcnt(8)
    v_mfma_f32_32x32x16_bf16 v[64:79], v[212:215], v[204:207], v[64:79]
    ds_read_b64_tr_b16 v[208:209], v18 offset:16384
    ds_read_b64_tr_b16 v[210:211], v18 offset:18432
    buffer_load_dwordx4 v25, s[16:19], s36 offen offset:1024 nt lds
    s_add_u32 s36, s36, 16384
    v_mov_b32 v3, v2
    s_nop 1
    v_permlane32_swap_b32 v2, v3
    v_max_f32 v2, v2, v3
    v_sub_f32 v3, v2, v30
    s_waitcnt lgkmcnt(8)
    v_mfma_f32_32x32x16_bf16 v[80:95], v[216:219], v[192:195], v[80:95]
    ds_read_b64_tr_b16 v[212:213], v18 offset:20480
    ds_read_b64_tr_b16 v[214:215], v18 offset:22528
    v_cmp_lt_f32 vcc, s62, v3
    s_cbranch_vccnz L_rs1_7
    L_bk1_7:
    v_fma_f32 v160, v160, s35, -v233
    v_fma_f32 v161, v161, s35, -v233
    v_exp_f32 v160, v160
    s_waitcnt lgkmcnt(8)
    v_mfma_f32_32x32x16_bf16 v[80:95], v[220:223], v[196:199], v[80:95]
    ds_read_b64_tr_b16 v[216:217], v18 offset:24576
    ds_read_b64_tr_b16 v[218:219], v18 offset:26624
    s_add_u32 m0, s39, 0
    s_nop 0
    buffer_load_dwordx4 v26, s[20:23], s37 offen offset:0 nt lds
    v_fma_f32 v162, v162, s35, -v233
    v_exp_f32 v161, v161
    v_add_f32 v31, v31, v160
    s_waitcnt lgkmcnt(8)
    v_mfma_f32_32x32x16_bf16 v[80:95], v[224:227], v[200:203], v[80:95]
    ds_read_b64_tr_b16 v[220:221], v18 offset:28672
    ds_read_b64_tr_b16 v[222:223], v18 offset:30720
    v_fma_f32 v163, v163, s35, -v233
    v_exp_f32 v162, v162
    v_add_f32 v31, v31, v161
    v_fma_f32 v164, v164, s35, -v233
    s_waitcnt lgkmcnt(8)
    v_mfma_f32_32x32x16_bf16 v[80:95], v[228:231], v[204:207], v[80:95]
    ds_read_b64_tr_b16 v[224:225], v19 offset:16384
    ds_read_b64_tr_b16 v[226:227], v19 offset:18432
    buffer_load_dwordx4 v26, s[20:23], s37 offen offset:1024 nt lds
    s_add_u32 s37, s37, 16384
    v_exp_f32 v163, v163
    v_add_f32 v31, v31, v162
    v_fma_f32 v165, v165, s35, -v233
    v_exp_f32 v164, v164
    s_waitcnt lgkmcnt(8)
    v_mfma_f32_32x32x16_bf16 v[96:111], v[208:211], v[192:195], v[96:111]
    ds_read_b64_tr_b16 v[228:229], v19 offset:20480
    ds_read_b64_tr_b16 v[230:231], v19 offset:22528
    v_add_f32 v31, v31, v163
    v_fma_f32 v166, v166, s35, -v233
    v_exp_f32 v165, v165
    v_add_f32 v31, v31, v164
    s_waitcnt lgkmcnt(8)
    v_mfma_f32_32x32x16_bf16 v[96:111], v[212:215], v[196:199], v[96:111]
    ds_read_b64_tr_b16 v[208:209], v19 offset:24576
    ds_read_b64_tr_b16 v[210:211], v19 offset:26624
    v_fma_f32 v167, v167, s35, -v233
    v_exp_f32 v166, v166
    v_add_f32 v31, v31, v165
    v_fma_f32 v168, v168, s35, -v233
    s_waitcnt lgkmcnt(8)
    v_mfma_f32_32x32x16_bf16 v[96:111], v[216:219], v[200:203], v[96:111]
    ds_read_b64_tr_b16 v[212:213], v19 offset:28672
    ds_read_b64_tr_b16 v[214:215], v19 offset:30720
    v_exp_f32 v167, v167
    v_add_f32 v31, v31, v166
    v_fma_f32 v169, v169, s35, -v233
    v_exp_f32 v168, v168
    s_waitcnt lgkmcnt(8)
    v_mfma_f32_32x32x16_bf16 v[96:111], v[220:223], v[204:207], v[96:111]
    ds_read_b128 v[216:219], v8 offset:0
    v_add_f32 v31, v31, v167
    v_fma_f32 v170, v170, s35, -v233
    v_exp_f32 v169, v169
    s_waitcnt lgkmcnt(7)
    v_mfma_f32_32x32x16_bf16 v[112:127], v[224:227], v[192:195], v[112:127]
    ds_read_b128 v[220:223], v9 offset:0
    v_add_f32 v31, v31, v168
    v_fma_f32 v171, v171, s35, -v233
    v_exp_f32 v170, v170
    v_add_f32 v31, v31, v169
    v_fma_f32 v172, v172, s35, -v233
    s_waitcnt lgkmcnt(6)
    v_mfma_f32_32x32x16_bf16 v[112:127], v[228:231], v[196:199], v[112:127]
    ds_read_b128 v[224:227], v10 offset:0
    v_exp_f32 v171, v171
    v_add_f32 v31, v31, v170
    v_fma_f32 v173, v173, s35, -v233
    v_exp_f32 v172, v172
    s_waitcnt lgkmcnt(5)
    v_mfma_f32_32x32x16_bf16 v[112:127], v[208:211], v[200:203], v[112:127]
    ds_read_b128 v[228:231], v11 offset:0
    v_add_f32 v31, v31, v171
    v_fma_f32 v174, v174, s35, -v233
    v_exp_f32 v173, v173
    s_waitcnt lgkmcnt(4)
    v_mfma_f32_32x32x16_bf16 v[112:127], v[212:215], v[204:207], v[112:127]
    ds_read_b128 v[208:211], v12 offset:0
    s_cmp_lg_u32 s61, 0
    s_cbranch_scc1 L_rs2_7
L_bk2_7:
    v_cvt_pk_bf16_f32 v192, v160, v161
    v_cvt_pk_bf16_f32 v193, v162, v163
    v_cvt_pk_bf16_f32 v194, v164, v165
    v_cvt_pk_bf16_f32 v195, v166, v167
    v_cvt_pk_bf16_f32 v196, v168, v169
    s_waitcnt lgkmcnt(4)
    v_mfma_f32_32x32x16_bf16 v[128:143], v[216:219], v[32:35], 0
    ds_read_b128 v[212:215], v13 offset:0
    v_cvt_pk_bf16_f32 v197, v170, v171
    v_cvt_pk_bf16_f32 v198, v172, v173
    v_add_f32 v31, v31, v172
    v_fma_f32 v175, v175, s35, -v233
    v_exp_f32 v174, v174
    s_waitcnt lgkmcnt(4)
    v_mfma_f32_32x32x16_bf16 v[128:143], v[220:223], v[36:39], v[128:143]
    ds_read_b128 v[216:219], v14 offset:0
    v_add_f32 v31, v31, v173
    v_fma_f32 v176, v176, s35, -v233
    v_exp_f32 v175, v175
    v_add_f32 v31, v31, v174
    s_waitcnt lgkmcnt(4)
    v_mfma_f32_32x32x16_bf16 v[128:143], v[224:227], v[40:43], v[128:143]
    ds_read_b128 v[220:223], v15 offset:0
    v_cvt_pk_bf16_f32 v199, v174, v175
    v_fma_f32 v177, v177, s35, -v233
    v_exp_f32 v176, v176
    v_add_f32 v31, v31, v175
    s_waitcnt lgkmcnt(4)
    v_mfma_f32_32x32x16_bf16 v[128:143], v[228:231], v[44:47], v[128:143]
    ds_read_b128 v[224:227], v8 offset:8192
    v_fma_f32 v178, v178, s35, -v233
    v_exp_f32 v177, v177
    v_add_f32 v31, v31, v176
    v_cvt_pk_bf16_f32 v200, v176, v177
    s_waitcnt lgkmcnt(4)
    v_mfma_f32_32x32x16_bf16 v[128:143], v[208:211], v[48:51], v[128:143]
    ds_read_b128 v[228:231], v9 offset:8192
    v_fma_f32 v179, v179, s35, -v233
    v_exp_f32 v178, v178
    v_add_f32 v31, v31, v177
    v_fma_f32 v180, v180, s35, -v233
    v_exp_f32 v179, v179
    s_waitcnt lgkmcnt(4)
    v_mfma_f32_32x32x16_bf16 v[128:143], v[212:215], v[52:55], v[128:143]
    ds_read_b128 v[208:211], v10 offset:8192
    v_add_f32 v31, v31, v178
    v_cvt_pk_bf16_f32 v201, v178, v179
    v_fma_f32 v181, v181, s35, -v233
    v_exp_f32 v180, v180
    s_waitcnt lgkmcnt(4)
    v_mfma_f32_32x32x16_bf16 v[128:143], v[216:219], v[56:59], v[128:143]
    ds_read_b128 v[212:215], v11 offset:8192
    v_add_f32 v31, v31, v179
    v_fma_f32 v182, v182, s35, -v233
    v_exp_f32 v181, v181
    s_waitcnt lgkmcnt(4)
    v_mfma_f32_32x32x16_bf16 v[128:143], v[220:223], v[60:63], v[128:143]
    ds_read_b128 v[216:219], v12 offset:8192
    v_add_f32 v31, v31, v180
    v_cvt_pk_bf16_f32 v202, v180, v181
    v_fma_f32 v183, v183, s35, -v233
    v_exp_f32 v182, v182
    s_waitcnt lgkmcnt(4)
    v_mfma_f32_32x32x16_bf16 v[144:159], v[224:227], v[32:35], 0
    ds_read_b128 v[220:223], v13 offset:8192
    v_add_f32 v31, v31, v181
    v_fma_f32 v184, v184, s35, -v233
    v_exp_f32 v183, v183
    v_add_f32 v31, v31, v182
    v_cvt_pk_bf16_f32 v203, v182, v183
    s_waitcnt lgkmcnt(4)
    v_mfma_f32_32x32x16_bf16 v[144:159], v[228:231], v[36:39], v[144:159]
    ds_read_b128 v[224:227], v14 offset:8192
    v_fma_f32 v185, v185, s35, -v233
    v_exp_f32 v184, v184
    v_add_f32 v31, v31, v183
    v_fma_f32 v186, v186, s35, -v233
    s_waitcnt lgkmcnt(4)
    v_mfma_f32_32x32x16_bf16 v[144:159], v[208:211], v[40:43], v[144:159]
    ds_read_b128 v[228:231], v15 offset:8192
    v_exp_f32 v185, v185
    v_add_f32 v31, v31, v184
    v_cvt_pk_bf16_f32 v204, v184, v185
    v_fma_f32 v187, v187, s35, -v233
    s_waitcnt lgkmcnt(4)
    v_mfma_f32_32x32x16_bf16 v[144:159], v[212:215], v[44:47], v[144:159]
    ds_read_b64_tr_b16 v[208:209], v16 offset:32768
    ds_read_b64_tr_b16 v[210:211], v16 offset:34816
    v_exp_f32 v186, v186
    v_add_f32 v31, v31, v185
    v_fma_f32 v188, v188, s35, -v233
    v_exp_f32 v187, v187
    s_waitcnt lgkmcnt(5)
    v_mfma_f32_32x32x16_bf16 v[144:159], v[216:219], v[48:51], v[144:159]
    ds_read_b64_tr_b16 v[212:213], v16 offset:36864
    ds_read_b64_tr_b16 v[214:215], v16 offset:38912
    v_add_f32 v31, v31, v186
    v_cvt_pk_bf16_f32 v205, v186, v187
    v_fma_f32 v189, v189, s35, -v233
    v_exp_f32 v188, v188
    s_waitcnt lgkmcnt(6)
    v_mfma_f32_32x32x16_bf16 v[144:159], v[220:223], v[52:55], v[144:159]
    ds_read_b64_tr_b16 v[216:217], v16 offset:40960
    ds_read_b64_tr_b16 v[218:219], v16 offset:43008
    v_add_f32 v31, v31, v187
    v_fma_f32 v190, v190, s35, -v233
    v_exp_f32 v189, v189
    v_add_f32 v31, v31, v188
    s_waitcnt lgkmcnt(7)
    v_mfma_f32_32x32x16_bf16 v[144:159], v[224:227], v[56:59], v[144:159]
    ds_read_b64_tr_b16 v[220:221], v16 offset:45056
    ds_read_b64_tr_b16 v[222:223], v16 offset:47104
    v_cvt_pk_bf16_f32 v206, v188, v189
    v_fma_f32 v191, v191, s35, -v233
    v_exp_f32 v190, v190
    v_add_f32 v31, v31, v189
    s_waitcnt lgkmcnt(8)
    v_mfma_f32_32x32x16_bf16 v[144:159], v[228:231], v[60:63], v[144:159]
    ds_read_b64_tr_b16 v[224:225], v17 offset:32768
    ds_read_b64_tr_b16 v[226:227], v17 offset:34816
    v_exp_f32 v191, v191
    v_add_f32 v31, v31, v190
    v_cvt_pk_bf16_f32 v207, v190, v191
    v_add_f32 v31, v31, v191
    s_nop 0
    s_waitcnt vmcnt(8)
    s_barrier
    s_waitcnt lgkmcnt(8)
    v_mfma_f32_32x32x16_bf16 v[64:79], v[208:211], v[192:195], v[64:79]
    ds_read_b64_tr_b16 v[228:229], v17 offset:36864
    ds_read_b64_tr_b16 v[230:231], v17 offset:38912
    v_max3_f32 v2, v128, v129, v130
    v_max3_f32 v3, v131, v132, v133
    v_max3_f32 v4, v134, v135, v136
    v_max3_f32 v5, v137, v138, v139
    v_max3_f32 v2, v2, v140, v141
    v_max3_f32 v3, v3, v142, v143
    s_waitcnt lgkmcnt(8)
    v_mfma_f32_32x32x16_bf16 v[64:79], v[212:215], v[196:199], v[64:79]
    ds_read_b64_tr_b16 v[208:209], v17 offset:40960
    ds_read_b64_tr_b16 v[210:211], v17 offset:43008
    s_add_u32 m0, s38, 0
    s_nop 0
    buffer_load_dwordx4 v24, s[16:19], s36 offen offset:0 nt lds
    v_max3_f32 v4, v4, v144, v145
    v_max3_f32 v5, v5, v146, v147
    v_max3_f32 v2, v2, v148, v149
    v_max3_f32 v3, v3, v150, v151
    v_max3_f32 v4, v4, v152, v153
    s_waitcnt lgkmcnt(8)
    v_mfma_f32_32x32x16_bf16 v[64:79], v[216:219], v[200:203], v[64:79]
    ds_read_b64_tr_b16 v[212:213], v17 offset:45056
    ds_read_b64_tr_b16 v[214:215], v17 offset:47104
    v_max3_f32 v5, v5, v154, v155
    v_max3_f32 v2, v2, v156, v157
    v_max3_f32 v3, v3, v158, v159
    v_max3_f32 v2, v2, v3, v4
    v_max_f32 v2, v2, v5
    s_waitcnt lgkmcnt(8)
    v_mfma_f32_32x32x16_bf16 v[64:79], v[220:223], v[204:207], v[64:79]
    ds_read_b64_tr_b16 v[216:217], v18 offset:32768
    ds_read_b64_tr_b16 v[218:219], v18 offset:34816
    buffer_load_dwordx4 v25, s[16:19], s36 offen offset:1024 nt lds
    s_add_u32 s36, s36, 16384
    v_mov_b32 v3, v2
    s_nop 1
    v_permlane32_swap_b32 v2, v3
    v_max_f32 v2, v2, v3
    v_sub_f32 v3, v2, v30
    s_waitcnt lgkmcnt(8)
    v_mfma_f32_32x32x16_bf16 v[80:95], v[224:227], v[192:195], v[80:95]
    ds_read_b64_tr_b16 v[220:221], v18 offset:36864
    ds_read_b64_tr_b16 v[222:223], v18 offset:38912
    v_cmp_lt_f32 vcc, s62, v3
    s_cbranch_vccnz L_rs1_8
    L_bk1_8:
    v_fma_f32 v128, v128, s35, -v233
    v_fma_f32 v129, v129, s35, -v233
    v_exp_f32 v128, v128
    s_waitcnt lgkmcnt(8)
    v_mfma_f32_32x32x16_bf16 v[80:95], v[228:231], v[196:199], v[80:95]
    ds_read_b64_tr_b16 v[224:225], v18 offset:40960
    ds_read_b64_tr_b16 v[226:227], v18 offset:43008
    s_add_u32 m0, s39, 16384
    s_nop 0
    buffer_load_dwordx4 v26, s[20:23], s37 offen offset:0 nt lds
    v_fma_f32 v130, v130, s35, -v233
    v_exp_f32 v129, v129
    v_add_f32 v31, v31, v128
    s_waitcnt lgkmcnt(8)
    v_mfma_f32_32x32x16_bf16 v[80:95], v[208:211], v[200:203], v[80:95]
    ds_read_b64_tr_b16 v[228:229], v18 offset:45056
    ds_read_b64_tr_b16 v[230:231], v18 offset:47104
    v_fma_f32 v131, v131, s35, -v233
    v_exp_f32 v130, v130
    v_add_f32 v31, v31, v129
    v_fma_f32 v132, v132, s35, -v233
    s_waitcnt lgkmcnt(8)
    v_mfma_f32_32x32x16_bf16 v[80:95], v[212:215], v[204:207], v[80:95]
    ds_read_b64_tr_b16 v[208:209], v19 offset:32768
    ds_read_b64_tr_b16 v[210:211], v19 offset:34816
    buffer_load_dwordx4 v26, s[20:23], s37 offen offset:1024 nt lds
    s_add_u32 s37, s37, 16384
    v_exp_f32 v131, v131
    v_add_f32 v31, v31, v130
    v_fma_f32 v133, v133, s35, -v233
    v_exp_f32 v132, v132
    s_waitcnt lgkmcnt(8)
    v_mfma_f32_32x32x16_bf16 v[96:111], v[216:219], v[192:195], v[96:111]
    ds_read_b64_tr_b16 v[212:213], v19 offset:36864
    ds_read_b64_tr_b16 v[214:215], v19 offset:38912
    v_add_f32 v31, v31, v131
    v_fma_f32 v134, v134, s35, -v233
    v_exp_f32 v133, v133
    v_add_f32 v31, v31, v132
    s_waitcnt lgkmcnt(8)
    v_mfma_f32_32x32x16_bf16 v[96:111], v[220:223], v[196:199], v[96:111]
    ds_read_b64_tr_b16 v[216:217], v19 offset:40960
    ds_read_b64_tr_b16 v[218:219], v19 offset:43008
    v_fma_f32 v135, v135, s35, -v233
    v_exp_f32 v134, v134
    v_add_f32 v31, v31, v133
    v_fma_f32 v136, v136, s35, -v233
    s_waitcnt lgkmcnt(8)
    v_mfma_f32_32x32x16_bf16 v[96:111], v[224:227], v[200:203], v[96:111]
    ds_read_b64_tr_b16 v[220:221], v19 offset:45056
    ds_read_b64_tr_b16 v[222:223], v19 offset:47104
    v_exp_f32 v135, v135
    v_add_f32 v31, v31, v134
    v_fma_f32 v137, v137, s35, -v233
    v_exp_f32 v136, v136
    s_waitcnt lgkmcnt(8)
    v_mfma_f32_32x32x16_bf16 v[96:111], v[228:231], v[204:207], v[96:111]
    ds_read_b128 v[224:227], v8 offset:16384
    v_add_f32 v31, v31, v135
    v_fma_f32 v138, v138, s35, -v233
    v_exp_f32 v137, v137
    s_waitcnt lgkmcnt(7)
    v_mfma_f32_32x32x16_bf16 v[112:127], v[208:211], v[192:195], v[112:127]
    ds_read_b128 v[228:231], v9 offset:16384
    v_add_f32 v31, v31, v136
    v_fma_f32 v139, v139, s35, -v233
    v_exp_f32 v138, v138
    v_add_f32 v31, v31, v137
    v_fma_f32 v140, v140, s35, -v233
    s_waitcnt lgkmcnt(6)
    v_mfma_f32_32x32x16_bf16 v[112:127], v[212:215], v[196:199], v[112:127]
    ds_read_b128 v[208:211], v10 offset:16384
    v_exp_f32 v139, v139
    v_add_f32 v31, v31, v138
    v_fma_f32 v141, v141, s35, -v233
    v_exp_f32 v140, v140
    s_waitcnt lgkmcnt(5)
    v_mfma_f32_32x32x16_bf16 v[112:127], v[216:219], v[200:203], v[112:127]
    ds_read_b128 v[212:215], v11 offset:16384
    v_add_f32 v31, v31, v139
    v_fma_f32 v142, v142, s35, -v233
    v_exp_f32 v141, v141
    s_waitcnt lgkmcnt(4)
    v_mfma_f32_32x32x16_bf16 v[112:127], v[220:223], v[204:207], v[112:127]
    ds_read_b128 v[216:219], v12 offset:16384
    s_cmp_lg_u32 s61, 0
    s_cbranch_scc1 L_rs2_8
L_bk2_8:
    v_cvt_pk_bf16_f32 v192, v128, v129
    v_cvt_pk_bf16_f32 v193, v130, v131
    v_cvt_pk_bf16_f32 v194, v132, v133
    v_cvt_pk_bf16_f32 v195, v134, v135
    v_cvt_pk_bf16_f32 v196, v136, v137
    s_waitcnt lgkmcnt(4)
    v_mfma_f32_32x32x16_bf16 v[160:175], v[224:227], v[32:35], 0
    ds_read_b128 v[220:223], v13 offset:16384
    v_cvt_pk_bf16_f32 v197, v138, v139
    v_cvt_pk_bf16_f32 v198, v140, v141
    v_add_f32 v31, v31, v140
    v_fma_f32 v143, v143, s35, -v233
    v_exp_f32 v142, v142
    s_waitcnt lgkmcnt(4)
    v_mfma_f32_32x32x16_bf16 v[160:175], v[228:231], v[36:39], v[160:175]
    ds_read_b128 v[224:227], v14 offset:16384
    v_add_f32 v31, v31, v141
    v_fma_f32 v144, v144, s35, -v233
    v_exp_f32 v143, v143
    v_add_f32 v31, v31, v142
    s_waitcnt lgkmcnt(4)
    v_mfma_f32_32x32x16_bf16 v[160:175], v[208:211], v[40:43], v[160:175]
    ds_read_b128 v[228:231], v15 offset:16384
    v_cvt_pk_bf16_f32 v199, v142, v143
    v_fma_f32 v145, v145, s35, -v233
    v_exp_f32 v144, v144
    v_add_f32 v31, v31, v143
    s_waitcnt lgkmcnt(4)
    v_mfma_f32_32x32x16_bf16 v[160:175], v[212:215], v[44:47], v[160:175]
    ds_read_b128 v[208:211], v8 offset:24576
    v_fma_f32 v146, v146, s35, -v233
    v_exp_f32 v145, v145
    v_add_f32 v31, v31, v144
    v_cvt_pk_bf16_f32 v200, v144, v145
    s_waitcnt lgkmcnt(4)
    v_mfma_f32_32x32x16_bf16 v[160:175], v[216:219], v[48:51], v[160:175]
    ds_read_b128 v[212:215], v9 offset:24576
    v_fma_f32 v147, v147, s35, -v233
    v_exp_f32 v146, v146
    v_add_f32 v31, v31, v145
    v_fma_f32 v148, v148, s35, -v233
    v_exp_f32 v147, v147
    s_waitcnt lgkmcnt(4)
    v_mfma_f32_32x32x16_bf16 v[160:175], v[220:223], v[52:55], v[160:175]
    ds_read_b128 v[216:219], v10 offset:24576
    v_add_f32 v31, v31, v146
    v_cvt_pk_bf16_f32 v201, v146, v147
    v_fma_f32 v149, v149, s35, -v233
    v_exp_f32 v148, v148
    s_waitcnt lgkmcnt(4)
    v_mfma_f32_32x32x16_bf16 v[160:175], v[224:227], v[56:59], v[160:175]
    ds_read_b128 v[220:223], v11 offset:24576
    v_add_f32 v31, v31, v147
    v_fma_f32 v150, v150, s35, -v233
    v_exp_f32 v149, v149
    s_waitcnt lgkmcnt(4)
    v_mfma_f32_32x32x16_bf16 v[160:175], v[228:231], v[60:63], v[160:175]
    ds_read_b128 v[224:227], v12 offset:24576
    v_add_f32 v31, v31, v148
    v_cvt_pk_bf16_f32 v202, v148, v149
    v_fma_f32 v151, v151, s35, -v233
    v_exp_f32 v150, v150
    s_waitcnt lgkmcnt(4)
    v_mfma_f32_32x32x16_bf16 v[176:191], v[208:211], v[32:35], 0
    ds_read_b128 v[228:231], v13 offset:24576
    v_add_f32 v31, v31, v149
    v_fma_f32 v152, v152, s35, -v233
    v_exp_f32 v151, v151
    v_add_f32 v31, v31, v150
    v_cvt_pk_bf16_f32 v203, v150, v151
    s_waitcnt lgkmcnt(4)
    v_mfma_f32_32x32x16_bf16 v[176:191], v[212:215], v[36:39], v[176:191]
    ds_read_b128 v[208:211], v14 offset:24576
    v_fma_f32 v153, v153, s35, -v233
    v_exp_f32 v152, v152
    v_add_f32 v31, v31, v151
    v_fma_f32 v154, v154, s35, -v233
    s_waitcnt lgkmcnt(4)
    v_mfma_f32_32x32x16_bf16 v[176:191], v[216:219], v[40:43], v[176:191]
    ds_read_b128 v[212:215], v15 offset:24576
    v_exp_f32 v153, v153
    v_add_f32 v31, v31, v152
    v_cvt_pk_bf16_f32 v204, v152, v153
    v_fma_f32 v155, v155, s35, -v233
    s_waitcnt lgkmcnt(4)
    v_mfma_f32_32x32x16_bf16 v[176:191], v[220:223], v[44:47], v[176:191]
    ds_read_b64_tr_b16 v[216:217], v16 offset:49152
    ds_read_b64_tr_b16 v[218:219], v16 offset:51200
    v_exp_f32 v154, v154
    v_add_f32 v31, v31, v153
    v_fma_f32 v156, v156, s35, -v233
    v_exp_f32 v155, v155
    s_waitcnt lgkmcnt(5)
    v_mfma_f32_32x32x16_bf16 v[176:191], v[224:227], v[48:51], v[176:191]
    ds_read_b64_tr_b16 v[220:221], v16 offset:53248
    ds_read_b64_tr_b16 v[222:223], v16 offset:55296
    v_add_f32 v31, v31, v154
    v_cvt_pk_bf16_f32 v205, v154, v155
    v_fma_f32 v157, v157, s35, -v233
    v_exp_f32 v156, v156
    s_waitcnt lgkmcnt(6)
    v_mfma_f32_32x32x16_bf16 v[176:191], v[228:231], v[52:55], v[176:191]
    ds_read_b64_tr_b16 v[224:225], v16 offset:57344
    ds_read_b64_tr_b16 v[226:227], v16 offset:59392
    v_add_f32 v31, v31, v155
    v_fma_f32 v158, v158, s35, -v233
    v_exp_f32 v157, v157
    v_add_f32 v31, v31, v156
    s_waitcnt lgkmcnt(7)
    v_mfma_f32_32x32x16_bf16 v[176:191], v[208:211], v[56:59], v[176:191]
    ds_read_b64_tr_b16 v[228:229], v16 offset:61440
    ds_read_b64_tr_b16 v[230:231], v16 offset:63488
    v_cvt_pk_bf16_f32 v206, v156, v157
    v_fma_f32 v159, v159, s35, -v233
    v_exp_f32 v158, v158
    v_add_f32 v31, v31, v157
    s_waitcnt lgkmcnt(8)
    v_mfma_f32_32x32x16_bf16 v[176:191], v[212:215], v[60:63], v[176:191]
    ds_read_b64_tr_b16 v[208:209], v17 offset:49152
    ds_read_b64_tr_b16 v[210:211], v17 offset:51200
    v_exp_f32 v159, v159
    v_add_f32 v31, v31, v158
    v_cvt_pk_bf16_f32 v207, v158, v159
    v_add_f32 v31, v31, v159
    s_nop 0
    s_waitcnt vmcnt(8)
    s_barrier
    s_waitcnt lgkmcnt(8)
    v_mfma_f32_32x32x16_bf16 v[64:79], v[216:219], v[192:195], v[64:79]
    ds_read_b64_tr_b16 v[212:213], v17 offset:53248
    ds_read_b64_tr_b16 v[214:215], v17 offset:55296
    v_max3_f32 v2, v160, v161, v162
    v_max3_f32 v3, v163, v164, v165
    v_max3_f32 v4, v166, v167, v168
    v_max3_f32 v5, v169, v170, v171
    v_max3_f32 v2, v2, v172, v173
    v_max3_f32 v3, v3, v174, v175
    s_waitcnt lgkmcnt(8)
    v_mfma_f32_32x32x16_bf16 v[64:79], v[220:223], v[196:199], v[64:79]
    ds_read_b64_tr_b16 v[216:217], v17 offset:57344
    ds_read_b64_tr_b16 v[218:219], v17 offset:59392
    s_add_u32 m0, s38, 16384
    s_nop 0
    buffer_load_dwordx4 v24, s[16:19], s36 offen offset:0 nt lds
    v_max3_f32 v4, v4, v176, v177
    v_max3_f32 v5, v5, v178, v179
    v_max3_f32 v2, v2, v180, v181
    v_max3_f32 v3, v3, v182, v183
    v_max3_f32 v4, v4, v184, v185
    s_waitcnt lgkmcnt(8)
    v_mfma_f32_32x32x16_bf16 v[64:79], v[224:227], v[200:203], v[64:79]
    ds_read_b64_tr_b16 v[220:221], v17 offset:61440
    ds_read_b64_tr_b16 v[222:223], v17 offset:63488
    v_max3_f32 v5, v5, v186, v187
    v_max3_f32 v2, v2, v188, v189
    v_max3_f32 v3, v3, v190, v191
    v_max3_f32 v2, v2, v3, v4
    v_max_f32 v2, v2, v5
    s_waitcnt lgkmcnt(8)
    v_mfma_f32_32x32x16_bf16 v[64:79], v[228:231], v[204:207], v[64:79]
    ds_read_b64_tr_b16 v[224:225], v18 offset:49152
    ds_read_b64_tr_b16 v[226:227], v18 offset:51200
    buffer_load_dwordx4 v25, s[16:19], s36 offen offset:1024 nt lds
    s_add_u32 s36, s36, 16384
    v_mov_b32 v3, v2
    s_nop 1
    v_permlane32_swap_b32 v2, v3
    v_max_f32 v2, v2, v3
    v_sub_f32 v3, v2, v30
    s_waitcnt lgkmcnt(8)
    v_mfma_f32_32x32x16_bf16 v[80:95], v[208:211], v[192:195], v[80:95]
    ds_read_b64_tr_b16 v[228:229], v18 offset:53248
    ds_read_b64_tr_b16 v[230:231], v18 offset:55296
    v_cmp_lt_f32 vcc, s62, v3
    s_cbranch_vccnz L_rs1_9
    L_bk1_9:
    v_fma_f32 v160, v160, s35, -v233
    v_fma_f32 v161, v161, s35, -v233
    v_exp_f32 v160, v160
    s_waitcnt lgkmcnt(8)
    v_mfma_f32_32x32x16_bf16 v[80:95], v[212:215], v[196:199], v[80:95]
    ds_read_b64_tr_b16 v[208:209], v18 offset:57344
    ds_read_b64_tr_b16 v[210:211], v18 offset:59392
    s_add_u32 m0, s39, 32768
    s_nop 0
    buffer_load_dwordx4 v26, s[20:23], s37 offen offset:0 nt lds
    v_fma_f32 v162, v162, s35, -v233
    v_exp_f32 v161, v161
    v_add_f32 v31, v31, v160
    s_waitcnt lgkmcnt(8)
    v_mfma_f32_32x32x16_bf16 v[80:95], v[216:219], v[200:203], v[80:95]
    ds_read_b64_tr_b16 v[212:213], v18 offset:61440
    ds_read_b64_tr_b16 v[214:215], v18 offset:63488
    v_fma_f32 v163, v163, s35, -v233
    v_exp_f32 v162, v162
    v_add_f32 v31, v31, v161
    v_fma_f32 v164, v164, s35, -v233
    s_waitcnt lgkmcnt(8)
    v_mfma_f32_32x32x16_bf16 v[80:95], v[220:223], v[204:207], v[80:95]
    ds_read_b64_tr_b16 v[216:217], v19 offset:49152
    ds_read_b64_tr_b16 v[218:219], v19 offset:51200
    buffer_load_dwordx4 v26, s[20:23], s37 offen offset:1024 nt lds
    s_add_u32 s37, s37, 16384
    v_exp_f32 v163, v163
    v_add_f32 v31, v31, v162
    v_fma_f32 v165, v165, s35, -v233
    v_exp_f32 v164, v164
    s_waitcnt lgkmcnt(8)
    v_mfma_f32_32x32x16_bf16 v[96:111], v[224:227], v[192:195], v[96:111]
    ds_read_b64_tr_b16 v[220:221], v19 offset:53248
    ds_read_b64_tr_b16 v[222:223], v19 offset:55296
    v_add_f32 v31, v31, v163
    v_fma_f32 v166, v166, s35, -v233
    v_exp_f32 v165, v165
    v_add_f32 v31, v31, v164
    s_waitcnt lgkmcnt(8)
    v_mfma_f32_32x32x16_bf16 v[96:111], v[228:231], v[196:199], v[96:111]
    ds_read_b64_tr_b16 v[224:225], v19 offset:57344
    ds_read_b64_tr_b16 v[226:227], v19 offset:59392
    v_fma_f32 v167, v167, s35, -v233
    v_exp_f32 v166, v166
    v_add_f32 v31, v31, v165
    v_fma_f32 v168, v168, s35, -v233
    s_waitcnt lgkmcnt(8)
    v_mfma_f32_32x32x16_bf16 v[96:111], v[208:211], v[200:203], v[96:111]
    ds_read_b64_tr_b16 v[228:229], v19 offset:61440
    ds_read_b64_tr_b16 v[230:231], v19 offset:63488
    v_exp_f32 v167, v167
    v_add_f32 v31, v31, v166
    v_fma_f32 v169, v169, s35, -v233
    v_exp_f32 v168, v168
    s_waitcnt lgkmcnt(8)
    v_mfma_f32_32x32x16_bf16 v[96:111], v[212:215], v[204:207], v[96:111]
    ds_read_b128 v[208:211], v8 offset:32768
    v_add_f32 v31, v31, v167
    v_fma_f32 v170, v170, s35, -v233
    v_exp_f32 v169, v169
    s_waitcnt lgkmcnt(7)
    v_mfma_f32_32x32x16_bf16 v[112:127], v[216:219], v[192:195], v[112:127]
    ds_read_b128 v[212:215], v9 offset:32768
    v_add_f32 v31, v31, v168
    v_fma_f32 v171, v171, s35, -v233
    v_exp_f32 v170, v170
    v_add_f32 v31, v31, v169
    v_fma_f32 v172, v172, s35, -v233
    s_waitcnt lgkmcnt(6)
    v_mfma_f32_32x32x16_bf16 v[112:127], v[220:223], v[196:199], v[112:127]
    ds_read_b128 v[216:219], v10 offset:32768
    v_exp_f32 v171, v171
    v_add_f32 v31, v31, v170
    v_fma_f32 v173, v173, s35, -v233
    v_exp_f32 v172, v172
    s_waitcnt lgkmcnt(5)
    v_mfma_f32_32x32x16_bf16 v[112:127], v[224:227], v[200:203], v[112:127]
    ds_read_b128 v[220:223], v11 offset:32768
    v_add_f32 v31, v31, v171
    v_fma_f32 v174, v174, s35, -v233
    v_exp_f32 v173, v173
    s_waitcnt lgkmcnt(4)
    v_mfma_f32_32x32x16_bf16 v[112:127], v[228:231], v[204:207], v[112:127]
    ds_read_b128 v[224:227], v12 offset:32768
    s_cmp_lg_u32 s61, 0
    s_cbranch_scc1 L_rs2_9
L_bk2_9:
    v_cvt_pk_bf16_f32 v192, v160, v161
    v_cvt_pk_bf16_f32 v193, v162, v163
    v_cvt_pk_bf16_f32 v194, v164, v165
    v_cvt_pk_bf16_f32 v195, v166, v167
    v_cvt_pk_bf16_f32 v196, v168, v169
    s_waitcnt lgkmcnt(4)
    v_mfma_f32_32x32x16_bf16 v[128:143], v[208:211], v[32:35], 0
    ds_read_b128 v[228:231], v13 offset:32768
    v_cvt_pk_bf16_f32 v197, v170, v171
    v_cvt_pk_bf16_f32 v198, v172, v173
    v_add_f32 v31, v31, v172
    v_fma_f32 v175, v175, s35, -v233
    v_exp_f32 v174, v174
    s_waitcnt lgkmcnt(4)
    v_mfma_f32_32x32x16_bf16 v[128:143], v[212:215], v[36:39], v[128:143]
    ds_read_b128 v[208:211], v14 offset:32768
    v_add_f32 v31, v31, v173
    v_fma_f32 v176, v176, s35, -v233
    v_exp_f32 v175, v175
    v_add_f32 v31, v31, v174
    s_waitcnt lgkmcnt(4)
    v_mfma_f32_32x32x16_bf16 v[128:143], v[216:219], v[40:43], v[128:143]
    ds_read_b128 v[212:215], v15 offset:32768
    v_cvt_pk_bf16_f32 v199, v174, v175
    v_fma_f32 v177, v177, s35, -v233
    v_exp_f32 v176, v176
    v_add_f32 v31, v31, v175
    s_waitcnt lgkmcnt(4)
    v_mfma_f32_32x32x16_bf16 v[128:143], v[220:223], v[44:47], v[128:143]
    ds_read_b128 v[216:219], v8 offset:40960
    v_fma_f32 v178, v178, s35, -v233
    v_exp_f32 v177, v177
    v_add_f32 v31, v31, v176
    v_cvt_pk_bf16_f32 v200, v176, v177
    s_waitcnt lgkmcnt(4)
    v_mfma_f32_32x32x16_bf16 v[128:143], v[224:227], v[48:51], v[128:143]
    ds_read_b128 v[220:223], v9 offset:40960
    v_fma_f32 v179, v179, s35, -v233
    v_exp_f32 v178, v178
    v_add_f32 v31, v31, v177
    v_fma_f32 v180, v180, s35, -v233
    v_exp_f32 v179, v179
    s_waitcnt lgkmcnt(4)
    v_mfma_f32_32x32x16_bf16 v[128:143], v[228:231], v[52:55], v[128:143]
    ds_read_b128 v[224:227], v10 offset:40960
    v_add_f32 v31, v31, v178
    v_cvt_pk_bf16_f32 v201, v178, v179
    v_fma_f32 v181, v181, s35, -v233
    v_exp_f32 v180, v180
    s_waitcnt lgkmcnt(4)
    v_mfma_f32_32x32x16_bf16 v[128:143], v[208:211], v[56:59], v[128:143]
    ds_read_b128 v[228:231], v11 offset:40960
    v_add_f32 v31, v31, v179
    v_fma_f32 v182, v182, s35, -v233
    v_exp_f32 v181, v181
    s_waitcnt lgkmcnt(4)
    v_mfma_f32_32x32x16_bf16 v[128:143], v[212:215], v[60:63], v[128:143]
    ds_read_b128 v[208:211], v12 offset:40960
    v_add_f32 v31, v31, v180
    v_cvt_pk_bf16_f32 v202, v180, v181
    v_fma_f32 v183, v183, s35, -v233
    v_exp_f32 v182, v182
    s_waitcnt lgkmcnt(4)
    v_mfma_f32_32x32x16_bf16 v[144:159], v[216:219], v[32:35], 0
    ds_read_b128 v[212:215], v13 offset:40960
    v_add_f32 v31, v31, v181
    v_fma_f32 v184, v184, s35, -v233
    v_exp_f32 v183, v183
    v_add_f32 v31, v31, v182
    v_cvt_pk_bf16_f32 v203, v182, v183
    s_waitcnt lgkmcnt(4)
    v_mfma_f32_32x32x16_bf16 v[144:159], v[220:223], v[36:39], v[144:159]
    ds_read_b128 v[216:219], v14 offset:40960
    v_fma_f32 v185, v185, s35, -v233
    v_exp_f32 v184, v184
    v_add_f32 v31, v31, v183
    v_fma_f32 v186, v186, s35, -v233
    s_waitcnt lgkmcnt(4)
    v_mfma_f32_32x32x16_bf16 v[144:159], v[224:227], v[40:43], v[144:159]
    ds_read_b128 v[220:223], v15 offset:40960
    v_exp_f32 v185, v185
    v_add_f32 v31, v31, v184
    v_cvt_pk_bf16_f32 v204, v184, v185
    v_fma_f32 v187, v187, s35, -v233
    s_waitcnt lgkmcnt(4)
    v_mfma_f32_32x32x16_bf16 v[144:159], v[228:231], v[44:47], v[144:159]
    ds_read_b64_tr_b16 v[224:225], v235 offset:0
    ds_read_b64_tr_b16 v[226:227], v235 offset:2048
    v_exp_f32 v186, v186
    v_add_f32 v31, v31, v185
    v_fma_f32 v188, v188, s35, -v233
    v_exp_f32 v187, v187
    s_waitcnt lgkmcnt(5)
    v_mfma_f32_32x32x16_bf16 v[144:159], v[208:211], v[48:51], v[144:159]
    ds_read_b64_tr_b16 v[228:229], v235 offset:4096
    ds_read_b64_tr_b16 v[230:231], v235 offset:6144
    v_add_f32 v31, v31, v186
    v_cvt_pk_bf16_f32 v205, v186, v187
    v_fma_f32 v189, v189, s35, -v233
    v_exp_f32 v188, v188
    s_waitcnt lgkmcnt(6)
    v_mfma_f32_32x32x16_bf16 v[144:159], v[212:215], v[52:55], v[144:159]
    ds_read_b64_tr_b16 v[208:209], v235 offset:8192
    ds_read_b64_tr_b16 v[210:211], v235 offset:10240
    v_add_f32 v31, v31, v187
    v_fma_f32 v190, v190, s35, -v233
    v_exp_f32 v189, v189
    v_add_f32 v31, v31, v188
    s_waitcnt lgkmcnt(7)
    v_mfma_f32_32x32x16_bf16 v[144:159], v[216:219], v[56:59], v[144:159]
    ds_read_b64_tr_b16 v[212:213], v235 offset:12288
    ds_read_b64_tr_b16 v[214:215], v235 offset:14336
    v_cvt_pk_bf16_f32 v206, v188, v189
    v_fma_f32 v191, v191, s35, -v233
    v_exp_f32 v190, v190
    v_add_f32 v31, v31, v189
    s_waitcnt lgkmcnt(8)
    v_mfma_f32_32x32x16_bf16 v[144:159], v[220:223], v[60:63], v[144:159]
    ds_read_b64_tr_b16 v[216:217], v236 offset:0
    ds_read_b64_tr_b16 v[218:219], v236 offset:2048
    v_exp_f32 v191, v191
    v_add_f32 v31, v31, v190
    v_cvt_pk_bf16_f32 v207, v190, v191
    v_add_f32 v31, v31, v191
    s_nop 0
    s_waitcnt vmcnt(8)
    s_barrier
    s_waitcnt lgkmcnt(8)
    v_mfma_f32_32x32x16_bf16 v[64:79], v[224:227], v[192:195], v[64:79]
    ds_read_b64_tr_b16 v[220:221], v236 offset:4096
    ds_read_b64_tr_b16 v[222:223], v236 offset:6144
    v_max3_f32 v2, v128, v129, v130
    v_max3_f32 v3, v131, v132, v133
    v_max3_f32 v4, v134, v135, v136
    v_max3_f32 v5, v137, v138, v139
    v_max3_f32 v2, v2, v140, v141
    v_max3_f32 v3, v3, v142, v143
    s_waitcnt lgkmcnt(8)
    v_mfma_f32_32x32x16_bf16 v[64:79], v[228:231], v[196:199], v[64:79]
    ds_read_b64_tr_b16 v[224:225], v236 offset:8192
    ds_read_b64_tr_b16 v[226:227], v236 offset:10240
    s_add_u32 m0, s38, 32768
    s_nop 0
    buffer_load_dwordx4 v24, s[16:19], s36 offen offset:0 nt lds
    v_max3_f32 v4, v4, v144, v145
    v_max3_f32 v5, v5, v146, v147
    v_max3_f32 v2, v2, v148, v149
    v_max3_f32 v3, v3, v150, v151
    v_max3_f32 v4, v4, v152, v153
    s_waitcnt lgkmcnt(8)
    v_mfma_f32_32x32x16_bf16 v[64:79], v[208:211], v[200:203], v[64:79]
    ds_read_b64_tr_b16 v[228:229], v236 offset:12288
    ds_read_b64_tr_b16 v[230:231], v236 offset:14336
    v_max3_f32 v5, v5, v154, v155
    v_max3_f32 v2, v2, v156, v157
    v_max3_f32 v3, v3, v158, v159
    v_max3_f32 v2, v2, v3, v4
    v_max_f32 v2, v2, v5
    s_waitcnt lgkmcnt(8)
    v_mfma_f32_32x32x16_bf16 v[64:79], v[212:215], v[204:207], v[64:79]
    ds_read_b64_tr_b16 v[208:209], v237 offset:0
    ds_read_b64_tr_b16 v[210:211], v237 offset:2048
    buffer_load_dwordx4 v25, s[16:19], s36 offen offset:1024 nt lds
    s_add_u32 s36, s36, 16384
    v_mov_b32 v3, v2
    s_nop 1
    v_permlane32_swap_b32 v2, v3
    v_max_f32 v2, v2, v3
    v_sub_f32 v3, v2, v30
    s_waitcnt lgkmcnt(8)
    v_mfma_f32_32x32x16_bf16 v[80:95], v[216:219], v[192:195], v[80:95]
    ds_read_b64_tr_b16 v[212:213], v237 offset:4096
    ds_read_b64_tr_b16 v[214:215], v237 offset:6144
    v_cmp_lt_f32 vcc, s62, v3
    s_cbranch_vccnz L_rs1_10
    L_bk1_10:
    v_fma_f32 v128, v128, s35, -v233
    v_fma_f32 v129, v129, s35, -v233
    v_exp_f32 v128, v128
    s_waitcnt lgkmcnt(8)
    v_mfma_f32_32x32x16_bf16 v[80:95], v[220:223], v[196:199], v[80:95]
    ds_read_b64_tr_b16 v[216:217], v237 offset:8192
    ds_read_b64_tr_b16 v[218:219], v237 offset:10240
    s_add_u32 m0, s39, 49152
    s_nop 0
    buffer_load_dwordx4 v26, s[20:23], s37 offen offset:0 nt lds
    v_fma_f32 v130, v130, s35, -v233
    v_exp_f32 v129, v129
    v_add_f32 v31, v31, v128
    s_waitcnt lgkmcnt(8)
    v_mfma_f32_32x32x16_bf16 v[80:95], v[224:227], v[200:203], v[80:95]
    ds_read_b64_tr_b16 v[220:221], v237 offset:12288
    ds_read_b64_tr_b16 v[222:223], v237 offset:14336
    v_fma_f32 v131, v131, s35, -v233
    v_exp_f32 v130, v130
    v_add_f32 v31, v31, v129
    v_fma_f32 v132, v132, s35, -v233
    s_waitcnt lgkmcnt(8)
    v_mfma_f32_32x32x16_bf16 v[80:95], v[228:231], v[204:207], v[80:95]
    ds_read_b64_tr_b16 v[224:225], v238 offset:0
    ds_read_b64_tr_b16 v[226:227], v238 offset:2048
    buffer_load_dwordx4 v26, s[20:23], s37 offen offset:1024 nt lds
    s_add_u32 s37, s37, 16384
    v_exp_f32 v131, v131
    v_add_f32 v31, v31, v130
    v_fma_f32 v133, v133, s35, -v233
    v_exp_f32 v132, v132
    s_waitcnt lgkmcnt(8)
    v_mfma_f32_32x32x16_bf16 v[96:111], v[208:211], v[192:195], v[96:111]
    ds_read_b64_tr_b16 v[228:229], v238 offset:4096
    ds_read_b64_tr_b16 v[230:231], v238 offset:6144
    v_add_f32 v31, v31, v131
    v_fma_f32 v134, v134, s35, -v233
    v_exp_f32 v133, v133
    v_add_f32 v31, v31, v132
    s_waitcnt lgkmcnt(8)
    v_mfma_f32_32x32x16_bf16 v[96:111], v[212:215], v[196:199], v[96:111]
    ds_read_b64_tr_b16 v[208:209], v238 offset:8192
    ds_read_b64_tr_b16 v[210:211], v238 offset:10240
    s_lshl_b32 s54, s34, 11
    s_add_u32 m0, s54, 147456
    v_lshlrev_b32 v27, 4, v1
    v_add_u32 v27, s54, v27
    buffer_load_dwordx4 v27, s[4:7], 0 offen lds
    buffer_load_dwordx4 v27, s[4:7], 0 offen offset:1024 lds
    v_fma_f32 v135, v135, s35, -v233
    v_exp_f32 v134, v134
    v_add_f32 v31, v31, v133
    v_fma_f32 v136, v136, s35, -v233
    s_waitcnt lgkmcnt(8)
    v_mfma_f32_32x32x16_bf16 v[96:111], v[216:219], v[200:203], v[96:111]
    ds_read_b64_tr_b16 v[212:213], v238 offset:12288
    ds_read_b64_tr_b16 v[214:215], v238 offset:14336
    v_exp_f32 v135, v135
    v_add_f32 v31, v31, v134
    v_fma_f32 v137, v137, s35, -v233
    v_exp_f32 v136, v136
    s_waitcnt lgkmcnt(8)
    v_mfma_f32_32x32x16_bf16 v[96:111], v[220:223], v[204:207], v[96:111]
    ds_read_b128 v[216:219], v8 offset:49152
    v_add_f32 v31, v31, v135
    v_fma_f32 v138, v138, s35, -v233
    v_exp_f32 v137, v137
    s_waitcnt lgkmcnt(7)
    v_mfma_f32_32x32x16_bf16 v[112:127], v[224:227], v[192:195], v[112:127]
    ds_read_b128 v[220:223], v9 offset:49152
    v_add_f32 v31, v31, v136
    v_fma_f32 v139, v139, s35, -v233
    v_exp_f32 v138, v138
    v_add_f32 v31, v31, v137
    v_fma_f32 v140, v140, s35, -v233
    s_waitcnt lgkmcnt(6)
    v_mfma_f32_32x32x16_bf16 v[112:127], v[228:231], v[196:199], v[112:127]
    ds_read_b128 v[224:227], v10 offset:49152
    v_exp_f32 v139, v139
    v_add_f32 v31, v31, v138
    v_fma_f32 v141, v141, s35, -v233
    v_exp_f32 v140, v140
    s_waitcnt lgkmcnt(5)
    v_mfma_f32_32x32x16_bf16 v[112:127], v[208:211], v[200:203], v[112:127]
    ds_read_b128 v[228:231], v11 offset:49152
    v_add_f32 v31, v31, v139
    v_fma_f32 v142, v142, s35, -v233
    v_exp_f32 v141, v141
    s_waitcnt lgkmcnt(4)
    v_mfma_f32_32x32x16_bf16 v[112:127], v[212:215], v[204:207], v[112:127]
    ds_read_b128 v[208:211], v12 offset:49152
    s_cmp_lg_u32 s61, 0
    s_cbranch_scc1 L_rs2_10
L_bk2_10:
    v_cvt_pk_bf16_f32 v192, v128, v129
    v_cvt_pk_bf16_f32 v193, v130, v131
    v_cvt_pk_bf16_f32 v194, v132, v133
    v_cvt_pk_bf16_f32 v195, v134, v135
    v_cvt_pk_bf16_f32 v196, v136, v137
    s_waitcnt lgkmcnt(4)
    v_mfma_f32_32x32x16_bf16 v[160:175], v[216:219], v[32:35], 0
    ds_read_b128 v[212:215], v13 offset:49152
    v_cvt_pk_bf16_f32 v197, v138, v139
    v_cvt_pk_bf16_f32 v198, v140, v141
    v_add_f32 v31, v31, v140
    v_fma_f32 v143, v143, s35, -v233
    v_exp_f32 v142, v142
    s_waitcnt lgkmcnt(4)
    v_mfma_f32_32x32x16_bf16 v[160:175], v[220:223], v[36:39], v[160:175]
    ds_read_b128 v[216:219], v14 offset:49152
    v_add_f32 v31, v31, v141
    v_fma_f32 v144, v144, s35, -v233
    v_exp_f32 v143, v143
    v_add_f32 v31, v31, v142
    s_waitcnt lgkmcnt(4)
    v_mfma_f32_32x32x16_bf16 v[160:175], v[224:227], v[40:43], v[160:175]
    ds_read_b128 v[220:223], v15 offset:49152
    v_cvt_pk_bf16_f32 v199, v142, v143
    v_fma_f32 v145, v145, s35, -v233
    v_exp_f32 v144, v144
    v_add_f32 v31, v31, v143
    s_waitcnt lgkmcnt(4)
    v_mfma_f32_32x32x16_bf16 v[160:175], v[228:231], v[44:47], v[160:175]
    ds_read_b128 v[224:227], v8 offset:57344
    v_fma_f32 v146, v146, s35, -v233
    v_exp_f32 v145, v145
    v_add_f32 v31, v31, v144
    v_cvt_pk_bf16_f32 v200, v144, v145
    s_waitcnt lgkmcnt(4)
    v_mfma_f32_32x32x16_bf16 v[160:175], v[208:211], v[48:51], v[160:175]
    ds_read_b128 v[228:231], v9 offset:57344
    v_fma_f32 v147, v147, s35, -v233
    v_exp_f32 v146, v146
    v_add_f32 v31, v31, v145
    v_fma_f32 v148, v148, s35, -v233
    v_exp_f32 v147, v147
    s_waitcnt lgkmcnt(4)
    v_mfma_f32_32x32x16_bf16 v[160:175], v[212:215], v[52:55], v[160:175]
    ds_read_b128 v[208:211], v10 offset:57344
    v_add_f32 v31, v31, v146
    v_cvt_pk_bf16_f32 v201, v146, v147
    v_fma_f32 v149, v149, s35, -v233
    v_exp_f32 v148, v148
    s_waitcnt lgkmcnt(4)
    v_mfma_f32_32x32x16_bf16 v[160:175], v[216:219], v[56:59], v[160:175]
    ds_read_b128 v[212:215], v11 offset:57344
    v_add_f32 v31, v31, v147
    v_fma_f32 v150, v150, s35, -v233
    v_exp_f32 v149, v149
    s_waitcnt lgkmcnt(4)
    v_mfma_f32_32x32x16_bf16 v[160:175], v[220:223], v[60:63], v[160:175]
    ds_read_b128 v[216:219], v12 offset:57344
    v_add_f32 v31, v31, v148
    v_cvt_pk_bf16_f32 v202, v148, v149
    v_fma_f32 v151, v151, s35, -v233
    v_exp_f32 v150, v150
    s_waitcnt lgkmcnt(4)
    v_mfma_f32_32x32x16_bf16 v[176:191], v[224:227], v[32:35], 0
    ds_read_b128 v[220:223], v13 offset:57344
    v_add_f32 v31, v31, v149
    v_fma_f32 v152, v152, s35, -v233
    v_exp_f32 v151, v151
    v_add_f32 v31, v31, v150
    v_cvt_pk_bf16_f32 v203, v150, v151
    s_waitcnt lgkmcnt(4)
    v_mfma_f32_32x32x16_bf16 v[176:191], v[228:231], v[36:39], v[176:191]
    ds_read_b128 v[224:227], v14 offset:57344
    v_fma_f32 v153, v153, s35, -v233
    v_exp_f32 v152, v152
    v_add_f32 v31, v31, v151
    v_fma_f32 v154, v154, s35, -v233
    s_waitcnt lgkmcnt(4)
    v_mfma_f32_32x32x16_bf16 v[176:191], v[208:211], v[40:43], v[176:191]
    ds_read_b128 v[228:231], v15 offset:57344
    v_exp_f32 v153, v153
    v_add_f32 v31, v31, v152
    v_cvt_pk_bf16_f32 v204, v152, v153
    v_fma_f32 v155, v155, s35, -v233
    s_waitcnt lgkmcnt(4)
    v_mfma_f32_32x32x16_bf16 v[176:191], v[212:215], v[44:47], v[176:191]
    ds_read_b64_tr_b16 v[208:209], v16 offset:0
    ds_read_b64_tr_b16 v[210:211], v16 offset:2048
    v_exp_f32 v154, v154
    v_add_f32 v31, v31, v153
    v_fma_f32 v156, v156, s35, -v233
    v_exp_f32 v155, v155
    s_waitcnt lgkmcnt(5)
    v_mfma_f32_32x32x16_bf16 v[176:191], v[216:219], v[48:51], v[176:191]
    ds_read_b64_tr_b16 v[212:213], v16 offset:4096
    ds_read_b64_tr_b16 v[214:215], v16 offset:6144
    v_add_f32 v31, v31, v154
    v_cvt_pk_bf16_f32 v205, v154, v155
    v_fma_f32 v157, v157, s35, -v233
    v_exp_f32 v156, v156
    s_waitcnt lgkmcnt(6)
    v_mfma_f32_32x32x16_bf16 v[176:191], v[220:223], v[52:55], v[176:191]
    ds_read_b64_tr_b16 v[216:217], v16 offset:8192
    ds_read_b64_tr_b16 v[218:219], v16 offset:10240
    v_add_f32 v31, v31, v155
    v_fma_f32 v158, v158, s35, -v233
    v_exp_f32 v157, v157
    v_add_f32 v31, v31, v156
    s_waitcnt lgkmcnt(7)
    v_mfma_f32_32x32x16_bf16 v[176:191], v[224:227], v[56:59], v[176:191]
    ds_read_b64_tr_b16 v[220:221], v16 offset:12288
    ds_read_b64_tr_b16 v[222:223], v16 offset:14336
    v_cvt_pk_bf16_f32 v206, v156, v157
    v_fma_f32 v159, v159, s35, -v233
    v_exp_f32 v158, v158
    v_add_f32 v31, v31, v157
    s_waitcnt lgkmcnt(8)
    v_mfma_f32_32x32x16_bf16 v[176:191], v[228:231], v[60:63], v[176:191]
    ds_read_b64_tr_b16 v[224:225], v17 offset:0
    ds_read_b64_tr_b16 v[226:227], v17 offset:2048
    v_exp_f32 v159, v159
    v_add_f32 v31, v31, v158
    v_cvt_pk_bf16_f32 v207, v158, v159
    v_add_f32 v31, v31, v159
    s_nop 0
    s_waitcnt vmcnt(10)
    s_barrier
    s_waitcnt lgkmcnt(8)
    v_mfma_f32_32x32x16_bf16 v[64:79], v[208:211], v[192:195], v[64:79]
    ds_read_b64_tr_b16 v[228:229], v17 offset:4096
    ds_read_b64_tr_b16 v[230:231], v17 offset:6144
    v_max3_f32 v2, v160, v161, v162
    v_max3_f32 v3, v163, v164, v165
    v_max3_f32 v4, v166, v167, v168
    v_max3_f32 v5, v169, v170, v171
    v_max3_f32 v2, v2, v172, v173
    v_max3_f32 v3, v3, v174, v175
    s_waitcnt lgkmcnt(8)
    v_mfma_f32_32x32x16_bf16 v[64:79], v[212:215], v[196:199], v[64:79]
    ds_read_b64_tr_b16 v[208:209], v17 offset:8192
    ds_read_b64_tr_b16 v[210:211], v17 offset:10240
    s_add_u32 m0, s38, 49152
    s_nop 0
    buffer_load_dwordx4 v24, s[16:19], s36 offen offset:0 nt lds
    v_max3_f32 v4, v4, v176, v177
    v_max3_f32 v5, v5, v178, v179
    v_max3_f32 v2, v2, v180, v181
    v_max3_f32 v3, v3, v182, v183
    v_max3_f32 v4, v4, v184, v185
    s_waitcnt lgkmcnt(8)
    v_mfma_f32_32x32x16_bf16 v[64:79], v[216:219], v[200:203], v[64:79]
    ds_read_b64_tr_b16 v[212:213], v17 offset:12288
    ds_read_b64_tr_b16 v[214:215], v17 offset:14336
    v_max3_f32 v5, v5, v186, v187
    v_max3_f32 v2, v2, v188, v189
    v_max3_f32 v3, v3, v190, v191
    v_max3_f32 v2, v2, v3, v4
    v_max_f32 v2, v2, v5
    s_waitcnt lgkmcnt(8)
    v_mfma_f32_32x32x16_bf16 v[64:79], v[220:223], v[204:207], v[64:79]
    ds_read_b64_tr_b16 v[216:217], v18 offset:0
    ds_read_b64_tr_b16 v[218:219], v18 offset:2048
    buffer_load_dwordx4 v25, s[16:19], s36 offen offset:1024 nt lds
    s_add_u32 s36, s36, 16384
    v_mov_b32 v3, v2
    s_nop 1
    v_permlane32_swap_b32 v2, v3
    v_max_f32 v2, v2, v3
    v_sub_f32 v3, v2, v30
    s_waitcnt lgkmcnt(8)
    v_mfma_f32_32x32x16_bf16 v[80:95], v[224:227], v[192:195], v[80:95]
    ds_read_b64_tr_b16 v[220:221], v18 offset:4096
    ds_read_b64_tr_b16 v[222:223], v18 offset:6144
    v_cmp_lt_f32 vcc, s62, v3
    s_cbranch_vccnz L_rs1_11
    L_bk1_11:
    v_fma_f32 v160, v160, s35, -v233
    v_fma_f32 v161, v161, s35, -v233
    v_exp_f32 v160, v160
    s_waitcnt lgkmcnt(8)
    v_mfma_f32_32x32x16_bf16 v[80:95], v[228:231], v[196:199], v[80:95]
    ds_read_b64_tr_b16 v[224:225], v18 offset:8192
    ds_read_b64_tr_b16 v[226:227], v18 offset:10240
    s_add_u32 m0, s39, 65536
    s_nop 0
    buffer_load_dwordx4 v26, s[20:23], s37 offen offset:0 nt lds
    v_fma_f32 v162, v162, s35, -v233
    v_exp_f32 v161, v161
    v_add_f32 v31, v31, v160
    s_waitcnt lgkmcnt(8)
    v_mfma_f32_32x32x16_bf16 v[80:95], v[208:211], v[200:203], v[80:95]
    ds_read_b64_tr_b16 v[228:229], v18 offset:12288
    ds_read_b64_tr_b16 v[230:231], v18 offset:14336
    v_fma_f32 v163, v163, s35, -v233
    v_exp_f32 v162, v162
    v_add_f32 v31, v31, v161
    v_fma_f32 v164, v164, s35, -v233
    s_waitcnt lgkmcnt(8)
    v_mfma_f32_32x32x16_bf16 v[80:95], v[212:215], v[204:207], v[80:95]
    ds_read_b64_tr_b16 v[208:209], v19 offset:0
    ds_read_b64_tr_b16 v[210:211], v19 offset:2048
    buffer_load_dwordx4 v26, s[20:23], s37 offen offset:1024 nt lds
    s_add_u32 s37, s37, 16384
    v_exp_f32 v163, v163
    v_add_f32 v31, v31, v162
    v_fma_f32 v165, v165, s35, -v233
    v_exp_f32 v164, v164
    s_waitcnt lgkmcnt(8)
    v_mfma_f32_32x32x16_bf16 v[96:111], v[216:219], v[192:195], v[96:111]
    ds_read_b64_tr_b16 v[212:213], v19 offset:4096
    ds_read_b64_tr_b16 v[214:215], v19 offset:6144
    v_add_f32 v31, v31, v163
    v_fma_f32 v166, v166, s35, -v233
    v_exp_f32 v165, v165
    v_add_f32 v31, v31, v164
    s_waitcnt lgkmcnt(8)
    v_mfma_f32_32x32x16_bf16 v[96:111], v[220:223], v[196:199], v[96:111]
    ds_read_b64_tr_b16 v[216:217], v19 offset:8192
    ds_read_b64_tr_b16 v[218:219], v19 offset:10240
    v_fma_f32 v167, v167, s35, -v233
    v_exp_f32 v166, v166
    v_add_f32 v31, v31, v165
    v_fma_f32 v168, v168, s35, -v233
    s_waitcnt lgkmcnt(8)
    v_mfma_f32_32x32x16_bf16 v[96:111], v[224:227], v[200:203], v[96:111]
    ds_read_b64_tr_b16 v[220:221], v19 offset:12288
    ds_read_b64_tr_b16 v[222:223], v19 offset:14336
    v_exp_f32 v167, v167
    v_add_f32 v31, v31, v166
    v_fma_f32 v169, v169, s35, -v233
    v_exp_f32 v168, v168
    s_waitcnt lgkmcnt(8)
    v_mfma_f32_32x32x16_bf16 v[96:111], v[228:231], v[204:207], v[96:111]
    ds_read_b128 v[224:227], v8 offset:0
    v_add_f32 v31, v31, v167
    v_fma_f32 v170, v170, s35, -v233
    v_exp_f32 v169, v169
    s_waitcnt lgkmcnt(7)
    v_mfma_f32_32x32x16_bf16 v[112:127], v[208:211], v[192:195], v[112:127]
    ds_read_b128 v[228:231], v9 offset:0
    v_add_f32 v31, v31, v168
    v_fma_f32 v171, v171, s35, -v233
    v_exp_f32 v170, v170
    v_add_f32 v31, v31, v169
    v_fma_f32 v172, v172, s35, -v233
    s_waitcnt lgkmcnt(6)
    v_mfma_f32_32x32x16_bf16 v[112:127], v[212:215], v[196:199], v[112:127]
    ds_read_b128 v[208:211], v10 offset:0
    v_exp_f32 v171, v171
    v_add_f32 v31, v31, v170
    v_fma_f32 v173, v173, s35, -v233
    v_exp_f32 v172, v172
    s_waitcnt lgkmcnt(5)
    v_mfma_f32_32x32x16_bf16 v[112:127], v[216:219], v[200:203], v[112:127]
    ds_read_b128 v[212:215], v11 offset:0
    v_add_f32 v31, v31, v171
    v_fma_f32 v174, v174, s35, -v233
    v_exp_f32 v173, v173
    s_waitcnt lgkmcnt(4)
    v_mfma_f32_32x32x16_bf16 v[112:127], v[220:223], v[204:207], v[112:127]
    ds_read_b128 v[216:219], v12 offset:0
    s_cmp_lg_u32 s61, 0
    s_cbranch_scc1 L_rs2_11
L_bk2_11:
    v_cvt_pk_bf16_f32 v192, v160, v161
    v_cvt_pk_bf16_f32 v193, v162, v163
    v_cvt_pk_bf16_f32 v194, v164, v165
    v_cvt_pk_bf16_f32 v195, v166, v167
    v_cvt_pk_bf16_f32 v196, v168, v169
    s_waitcnt lgkmcnt(4)
    v_mfma_f32_32x32x16_bf16 v[128:143], v[224:227], v[32:35], 0
    ds_read_b128 v[220:223], v13 offset:0
    v_cvt_pk_bf16_f32 v197, v170, v171
    v_cvt_pk_bf16_f32 v198, v172, v173
    v_add_f32 v31, v31, v172
    v_fma_f32 v175, v175, s35, -v233
    v_exp_f32 v174, v174
    s_waitcnt lgkmcnt(4)
    v_mfma_f32_32x32x16_bf16 v[128:143], v[228:231], v[36:39], v[128:143]
    ds_read_b128 v[224:227], v14 offset:0
    v_add_f32 v31, v31, v173
    v_fma_f32 v176, v176, s35, -v233
    v_exp_f32 v175, v175
    v_add_f32 v31, v31, v174
    s_waitcnt lgkmcnt(4)
    v_mfma_f32_32x32x16_bf16 v[128:143], v[208:211], v[40:43], v[128:143]
    ds_read_b128 v[228:231], v15 offset:0
    v_cvt_pk_bf16_f32 v199, v174, v175
    v_fma_f32 v177, v177, s35, -v233
    v_exp_f32 v176, v176
    v_add_f32 v31, v31, v175
    s_waitcnt lgkmcnt(4)
    v_mfma_f32_32x32x16_bf16 v[128:143], v[212:215], v[44:47], v[128:143]
    ds_read_b128 v[208:211], v8 offset:8192
    v_fma_f32 v178, v178, s35, -v233
    v_exp_f32 v177, v177
    v_add_f32 v31, v31, v176
    v_cvt_pk_bf16_f32 v200, v176, v177
    s_waitcnt lgkmcnt(4)
    v_mfma_f32_32x32x16_bf16 v[128:143], v[216:219], v[48:51], v[128:143]
    ds_read_b128 v[212:215], v9 offset:8192
    v_fma_f32 v179, v179, s35, -v233
    v_exp_f32 v178, v178
    v_add_f32 v31, v31, v177
    v_fma_f32 v180, v180, s35, -v233
    v_exp_f32 v179, v179
    s_waitcnt lgkmcnt(4)
    v_mfma_f32_32x32x16_bf16 v[128:143], v[220:223], v[52:55], v[128:143]
    ds_read_b128 v[216:219], v10 offset:8192
    v_add_f32 v31, v31, v178
    v_cvt_pk_bf16_f32 v201, v178, v179
    v_fma_f32 v181, v181, s35, -v233
    v_exp_f32 v180, v180
    s_waitcnt lgkmcnt(4)
    v_mfma_f32_32x32x16_bf16 v[128:143], v[224:227], v[56:59], v[128:143]
    ds_read_b128 v[220:223], v11 offset:8192
    v_add_f32 v31, v31, v179
    v_fma_f32 v182, v182, s35, -v233
    v_exp_f32 v181, v181
    s_waitcnt lgkmcnt(4)
    v_mfma_f32_32x32x16_bf16 v[128:143], v[228:231], v[60:63], v[128:143]
    ds_read_b128 v[224:227], v12 offset:8192
    v_add_f32 v31, v31, v180
    v_cvt_pk_bf16_f32 v202, v180, v181
    v_fma_f32 v183, v183, s35, -v233
    v_exp_f32 v182, v182
    s_waitcnt lgkmcnt(4)
    v_mfma_f32_32x32x16_bf16 v[144:159], v[208:211], v[32:35], 0
    ds_read_b128 v[228:231], v13 offset:8192
    v_add_f32 v31, v31, v181
    v_fma_f32 v184, v184, s35, -v233
    v_exp_f32 v183, v183
    v_add_f32 v31, v31, v182
    v_cvt_pk_bf16_f32 v203, v182, v183
    s_waitcnt lgkmcnt(4)
    v_mfma_f32_32x32x16_bf16 v[144:159], v[212:215], v[36:39], v[144:159]
    ds_read_b128 v[208:211], v14 offset:8192
    v_fma_f32 v185, v185, s35, -v233
    v_exp_f32 v184, v184
    v_add_f32 v31, v31, v183
    v_fma_f32 v186, v186, s35, -v233
    s_waitcnt lgkmcnt(4)
    v_mfma_f32_32x32x16_bf16 v[144:159], v[216:219], v[40:43], v[144:159]
    ds_read_b128 v[212:215], v15 offset:8192
    v_exp_f32 v185, v185
    v_add_f32 v31, v31, v184
    v_cvt_pk_bf16_f32 v204, v184, v185
    v_fma_f32 v187, v187, s35, -v233
    s_waitcnt lgkmcnt(4)
    v_mfma_f32_32x32x16_bf16 v[144:159], v[220:223], v[44:47], v[144:159]
    ds_read_b64_tr_b16 v[216:217], v16 offset:16384
    ds_read_b64_tr_b16 v[218:219], v16 offset:18432
    v_exp_f32 v186, v186
    v_add_f32 v31, v31, v185
    v_fma_f32 v188, v188, s35, -v233
    v_exp_f32 v187, v187
    s_waitcnt lgkmcnt(5)
    v_mfma_f32_32x32x16_bf16 v[144:159], v[224:227], v[48:51], v[144:159]
    ds_read_b64_tr_b16 v[220:221], v16 offset:20480
    ds_read_b64_tr_b16 v[222:223], v16 offset:22528
    v_add_f32 v31, v31, v186
    v_cvt_pk_bf16_f32 v205, v186, v187
    v_fma_f32 v189, v189, s35, -v233
    v_exp_f32 v188, v188
    s_waitcnt lgkmcnt(6)
    v_mfma_f32_32x32x16_bf16 v[144:159], v[228:231], v[52:55], v[144:159]
    ds_read_b64_tr_b16 v[224:225], v16 offset:24576
    ds_read_b64_tr_b16 v[226:227], v16 offset:26624
    v_add_f32 v31, v31, v187
    v_fma_f32 v190, v190, s35, -v233
    v_exp_f32 v189, v189
    v_add_f32 v31, v31, v188
    s_waitcnt lgkmcnt(7)
    v_mfma_f32_32x32x16_bf16 v[144:159], v[208:211], v[56:59], v[144:159]
    ds_read_b64_tr_b16 v[228:229], v16 offset:28672
    ds_read_b64_tr_b16 v[230:231], v16 offset:30720
    v_cvt_pk_bf16_f32 v206, v188, v189
    v_fma_f32 v191, v191, s35, -v233
    v_exp_f32 v190, v190
    v_add_f32 v31, v31, v189
    s_waitcnt lgkmcnt(8)
    v_mfma_f32_32x32x16_bf16 v[144:159], v[212:215], v[60:63], v[144:159]
    ds_read_b64_tr_b16 v[208:209], v17 offset:16384
    ds_read_b64_tr_b16 v[210:211], v17 offset:18432
    v_exp_f32 v191, v191
    v_add_f32 v31, v31, v190
    v_cvt_pk_bf16_f32 v207, v190, v191
    v_add_f32 v31, v31, v191
    s_nop 0
    s_waitcnt vmcnt(10)
    s_barrier
    s_waitcnt lgkmcnt(8)
    v_mfma_f32_32x32x16_bf16 v[64:79], v[216:219], v[192:195], v[64:79]
    ds_read_b64_tr_b16 v[212:213], v17 offset:20480
    ds_read_b64_tr_b16 v[214:215], v17 offset:22528
    v_max3_f32 v2, v128, v129, v130
    v_max3_f32 v3, v131, v132, v133
    v_max3_f32 v4, v134, v135, v136
    v_max3_f32 v5, v137, v138, v139
    v_max3_f32 v2, v2, v140, v141
    v_max3_f32 v3, v3, v142, v143
    s_waitcnt lgkmcnt(8)
    v_mfma_f32_32x32x16_bf16 v[64:79], v[220:223], v[196:199], v[64:79]
    ds_read_b64_tr_b16 v[216:217], v17 offset:24576
    ds_read_b64_tr_b16 v[218:219], v17 offset:26624
    v_max3_f32 v4, v4, v144, v145
    v_max3_f32 v5, v5, v146, v147
    v_max3_f32 v2, v2, v148, v149
    v_max3_f32 v3, v3, v150, v151
    v_max3_f32 v4, v4, v152, v153
    s_waitcnt lgkmcnt(8)
    v_mfma_f32_32x32x16_bf16 v[64:79], v[224:227], v[200:203], v[64:79]
    ds_read_b64_tr_b16 v[220:221], v17 offset:28672
    ds_read_b64_tr_b16 v[222:223], v17 offset:30720
    v_max3_f32 v5, v5, v154, v155
    v_max3_f32 v2, v2, v156, v157
    v_max3_f32 v3, v3, v158, v159
    v_max3_f32 v2, v2, v3, v4
    v_max_f32 v2, v2, v5
    s_waitcnt lgkmcnt(8)
    v_mfma_f32_32x32x16_bf16 v[64:79], v[228:231], v[204:207], v[64:79]
    ds_read_b64_tr_b16 v[224:225], v18 offset:16384
    ds_read_b64_tr_b16 v[226:227], v18 offset:18432
    v_mov_b32 v3, v2
    s_nop 1
    v_permlane32_swap_b32 v2, v3
    v_max_f32 v2, v2, v3
    v_sub_f32 v3, v2, v30
    s_waitcnt lgkmcnt(8)
    v_mfma_f32_32x32x16_bf16 v[80:95], v[208:211], v[192:195], v[80:95]
    ds_read_b64_tr_b16 v[228:229], v18 offset:20480
    ds_read_b64_tr_b16 v[230:231], v18 offset:22528
    v_cmp_lt_f32 vcc, s62, v3
    s_cbranch_vccnz L_rs1_12
    L_bk1_12:
    v_fma_f32 v128, v128, s35, -v233
    v_fma_f32 v129, v129, s35, -v233
    v_exp_f32 v128, v128
    s_waitcnt lgkmcnt(8)
    v_mfma_f32_32x32x16_bf16 v[80:95], v[212:215], v[196:199], v[80:95]
    ds_read_b64_tr_b16 v[208:209], v18 offset:24576
    ds_read_b64_tr_b16 v[210:211], v18 offset:26624
    s_add_u32 m0, s39, 0
    s_nop 0
    buffer_load_dwordx4 v26, s[20:23], s37 offen offset:0 nt lds
    v_fma_f32 v130, v130, s35, -v233
    v_exp_f32 v129, v129
    v_add_f32 v31, v31, v128
    s_waitcnt lgkmcnt(8)
    v_mfma_f32_32x32x16_bf16 v[80:95], v[216:219], v[200:203], v[80:95]
    ds_read_b64_tr_b16 v[212:213], v18 offset:28672
    ds_read_b64_tr_b16 v[214:215], v18 offset:30720
    v_fma_f32 v131, v131, s35, -v233
    v_exp_f32 v130, v130
    v_add_f32 v31, v31, v129
    v_fma_f32 v132, v132, s35, -v233
    s_waitcnt lgkmcnt(8)
    v_mfma_f32_32x32x16_bf16 v[80:95], v[220:223], v[204:207], v[80:95]
    ds_read_b64_tr_b16 v[216:217], v19 offset:16384
    ds_read_b64_tr_b16 v[218:219], v19 offset:18432
    buffer_load_dwordx4 v26, s[20:23], s37 offen offset:1024 nt lds
    s_add_u32 s37, s37, 16384
    v_exp_f32 v131, v131
    v_add_f32 v31, v31, v130
    v_fma_f32 v133, v133, s35, -v233
    v_exp_f32 v132, v132
    s_waitcnt lgkmcnt(8)
    v_mfma_f32_32x32x16_bf16 v[96:111], v[224:227], v[192:195], v[96:111]
    ds_read_b64_tr_b16 v[220:221], v19 offset:20480
    ds_read_b64_tr_b16 v[222:223], v19 offset:22528
    v_add_f32 v31, v31, v131
    v_fma_f32 v134, v134, s35, -v233
    v_exp_f32 v133, v133
    v_add_f32 v31, v31, v132
    s_waitcnt lgkmcnt(8)
    v_mfma_f32_32x32x16_bf16 v[96:111], v[228:231], v[196:199], v[96:111]
    ds_read_b64_tr_b16 v[224:225], v19 offset:24576
    ds_read_b64_tr_b16 v[226:227], v19 offset:26624
    v_fma_f32 v135, v135, s35, -v233
    v_exp_f32 v134, v134
    v_add_f32 v31, v31, v133
    v_fma_f32 v136, v136, s35, -v233
    s_waitcnt lgkmcnt(8)
    v_mfma_f32_32x32x16_bf16 v[96:111], v[208:211], v[200:203], v[96:111]
    ds_read_b64_tr_b16 v[228:229], v19 offset:28672
    ds_read_b64_tr_b16 v[230:231], v19 offset:30720
    v_exp_f32 v135, v135
    v_add_f32 v31, v31, v134
    v_fma_f32 v137, v137, s35, -v233
    v_exp_f32 v136, v136
    s_waitcnt lgkmcnt(8)
    v_mfma_f32_32x32x16_bf16 v[96:111], v[212:215], v[204:207], v[96:111]
    ds_read_b128 v[208:211], v8 offset:16384
    v_add_f32 v31, v31, v135
    v_fma_f32 v138, v138, s35, -v233
    v_exp_f32 v137, v137
    s_waitcnt lgkmcnt(7)
    v_mfma_f32_32x32x16_bf16 v[112:127], v[216:219], v[192:195], v[112:127]
    ds_read_b128 v[212:215], v9 offset:16384
    v_add_f32 v31, v31, v136
    v_fma_f32 v139, v139, s35, -v233
    v_exp_f32 v138, v138
    v_add_f32 v31, v31, v137
    v_fma_f32 v140, v140, s35, -v233
    s_waitcnt lgkmcnt(6)
    v_mfma_f32_32x32x16_bf16 v[112:127], v[220:223], v[196:199], v[112:127]
    ds_read_b128 v[216:219], v10 offset:16384
    v_exp_f32 v139, v139
    v_add_f32 v31, v31, v138
    v_fma_f32 v141, v141, s35, -v233
    v_exp_f32 v140, v140
    s_waitcnt lgkmcnt(5)
    v_mfma_f32_32x32x16_bf16 v[112:127], v[224:227], v[200:203], v[112:127]
    ds_read_b128 v[220:223], v11 offset:16384
    v_add_f32 v31, v31, v139
    v_fma_f32 v142, v142, s35, -v233
    v_exp_f32 v141, v141
    s_waitcnt lgkmcnt(4)
    v_mfma_f32_32x32x16_bf16 v[112:127], v[228:231], v[204:207], v[112:127]
    ds_read_b128 v[224:227], v12 offset:16384
    s_cmp_lg_u32 s61, 0
    s_cbranch_scc1 L_rs2_12
L_bk2_12:
    v_cvt_pk_bf16_f32 v192, v128, v129
    v_cvt_pk_bf16_f32 v193, v130, v131
    v_cvt_pk_bf16_f32 v194, v132, v133
    v_cvt_pk_bf16_f32 v195, v134, v135
    v_cvt_pk_bf16_f32 v196, v136, v137
    s_waitcnt lgkmcnt(4)
    v_mfma_f32_32x32x16_bf16 v[160:175], v[208:211], v[32:35], 0
    ds_read_b128 v[228:231], v13 offset:16384
    v_cvt_pk_bf16_f32 v197, v138, v139
    v_cvt_pk_bf16_f32 v198, v140, v141
    v_add_f32 v31, v31, v140
    v_fma_f32 v143, v143, s35, -v233
    v_exp_f32 v142, v142
    s_waitcnt lgkmcnt(4)
    v_mfma_f32_32x32x16_bf16 v[160:175], v[212:215], v[36:39], v[160:175]
    ds_read_b128 v[208:211], v14 offset:16384
    v_add_f32 v31, v31, v141
    v_fma_f32 v144, v144, s35, -v233
    v_exp_f32 v143, v143
    v_add_f32 v31, v31, v142
    s_waitcnt lgkmcnt(4)
    v_mfma_f32_32x32x16_bf16 v[160:175], v[216:219], v[40:43], v[160:175]
    ds_read_b128 v[212:215], v15 offset:16384
    v_cvt_pk_bf16_f32 v199, v142, v143
    v_fma_f32 v145, v145, s35, -v233
    v_exp_f32 v144, v144
    v_add_f32 v31, v31, v143
    s_waitcnt lgkmcnt(4)
    v_mfma_f32_32x32x16_bf16 v[160:175], v[220:223], v[44:47], v[160:175]
    ds_read_b128 v[216:219], v8 offset:24576
    v_fma_f32 v146, v146, s35, -v233
    v_exp_f32 v145, v145
    v_add_f32 v31, v31, v144
    v_cvt_pk_bf16_f32 v200, v144, v145
    s_waitcnt lgkmcnt(4)
    v_mfma_f32_32x32x16_bf16 v[160:175], v[224:227], v[48:51], v[160:175]
    ds_read_b128 v[220:223], v9 offset:24576
    v_fma_f32 v147, v147, s35, -v233
    v_exp_f32 v146, v146
    v_add_f32 v31, v31, v145
    v_fma_f32 v148, v148, s35, -v233
    v_exp_f32 v147, v147
    s_waitcnt lgkmcnt(4)
    v_mfma_f32_32x32x16_bf16 v[160:175], v[228:231], v[52:55], v[160:175]
    ds_read_b128 v[224:227], v10 offset:24576
    v_add_f32 v31, v31, v146
    v_cvt_pk_bf16_f32 v201, v146, v147
    v_fma_f32 v149, v149, s35, -v233
    v_exp_f32 v148, v148
    s_waitcnt lgkmcnt(4)
    v_mfma_f32_32x32x16_bf16 v[160:175], v[208:211], v[56:59], v[160:175]
    ds_read_b128 v[228:231], v11 offset:24576
    v_add_f32 v31, v31, v147
    v_fma_f32 v150, v150, s35, -v233
    v_exp_f32 v149, v149
    s_waitcnt lgkmcnt(4)
    v_mfma_f32_32x32x16_bf16 v[160:175], v[212:215], v[60:63], v[160:175]
    ds_read_b128 v[208:211], v12 offset:24576
    v_add_f32 v31, v31, v148
    v_cvt_pk_bf16_f32 v202, v148, v149
    v_fma_f32 v151, v151, s35, -v233
    v_exp_f32 v150, v150
    s_waitcnt lgkmcnt(4)
    v_mfma_f32_32x32x16_bf16 v[176:191], v[216:219], v[32:35], 0
    ds_read_b128 v[212:215], v13 offset:24576
    v_add_f32 v31, v31, v149
    v_fma_f32 v152, v152, s35, -v233
    v_exp_f32 v151, v151
    v_add_f32 v31, v31, v150
    v_cvt_pk_bf16_f32 v203, v150, v151
    s_waitcnt lgkmcnt(4)
    v_mfma_f32_32x32x16_bf16 v[176:191], v[220:223], v[36:39], v[176:191]
    ds_read_b128 v[216:219], v14 offset:24576
    v_fma_f32 v153, v153, s35, -v233
    v_exp_f32 v152, v152
    v_add_f32 v31, v31, v151
    v_fma_f32 v154, v154, s35, -v233
    s_waitcnt lgkmcnt(4)
    v_mfma_f32_32x32x16_bf16 v[176:191], v[224:227], v[40:43], v[176:191]
    ds_read_b128 v[220:223], v15 offset:24576
    v_exp_f32 v153, v153
    v_add_f32 v31, v31, v152
    v_cvt_pk_bf16_f32 v204, v152, v153
    v_fma_f32 v155, v155, s35, -v233
    s_waitcnt lgkmcnt(4)
    v_mfma_f32_32x32x16_bf16 v[176:191], v[228:231], v[44:47], v[176:191]
    ds_read_b64_tr_b16 v[224:225], v16 offset:32768
    ds_read_b64_tr_b16 v[226:227], v16 offset:34816
    v_exp_f32 v154, v154
    v_add_f32 v31, v31, v153
    v_fma_f32 v156, v156, s35, -v233
    v_exp_f32 v155, v155
    s_waitcnt lgkmcnt(5)
    v_mfma_f32_32x32x16_bf16 v[176:191], v[208:211], v[48:51], v[176:191]
    ds_read_b64_tr_b16 v[228:229], v16 offset:36864
    ds_read_b64_tr_b16 v[230:231], v16 offset:38912
    v_add_f32 v31, v31, v154
    v_cvt_pk_bf16_f32 v205, v154, v155
    v_fma_f32 v157, v157, s35, -v233
    v_exp_f32 v156, v156
    s_waitcnt lgkmcnt(6)
    v_mfma_f32_32x32x16_bf16 v[176:191], v[212:215], v[52:55], v[176:191]
    ds_read_b64_tr_b16 v[208:209], v16 offset:40960
    ds_read_b64_tr_b16 v[210:211], v16 offset:43008
    v_add_f32 v31, v31, v155
    v_fma_f32 v158, v158, s35, -v233
    v_exp_f32 v157, v157
    v_add_f32 v31, v31, v156
    s_waitcnt lgkmcnt(7)
    v_mfma_f32_32x32x16_bf16 v[176:191], v[216:219], v[56:59], v[176:191]
    ds_read_b64_tr_b16 v[212:213], v16 offset:45056
    ds_read_b64_tr_b16 v[214:215], v16 offset:47104
    v_cvt_pk_bf16_f32 v206, v156, v157
    v_fma_f32 v159, v159, s35, -v233
    v_exp_f32 v158, v158
    v_add_f32 v31, v31, v157
    s_waitcnt lgkmcnt(8)
    v_mfma_f32_32x32x16_bf16 v[176:191], v[220:223], v[60:63], v[176:191]
    ds_read_b64_tr_b16 v[216:217], v17 offset:32768
    ds_read_b64_tr_b16 v[218:219], v17 offset:34816
    v_exp_f32 v159, v159
    v_add_f32 v31, v31, v158
    v_cvt_pk_bf16_f32 v207, v158, v159
    v_add_f32 v31, v31, v159
    s_nop 0
    s_waitcnt vmcnt(8)
    s_barrier
    s_waitcnt lgkmcnt(8)
    v_mfma_f32_32x32x16_bf16 v[64:79], v[224:227], v[192:195], v[64:79]
    ds_read_b64_tr_b16 v[220:221], v17 offset:36864
    ds_read_b64_tr_b16 v[222:223], v17 offset:38912
    v_max3_f32 v2, v160, v161, v162
    v_max3_f32 v3, v163, v164, v165
    v_max3_f32 v4, v166, v167, v168
    v_max3_f32 v5, v169, v170, v171
    v_max3_f32 v2, v2, v172, v173
    v_max3_f32 v3, v3, v174, v175
    s_waitcnt lgkmcnt(8)
    v_mfma_f32_32x32x16_bf16 v[64:79], v[228:231], v[196:199], v[64:79]
    ds_read_b64_tr_b16 v[224:225], v17 offset:40960
    ds_read_b64_tr_b16 v[226:227], v17 offset:43008
    v_max3_f32 v4, v4, v176, v177
    v_max3_f32 v5, v5, v178, v179
    v_max3_f32 v2, v2, v180, v181
    v_max3_f32 v3, v3, v182, v183
    v_max3_f32 v4, v4, v184, v185
    s_waitcnt lgkmcnt(8)
    v_mfma_f32_32x32x16_bf16 v[64:79], v[208:211], v[200:203], v[64:79]
    ds_read_b64_tr_b16 v[228:229], v17 offset:45056
    ds_read_b64_tr_b16 v[230:231], v17 offset:47104
    v_max3_f32 v5, v5, v186, v187
    v_max3_f32 v2, v2, v188, v189
    v_max3_f32 v3, v3, v190, v191
    v_max3_f32 v2, v2, v3, v4
    v_max_f32 v2, v2, v5
    s_waitcnt lgkmcnt(8)
    v_mfma_f32_32x32x16_bf16 v[64:79], v[212:215], v[204:207], v[64:79]
    ds_read_b64_tr_b16 v[208:209], v18 offset:32768
    ds_read_b64_tr_b16 v[210:211], v18 offset:34816
    v_mov_b32 v3, v2
    s_nop 1
    v_permlane32_swap_b32 v2, v3
    v_max_f32 v2, v2, v3
    v_sub_f32 v3, v2, v30
    s_waitcnt lgkmcnt(8)
    v_mfma_f32_32x32x16_bf16 v[80:95], v[216:219], v[192:195], v[80:95]
    ds_read_b64_tr_b16 v[212:213], v18 offset:36864
    ds_read_b64_tr_b16 v[214:215], v18 offset:38912
    v_cmp_lt_f32 vcc, s62, v3
    s_cbranch_vccnz L_rs1_13
    L_bk1_13:
    v_fma_f32 v160, v160, s35, -v233
    v_fma_f32 v161, v161, s35, -v233
    v_exp_f32 v160, v160
    s_waitcnt lgkmcnt(8)
    v_mfma_f32_32x32x16_bf16 v[80:95], v[220:223], v[196:199], v[80:95]
    ds_read_b64_tr_b16 v[216:217], v18 offset:40960
    ds_read_b64_tr_b16 v[218:219], v18 offset:43008
    v_fma_f32 v162, v162, s35, -v233
    v_exp_f32 v161, v161
    v_add_f32 v31, v31, v160
    s_waitcnt lgkmcnt(8)
    v_mfma_f32_32x32x16_bf16 v[80:95], v[224:227], v[200:203], v[80:95]
    ds_read_b64_tr_b16 v[220:221], v18 offset:45056
    ds_read_b64_tr_b16 v[222:223], v18 offset:47104
    v_fma_f32 v163, v163, s35, -v233
    v_exp_f32 v162, v162
    v_add_f32 v31, v31, v161
    v_fma_f32 v164, v164, s35, -v233
    s_waitcnt lgkmcnt(8)
    v_mfma_f32_32x32x16_bf16 v[80:95], v[228:231], v[204:207], v[80:95]
    ds_read_b64_tr_b16 v[224:225], v19 offset:32768
    ds_read_b64_tr_b16 v[226:227], v19 offset:34816
    v_exp_f32 v163, v163
    v_add_f32 v31, v31, v162
    v_fma_f32 v165, v165, s35, -v233
    v_exp_f32 v164, v164
    s_waitcnt lgkmcnt(8)
    v_mfma_f32_32x32x16_bf16 v[96:111], v[208:211], v[192:195], v[96:111]
    ds_read_b64_tr_b16 v[228:229], v19 offset:36864
    ds_read_b64_tr_b16 v[230:231], v19 offset:38912
    v_add_f32 v31, v31, v163
    v_fma_f32 v166, v166, s35, -v233
    v_exp_f32 v165, v165
    v_add_f32 v31, v31, v164
    s_waitcnt lgkmcnt(8)
    v_mfma_f32_32x32x16_bf16 v[96:111], v[212:215], v[196:199], v[96:111]
    ds_read_b64_tr_b16 v[208:209], v19 offset:40960
    ds_read_b64_tr_b16 v[210:211], v19 offset:43008
    v_fma_f32 v167, v167, s35, -v233
    v_exp_f32 v166, v166
    v_add_f32 v31, v31, v165
    v_fma_f32 v168, v168, s35, -v233
    s_waitcnt lgkmcnt(8)
    v_mfma_f32_32x32x16_bf16 v[96:111], v[216:219], v[200:203], v[96:111]
    ds_read_b64_tr_b16 v[212:213], v19 offset:45056
    ds_read_b64_tr_b16 v[214:215], v19 offset:47104
    v_exp_f32 v167, v167
    v_add_f32 v31, v31, v166
    v_fma_f32 v169, v169, s35, -v233
    v_exp_f32 v168, v168
    s_waitcnt lgkmcnt(8)
    v_mfma_f32_32x32x16_bf16 v[96:111], v[220:223], v[204:207], v[96:111]
    ds_read_b128 v[216:219], v8 offset:32768
    v_add_f32 v31, v31, v167
    v_fma_f32 v170, v170, s35, -v233
    v_exp_f32 v169, v169
    s_waitcnt lgkmcnt(7)
    v_mfma_f32_32x32x16_bf16 v[112:127], v[224:227], v[192:195], v[112:127]
    ds_read_b128 v[220:223], v9 offset:32768
    v_add_f32 v31, v31, v168
    v_fma_f32 v171, v171, s35, -v233
    v_exp_f32 v170, v170
    v_add_f32 v31, v31, v169
    v_fma_f32 v172, v172, s35, -v233
    s_waitcnt lgkmcnt(6)
    v_mfma_f32_32x32x16_bf16 v[112:127], v[228:231], v[196:199], v[112:127]
    ds_read_b128 v[224:227], v10 offset:32768
    v_exp_f32 v171, v171
    v_add_f32 v31, v31, v170
    v_fma_f32 v173, v173, s35, -v233
    v_exp_f32 v172, v172
    s_waitcnt lgkmcnt(5)
    v_mfma_f32_32x32x16_bf16 v[112:127], v[208:211], v[200:203], v[112:127]
    ds_read_b128 v[228:231], v11 offset:32768
    v_add_f32 v31, v31, v171
    v_fma_f32 v174, v174, s35, -v233
    v_exp_f32 v173, v173
    s_waitcnt lgkmcnt(4)
    v_mfma_f32_32x32x16_bf16 v[112:127], v[212:215], v[204:207], v[112:127]
    ds_read_b128 v[208:211], v12 offset:32768
    s_cmp_lg_u32 s61, 0
    s_cbranch_scc1 L_rs2_13
L_bk2_13:
    v_cvt_pk_bf16_f32 v192, v160, v161
    v_cvt_pk_bf16_f32 v193, v162, v163
    v_cvt_pk_bf16_f32 v194, v164, v165
    v_cvt_pk_bf16_f32 v195, v166, v167
    v_cvt_pk_bf16_f32 v196, v168, v169
    s_waitcnt lgkmcnt(4)
    v_mfma_f32_32x32x16_bf16 v[128:143], v[216:219], v[32:35], 0
    ds_read_b128 v[212:215], v13 offset:32768
    v_cvt_pk_bf16_f32 v197, v170, v171
    v_cvt_pk_bf16_f32 v198, v172, v173
    v_add_f32 v31, v31, v172
    v_fma_f32 v175, v175, s35, -v233
    v_exp_f32 v174, v174
    s_waitcnt lgkmcnt(4)
    v_mfma_f32_32x32x16_bf16 v[128:143], v[220:223], v[36:39], v[128:143]
    ds_read_b128 v[216:219], v14 offset:32768
    v_add_f32 v31, v31, v173
    v_fma_f32 v176, v176, s35, -v233
    v_exp_f32 v175, v175
    v_add_f32 v31, v31, v174
    s_waitcnt lgkmcnt(4)
    v_mfma_f32_32x32x16_bf16 v[128:143], v[224:227], v[40:43], v[128:143]
    ds_read_b128 v[220:223], v15 offset:32768
    v_cvt_pk_bf16_f32 v199, v174, v175
    v_fma_f32 v177, v177, s35, -v233
    v_exp_f32 v176, v176
    v_add_f32 v31, v31, v175
    s_waitcnt lgkmcnt(4)
    v_mfma_f32_32x32x16_bf16 v[128:143], v[228:231], v[44:47], v[128:143]
    ds_read_b128 v[224:227], v8 offset:40960
    v_fma_f32 v178, v178, s35, -v233
    v_exp_f32 v177, v177
    v_add_f32 v31, v31, v176
    v_cvt_pk_bf16_f32 v200, v176, v177
    s_waitcnt lgkmcnt(4)
    v_mfma_f32_32x32x16_bf16 v[128:143], v[208:211], v[48:51], v[128:143]
    ds_read_b128 v[228:231], v9 offset:40960
    v_fma_f32 v179, v179, s35, -v233
    v_exp_f32 v178, v178
    v_add_f32 v31, v31, v177
    v_fma_f32 v180, v180, s35, -v233
    v_exp_f32 v179, v179
    s_waitcnt lgkmcnt(4)
    v_mfma_f32_32x32x16_bf16 v[128:143], v[212:215], v[52:55], v[128:143]
    ds_read_b128 v[208:211], v10 offset:40960
    v_add_f32 v31, v31, v178
    v_cvt_pk_bf16_f32 v201, v178, v179
    v_fma_f32 v181, v181, s35, -v233
    v_exp_f32 v180, v180
    s_waitcnt lgkmcnt(4)
    v_mfma_f32_32x32x16_bf16 v[128:143], v[216:219], v[56:59], v[128:143]
    ds_read_b128 v[212:215], v11 offset:40960
    v_add_f32 v31, v31, v179
    v_fma_f32 v182, v182, s35, -v233
    v_exp_f32 v181, v181
    s_waitcnt lgkmcnt(4)
    v_mfma_f32_32x32x16_bf16 v[128:143], v[220:223], v[60:63], v[128:143]
    ds_read_b128 v[216:219], v12 offset:40960
    v_add_f32 v31, v31, v180
    v_cvt_pk_bf16_f32 v202, v180, v181
    v_fma_f32 v183, v183, s35, -v233
    v_exp_f32 v182, v182
    s_waitcnt lgkmcnt(4)
    v_mfma_f32_32x32x16_bf16 v[144:159], v[224:227], v[32:35], 0
    ds_read_b128 v[220:223], v13 offset:40960
    v_add_f32 v31, v31, v181
    v_fma_f32 v184, v184, s35, -v233
    v_exp_f32 v183, v183
    v_add_f32 v31, v31, v182
    v_cvt_pk_bf16_f32 v203, v182, v183
    s_waitcnt lgkmcnt(4)
    v_mfma_f32_32x32x16_bf16 v[144:159], v[228:231], v[36:39], v[144:159]
    ds_read_b128 v[224:227], v14 offset:40960
    v_fma_f32 v185, v185, s35, -v233
    v_exp_f32 v184, v184
    v_add_f32 v31, v31, v183
    v_fma_f32 v186, v186, s35, -v233
    s_waitcnt lgkmcnt(4)
    v_mfma_f32_32x32x16_bf16 v[144:159], v[208:211], v[40:43], v[144:159]
    ds_read_b128 v[228:231], v15 offset:40960
    v_exp_f32 v185, v185
    v_add_f32 v31, v31, v184
    v_cvt_pk_bf16_f32 v204, v184, v185
    v_fma_f32 v187, v187, s35, -v233
    s_waitcnt lgkmcnt(4)
    v_mfma_f32_32x32x16_bf16 v[144:159], v[212:215], v[44:47], v[144:159]
    ds_read_b64_tr_b16 v[208:209], v16 offset:49152
    ds_read_b64_tr_b16 v[210:211], v16 offset:51200
    v_exp_f32 v186, v186
    v_add_f32 v31, v31, v185
    v_fma_f32 v188, v188, s35, -v233
    v_exp_f32 v187, v187
    s_waitcnt lgkmcnt(5)
    v_mfma_f32_32x32x16_bf16 v[144:159], v[216:219], v[48:51], v[144:159]
    ds_read_b64_tr_b16 v[212:213], v16 offset:53248
    ds_read_b64_tr_b16 v[214:215], v16 offset:55296
    v_add_f32 v31, v31, v186
    v_cvt_pk_bf16_f32 v205, v186, v187
    v_fma_f32 v189, v189, s35, -v233
    v_exp_f32 v188, v188
    s_waitcnt lgkmcnt(6)
    v_mfma_f32_32x32x16_bf16 v[144:159], v[220:223], v[52:55], v[144:159]
    ds_read_b64_tr_b16 v[216:217], v16 offset:57344
    ds_read_b64_tr_b16 v[218:219], v16 offset:59392
    v_add_f32 v31, v31, v187
    v_fma_f32 v190, v190, s35, -v233
    v_exp_f32 v189, v189
    v_add_f32 v31, v31, v188
    s_waitcnt lgkmcnt(7)
    v_mfma_f32_32x32x16_bf16 v[144:159], v[224:227], v[56:59], v[144:159]
    ds_read_b64_tr_b16 v[220:221], v16 offset:61440
    ds_read_b64_tr_b16 v[222:223], v16 offset:63488
    v_cvt_pk_bf16_f32 v206, v188, v189
    v_fma_f32 v191, v191, s35, -v233
    v_exp_f32 v190, v190
    v_add_f32 v31, v31, v189
    s_waitcnt lgkmcnt(8)
    v_mfma_f32_32x32x16_bf16 v[144:159], v[228:231], v[60:63], v[144:159]
    ds_read_b64_tr_b16 v[224:225], v17 offset:49152
    ds_read_b64_tr_b16 v[226:227], v17 offset:51200
    v_exp_f32 v191, v191
    v_add_f32 v31, v31, v190
    v_cvt_pk_bf16_f32 v207, v190, v191
    v_add_f32 v31, v31, v191
    s_nop 0
    s_waitcnt vmcnt(2)
    s_barrier
    s_waitcnt lgkmcnt(8)
    v_mfma_f32_32x32x16_bf16 v[64:79], v[208:211], v[192:195], v[64:79]
    ds_read_b64_tr_b16 v[228:229], v17 offset:53248
    ds_read_b64_tr_b16 v[230:231], v17 offset:55296
    v_max3_f32 v2, v128, v129, v130
    v_max3_f32 v3, v131, v132, v133
    v_max3_f32 v4, v134, v135, v136
    v_max3_f32 v5, v137, v138, v139
    v_max3_f32 v2, v2, v140, v141
    v_max3_f32 v3, v3, v142, v143
    s_waitcnt lgkmcnt(8)
    v_mfma_f32_32x32x16_bf16 v[64:79], v[212:215], v[196:199], v[64:79]
    ds_read_b64_tr_b16 v[208:209], v17 offset:57344
    ds_read_b64_tr_b16 v[210:211], v17 offset:59392
    v_max3_f32 v4, v4, v144, v145
    v_max3_f32 v5, v5, v146, v147
    v_max3_f32 v2, v2, v148, v149
    v_max3_f32 v3, v3, v150, v151
    v_max3_f32 v4, v4, v152, v153
    s_waitcnt lgkmcnt(8)
    v_mfma_f32_32x32x16_bf16 v[64:79], v[216:219], v[200:203], v[64:79]
    ds_read_b64_tr_b16 v[212:213], v17 offset:61440
    ds_read_b64_tr_b16 v[214:215], v17 offset:63488
    v_max3_f32 v5, v5, v154, v155
    v_max3_f32 v2, v2, v156, v157
    v_max3_f32 v3, v3, v158, v159
    v_max3_f32 v2, v2, v3, v4
    v_max_f32 v2, v2, v5
    s_waitcnt lgkmcnt(8)
    v_mfma_f32_32x32x16_bf16 v[64:79], v[220:223], v[204:207], v[64:79]
    ds_read_b64_tr_b16 v[216:217], v18 offset:49152
    ds_read_b64_tr_b16 v[218:219], v18 offset:51200
    v_mov_b32 v3, v2
    s_nop 1
    v_permlane32_swap_b32 v2, v3
    v_max_f32 v2, v2, v3
    v_sub_f32 v3, v2, v30
    s_waitcnt lgkmcnt(8)
    v_mfma_f32_32x32x16_bf16 v[80:95], v[224:227], v[192:195], v[80:95]
    ds_read_b64_tr_b16 v[220:221], v18 offset:53248
    ds_read_b64_tr_b16 v[222:223], v18 offset:55296
    v_cmp_lt_f32 vcc, s62, v3
    s_cbranch_vccnz L_rs1_14
    L_bk1_14:
    v_fma_f32 v128, v128, s35, -v233
    v_fma_f32 v129, v129, s35, -v233
    v_exp_f32 v128, v128
    s_waitcnt lgkmcnt(8)
    v_mfma_f32_32x32x16_bf16 v[80:95], v[228:231], v[196:199], v[80:95]
    ds_read_b64_tr_b16 v[224:225], v18 offset:57344
    ds_read_b64_tr_b16 v[226:227], v18 offset:59392
    v_fma_f32 v130, v130, s35, -v233
    v_exp_f32 v129, v129
    v_add_f32 v31, v31, v128
    s_waitcnt lgkmcnt(8)
    v_mfma_f32_32x32x16_bf16 v[80:95], v[208:211], v[200:203], v[80:95]
    ds_read_b64_tr_b16 v[228:229], v18 offset:61440
    ds_read_b64_tr_b16 v[230:231], v18 offset:63488
    v_fma_f32 v131, v131, s35, -v233
    v_exp_f32 v130, v130
    v_add_f32 v31, v31, v129
    v_fma_f32 v132, v132, s35, -v233
    s_waitcnt lgkmcnt(8)
    v_mfma_f32_32x32x16_bf16 v[80:95], v[212:215], v[204:207], v[80:95]
    ds_read_b64_tr_b16 v[208:209], v19 offset:49152
    ds_read_b64_tr_b16 v[210:211], v19 offset:51200
    v_exp_f32 v131, v131
    v_add_f32 v31, v31, v130
    v_fma_f32 v133, v133, s35, -v233
    v_exp_f32 v132, v132
    s_waitcnt lgkmcnt(8)
    v_mfma_f32_32x32x16_bf16 v[96:111], v[216:219], v[192:195], v[96:111]
    ds_read_b64_tr_b16 v[212:213], v19 offset:53248
    ds_read_b64_tr_b16 v[214:215], v19 offset:55296
    v_add_f32 v31, v31, v131
    v_fma_f32 v134, v134, s35, -v233
    v_exp_f32 v133, v133
    v_add_f32 v31, v31, v132
    s_waitcnt lgkmcnt(8)
    v_mfma_f32_32x32x16_bf16 v[96:111], v[220:223], v[196:199], v[96:111]
    ds_read_b64_tr_b16 v[216:217], v19 offset:57344
    ds_read_b64_tr_b16 v[218:219], v19 offset:59392
    ds_read_b64_tr_b16 v[240:241], v239 offset:0
    ds_read_b64_tr_b16 v[242:243], v239 offset:8192
    ds_read_b64_tr_b16 v[244:245], v239 offset:64
    ds_read_b64_tr_b16 v[246:247], v239 offset:8256
    v_fma_f32 v135, v135, s35, -v233
    v_exp_f32 v134, v134
    v_add_f32 v31, v31, v133
    v_fma_f32 v136, v136, s35, -v233
    s_waitcnt lgkmcnt(12)
    v_mfma_f32_32x32x16_bf16 v[96:111], v[224:227], v[200:203], v[96:111]
    ds_read_b64_tr_b16 v[220:221], v19 offset:61440
    ds_read_b64_tr_b16 v[222:223], v19 offset:63488
    v_exp_f32 v135, v135
    v_add_f32 v31, v31, v134
    v_fma_f32 v137, v137, s35, -v233
    v_exp_f32 v136, v136
    s_waitcnt lgkmcnt(12)
    v_mfma_f32_32x32x16_bf16 v[96:111], v[228:231], v[204:207], v[96:111]
    ds_read_b128 v[224:227], v8 offset:49152
    v_add_f32 v31, v31, v135
    v_fma_f32 v138, v138, s35, -v233
    v_exp_f32 v137, v137
    s_waitcnt lgkmcnt(11)
    v_mfma_f32_32x32x16_bf16 v[112:127], v[208:211], v[192:195], v[112:127]
    ds_read_b128 v[228:231], v9 offset:49152
    v_add_f32 v31, v31, v136
    v_fma_f32 v139, v139, s35, -v233
    v_exp_f32 v138, v138
    v_add_f32 v31, v31, v137
    v_fma_f32 v140, v140, s35, -v233
    s_waitcnt lgkmcnt(10)
    v_mfma_f32_32x32x16_bf16 v[112:127], v[212:215], v[196:199], v[112:127]
    ds_read_b128 v[208:211], v10 offset:49152
    s_lshl_b32 s54, s34, 19
    s_lshl_b32 s55, s2, 10
    s_add_u32 s54, s54, s55
    s_add_u32 s54, s54, 33554432
    s_add_u32 s8, s52, s54
    s_addc_u32 s9, s53, 0
    s_mov_b32 s10, 0x80000
    s_mov_b32 s11, 0x00020000
    s_mov_b32 s55, 262144
    s_waitcnt lgkmcnt(5)
    buffer_store_dwordx4 v[240:243], v248, s[8:11], 0 offen
    buffer_store_dwordx4 v[244:247], v248, s[8:11], s55 offen
    v_exp_f32 v139, v139
    v_add_f32 v31, v31, v138
    v_fma_f32 v141, v141, s35, -v233
    v_exp_f32 v140, v140
    v_mfma_f32_32x32x16_bf16 v[112:127], v[216:219], v[200:203], v[112:127]
    ds_read_b128 v[212:215], v11 offset:49152
    v_add_f32 v31, v31, v139
    v_fma_f32 v142, v142, s35, -v233
    v_exp_f32 v141, v141
    s_waitcnt lgkmcnt(4)
    v_mfma_f32_32x32x16_bf16 v[112:127], v[220:223], v[204:207], v[112:127]
    ds_read_b128 v[216:219], v12 offset:49152
    s_cmp_lg_u32 s61, 0
    s_cbranch_scc1 L_rs2_14
L_bk2_14:
    v_cvt_pk_bf16_f32 v192, v128, v129
    v_cvt_pk_bf16_f32 v193, v130, v131
    v_cvt_pk_bf16_f32 v194, v132, v133
    v_cvt_pk_bf16_f32 v195, v134, v135
    v_cvt_pk_bf16_f32 v196, v136, v137
    s_waitcnt lgkmcnt(4)
    v_mfma_f32_32x32x16_bf16 v[160:175], v[224:227], v[32:35], 0
    ds_read_b128 v[220:223], v13 offset:49152
    v_cvt_pk_bf16_f32 v197, v138, v139
    v_cvt_pk_bf16_f32 v198, v140, v141
    v_add_f32 v31, v31, v140
    v_fma_f32 v143, v143, s35, -v233
    v_exp_f32 v142, v142
    s_waitcnt lgkmcnt(4)
    v_mfma_f32_32x32x16_bf16 v[160:175], v[228:231], v[36:39], v[160:175]
    ds_read_b128 v[224:227], v14 offset:49152
    v_add_f32 v31, v31, v141
    v_fma_f32 v144, v144, s35, -v233
    v_exp_f32 v143, v143
    v_add_f32 v31, v31, v142
    s_waitcnt lgkmcnt(4)
    v_mfma_f32_32x32x16_bf16 v[160:175], v[208:211], v[40:43], v[160:175]
    ds_read_b128 v[228:231], v15 offset:49152
    v_cvt_pk_bf16_f32 v199, v142, v143
    v_fma_f32 v145, v145, s35, -v233
    v_exp_f32 v144, v144
    v_add_f32 v31, v31, v143
    s_waitcnt lgkmcnt(4)
    v_mfma_f32_32x32x16_bf16 v[160:175], v[212:215], v[44:47], v[160:175]
    ds_read_b128 v[208:211], v8 offset:57344
    v_fma_f32 v146, v146, s35, -v233
    v_exp_f32 v145, v145
    v_add_f32 v31, v31, v144
    v_cvt_pk_bf16_f32 v200, v144, v145
    s_waitcnt lgkmcnt(4)
    v_mfma_f32_32x32x16_bf16 v[160:175], v[216:219], v[48:51], v[160:175]
    ds_read_b128 v[212:215], v9 offset:57344
    v_fma_f32 v147, v147, s35, -v233
    v_exp_f32 v146, v146
    v_add_f32 v31, v31, v145
    v_fma_f32 v148, v148, s35, -v233
    v_exp_f32 v147, v147
    s_waitcnt lgkmcnt(4)
    v_mfma_f32_32x32x16_bf16 v[160:175], v[220:223], v[52:55], v[160:175]
    ds_read_b128 v[216:219], v10 offset:57344
    v_add_f32 v31, v31, v146
    v_cvt_pk_bf16_f32 v201, v146, v147
    v_fma_f32 v149, v149, s35, -v233
    v_exp_f32 v148, v148
    s_waitcnt lgkmcnt(4)
    v_mfma_f32_32x32x16_bf16 v[160:175], v[224:227], v[56:59], v[160:175]
    ds_read_b128 v[220:223], v11 offset:57344
    v_add_f32 v31, v31, v147
    v_fma_f32 v150, v150, s35, -v233
    v_exp_f32 v149, v149
    s_waitcnt lgkmcnt(4)
    v_mfma_f32_32x32x16_bf16 v[160:175], v[228:231], v[60:63], v[160:175]
    ds_read_b128 v[224:227], v12 offset:57344
    v_add_f32 v31, v31, v148
    v_cvt_pk_bf16_f32 v202, v148, v149
    v_fma_f32 v151, v151, s35, -v233
    v_exp_f32 v150, v150
    s_waitcnt lgkmcnt(4)
    v_mfma_f32_32x32x16_bf16 v[176:191], v[208:211], v[32:35], 0
    ds_read_b128 v[228:231], v13 offset:57344
    v_add_f32 v31, v31, v149
    v_fma_f32 v152, v152, s35, -v233
    v_exp_f32 v151, v151
    v_add_f32 v31, v31, v150
    v_cvt_pk_bf16_f32 v203, v150, v151
    s_waitcnt lgkmcnt(4)
    v_mfma_f32_32x32x16_bf16 v[176:191], v[212:215], v[36:39], v[176:191]
    ds_read_b128 v[208:211], v14 offset:57344
    v_fma_f32 v153, v153, s35, -v233
    v_exp_f32 v152, v152
    v_add_f32 v31, v31, v151
    v_fma_f32 v154, v154, s35, -v233
    s_waitcnt lgkmcnt(4)
    v_mfma_f32_32x32x16_bf16 v[176:191], v[216:219], v[40:43], v[176:191]
    ds_read_b128 v[212:215], v15 offset:57344
    v_exp_f32 v153, v153
    v_add_f32 v31, v31, v152
    v_cvt_pk_bf16_f32 v204, v152, v153
    v_fma_f32 v155, v155, s35, -v233
    s_waitcnt lgkmcnt(4)
    v_mfma_f32_32x32x16_bf16 v[176:191], v[220:223], v[44:47], v[176:191]
    ds_read_b64_tr_b16 v[216:217], v235 offset:0
    ds_read_b64_tr_b16 v[218:219], v235 offset:2048
    v_exp_f32 v154, v154
    v_add_f32 v31, v31, v153
    v_fma_f32 v156, v156, s35, -v233
    v_exp_f32 v155, v155
    s_waitcnt lgkmcnt(5)
    v_mfma_f32_32x32x16_bf16 v[176:191], v[224:227], v[48:51], v[176:191]
    ds_read_b64_tr_b16 v[220:221], v235 offset:4096
    ds_read_b64_tr_b16 v[222:223], v235 offset:6144
    v_add_f32 v31, v31, v154
    v_cvt_pk_bf16_f32 v205, v154, v155
    v_fma_f32 v157, v157, s35, -v233
    v_exp_f32 v156, v156
    s_waitcnt lgkmcnt(6)
    v_mfma_f32_32x32x16_bf16 v[176:191], v[228:231], v[52:55], v[176:191]
    ds_read_b64_tr_b16 v[224:225], v235 offset:8192
    ds_read_b64_tr_b16 v[226:227], v235 offset:10240
    v_add_f32 v31, v31, v155
    v_fma_f32 v158, v158, s35, -v233
    v_exp_f32 v157, v157
    v_add_f32 v31, v31, v156
    s_waitcnt lgkmcnt(7)
    v_mfma_f32_32x32x16_bf16 v[176:191], v[208:211], v[56:59], v[176:191]
    ds_read_b64_tr_b16 v[228:229], v235 offset:12288
    ds_read_b64_tr_b16 v[230:231], v235 offset:14336
    v_cvt_pk_bf16_f32 v206, v156, v157
    v_fma_f32 v159, v159, s35, -v233
    v_exp_f32 v158, v158
    v_add_f32 v31, v31, v157
    s_waitcnt lgkmcnt(8)
    v_mfma_f32_32x32x16_bf16 v[176:191], v[212:215], v[60:63], v[176:191]
    ds_read_b64_tr_b16 v[208:209], v236 offset:0
    ds_read_b64_tr_b16 v[210:211], v236 offset:2048
    v_exp_f32 v159, v159
    v_add_f32 v31, v31, v158
    v_cvt_pk_bf16_f32 v207, v158, v159
    v_add_f32 v31, v31, v159
    s_nop 0
    s_waitcnt vmcnt(2)
    s_barrier
    s_waitcnt lgkmcnt(8)
    v_mfma_f32_32x32x16_bf16 v[64:79], v[216:219], v[192:195], v[64:79]
    ds_read_b64_tr_b16 v[212:213], v236 offset:4096
    ds_read_b64_tr_b16 v[214:215], v236 offset:6144
    v_max3_f32 v2, v160, v161, v162
    v_max3_f32 v3, v163, v164, v165
    v_max3_f32 v4, v166, v167, v168
    v_max3_f32 v5, v169, v170, v171
    v_max3_f32 v2, v2, v172, v173
    v_max3_f32 v3, v3, v174, v175
    v_max3_f32 v4, v4, v176, v177
    v_max3_f32 v5, v5, v178, v179
    v_max3_f32 v2, v2, v180, v181
    v_max3_f32 v3, v3, v182, v183
    v_max3_f32 v4, v4, v184, v185
    s_waitcnt lgkmcnt(8)
    v_mfma_f32_32x32x16_bf16 v[64:79], v[220:223], v[196:199], v[64:79]
    ds_read_b64_tr_b16 v[216:217], v236 offset:8192
    ds_read_b64_tr_b16 v[218:219], v236 offset:10240
    v_max3_f32 v5, v5, v186, v187
    v_max3_f32 v2, v2, v188, v189
    v_max3_f32 v3, v3, v190, v191
    v_max3_f32 v2, v2, v3, v4
    v_max_f32 v2, v2, v5
    v_mov_b32 v3, v2
    s_nop 1
    v_permlane32_swap_b32 v2, v3
    v_max_f32 v2, v2, v3
    v_sub_f32 v3, v2, v30
    s_waitcnt lgkmcnt(8)
    v_mfma_f32_32x32x16_bf16 v[64:79], v[224:227], v[200:203], v[64:79]
    ds_read_b64_tr_b16 v[220:221], v236 offset:12288
    ds_read_b64_tr_b16 v[222:223], v236 offset:14336
    v_cmp_lt_f32 vcc, s62, v3
    s_cbranch_vccnz L_rs1_15
    L_bk1_15:
    v_fma_f32 v160, v160, s35, -v233
    v_fma_f32 v161, v161, s35, -v233
    v_exp_f32 v160, v160
    v_fma_f32 v162, v162, s35, -v233
    v_exp_f32 v161, v161
    v_add_f32 v31, v31, v160
    s_waitcnt lgkmcnt(8)
    v_mfma_f32_32x32x16_bf16 v[64:79], v[228:231], v[204:207], v[64:79]
    ds_read_b64_tr_b16 v[224:225], v237 offset:0
    ds_read_b64_tr_b16 v[226:227], v237 offset:2048
    v_fma_f32 v163, v163, s35, -v233
    v_exp_f32 v162, v162
    v_add_f32 v31, v31, v161
    v_fma_f32 v164, v164, s35, -v233
    v_exp_f32 v163, v163
    v_add_f32 v31, v31, v162
    v_fma_f32 v165, v165, s35, -v233
    v_exp_f32 v164, v164
    s_waitcnt lgkmcnt(8)
    v_mfma_f32_32x32x16_bf16 v[80:95], v[208:211], v[192:195], v[80:95]
    ds_read_b64_tr_b16 v[228:229], v237 offset:4096
    ds_read_b64_tr_b16 v[230:231], v237 offset:6144
    v_add_f32 v31, v31, v163
    v_fma_f32 v166, v166, s35, -v233
    v_exp_f32 v165, v165
    v_add_f32 v31, v31, v164
    v_fma_f32 v167, v167, s35, -v233
    v_exp_f32 v166, v166
    v_add_f32 v31, v31, v165
    v_fma_f32 v168, v168, s35, -v233
    s_waitcnt lgkmcnt(8)
    v_mfma_f32_32x32x16_bf16 v[80:95], v[212:215], v[196:199], v[80:95]
    ds_read_b64_tr_b16 v[208:209], v237 offset:8192
    ds_read_b64_tr_b16 v[210:211], v237 offset:10240
    v_exp_f32 v167, v167
    v_add_f32 v31, v31, v166
    v_fma_f32 v169, v169, s35, -v233
    v_exp_f32 v168, v168
    v_add_f32 v31, v31, v167
    v_fma_f32 v170, v170, s35, -v233
    v_exp_f32 v169, v169
    s_waitcnt lgkmcnt(8)
    v_mfma_f32_32x32x16_bf16 v[80:95], v[216:219], v[200:203], v[80:95]
    ds_read_b64_tr_b16 v[212:213], v237 offset:12288
    ds_read_b64_tr_b16 v[214:215], v237 offset:14336
    v_add_f32 v31, v31, v168
    v_fma_f32 v171, v171, s35, -v233
    v_exp_f32 v170, v170
    v_add_f32 v31, v31, v169
    v_fma_f32 v172, v172, s35, -v233
    v_exp_f32 v171, v171
    v_add_f32 v31, v31, v170
    v_fma_f32 v173, v173, s35, -v233
    v_exp_f32 v172, v172
    s_waitcnt lgkmcnt(8)
    v_mfma_f32_32x32x16_bf16 v[80:95], v[220:223], v[204:207], v[80:95]
    ds_read_b64_tr_b16 v[216:217], v238 offset:0
    ds_read_b64_tr_b16 v[218:219], v238 offset:2048
    v_add_f32 v31, v31, v171
    v_fma_f32 v174, v174, s35, -v233
    v_exp_f32 v173, v173
    v_add_f32 v31, v31, v172
    v_fma_f32 v175, v175, s35, -v233
    v_exp_f32 v174, v174
    v_add_f32 v31, v31, v173
    s_waitcnt lgkmcnt(8)
    v_mfma_f32_32x32x16_bf16 v[96:111], v[224:227], v[192:195], v[96:111]
    ds_read_b64_tr_b16 v[220:221], v238 offset:4096
    ds_read_b64_tr_b16 v[222:223], v238 offset:6144
    v_fma_f32 v176, v176, s35, -v233
    v_exp_f32 v175, v175
    v_add_f32 v31, v31, v174
    v_fma_f32 v177, v177, s35, -v233
    v_exp_f32 v176, v176
    v_add_f32 v31, v31, v175
    v_fma_f32 v178, v178, s35, -v233
    v_exp_f32 v177, v177
    s_waitcnt lgkmcnt(8)
    v_mfma_f32_32x32x16_bf16 v[96:111], v[228:231], v[196:199], v[96:111]
    ds_read_b64_tr_b16 v[224:225], v238 offset:8192
    ds_read_b64_tr_b16 v[226:227], v238 offset:10240
    v_add_f32 v31, v31, v176
    v_fma_f32 v179, v179, s35, -v233
    v_exp_f32 v178, v178
    v_add_f32 v31, v31, v177
    v_fma_f32 v180, v180, s35, -v233
    v_exp_f32 v179, v179
    v_add_f32 v31, v31, v178
    v_fma_f32 v181, v181, s35, -v233
    s_waitcnt lgkmcnt(8)
    v_mfma_f32_32x32x16_bf16 v[96:111], v[208:211], v[200:203], v[96:111]
    ds_read_b64_tr_b16 v[228:229], v238 offset:12288
    ds_read_b64_tr_b16 v[230:231], v238 offset:14336
    v_exp_f32 v180, v180
    v_add_f32 v31, v31, v179
    v_fma_f32 v182, v182, s35, -v233
    v_exp_f32 v181, v181
    v_add_f32 v31, v31, v180
    v_fma_f32 v183, v183, s35, -v233
    v_exp_f32 v182, v182
    v_add_f32 v31, v31, v181
    s_waitcnt lgkmcnt(8)
    v_mfma_f32_32x32x16_bf16 v[96:111], v[212:215], v[204:207], v[96:111]
    ds_read_b64_tr_b16 v[208:209], v16 offset:0
    ds_read_b64_tr_b16 v[210:211], v16 offset:2048
    v_fma_f32 v184, v184, s35, -v233
    v_exp_f32 v183, v183
    v_add_f32 v31, v31, v182
    v_fma_f32 v185, v185, s35, -v233
    v_exp_f32 v184, v184
    v_add_f32 v31, v31, v183
    v_fma_f32 v186, v186, s35, -v233
    v_exp_f32 v185, v185
    s_waitcnt lgkmcnt(8)
    v_mfma_f32_32x32x16_bf16 v[112:127], v[216:219], v[192:195], v[112:127]
    ds_read_b64_tr_b16 v[212:213], v16 offset:4096
    ds_read_b64_tr_b16 v[214:215], v16 offset:6144
    v_add_f32 v31, v31, v184
    v_fma_f32 v187, v187, s35, -v233
    v_exp_f32 v186, v186
    v_add_f32 v31, v31, v185
    v_fma_f32 v188, v188, s35, -v233
    v_exp_f32 v187, v187
    v_add_f32 v31, v31, v186
    v_fma_f32 v189, v189, s35, -v233
    s_waitcnt lgkmcnt(8)
    v_mfma_f32_32x32x16_bf16 v[112:127], v[220:223], v[196:199], v[112:127]
    ds_read_b64_tr_b16 v[216:217], v16 offset:8192
    ds_read_b64_tr_b16 v[218:219], v16 offset:10240
    v_exp_f32 v188, v188
    v_add_f32 v31, v31, v187
    v_fma_f32 v190, v190, s35, -v233
    v_exp_f32 v189, v189
    v_add_f32 v31, v31, v188
    v_fma_f32 v191, v191, s35, -v233
    v_exp_f32 v190, v190
    s_waitcnt lgkmcnt(8)
    v_mfma_f32_32x32x16_bf16 v[112:127], v[224:227], v[200:203], v[112:127]
    ds_read_b64_tr_b16 v[220:221], v16 offset:12288
    ds_read_b64_tr_b16 v[222:223], v16 offset:14336
    v_add_f32 v31, v31, v189
    v_exp_f32 v191, v191
    v_add_f32 v31, v31, v190
    v_add_f32 v31, v31, v191
    s_waitcnt lgkmcnt(8)
    v_mfma_f32_32x32x16_bf16 v[112:127], v[228:231], v[204:207], v[112:127]
    ds_read_b64_tr_b16 v[224:225], v17 offset:0
    ds_read_b64_tr_b16 v[226:227], v17 offset:2048
    s_cmp_lg_u32 s61, 0
    s_cbranch_scc1 L_rs2_15
L_bk2_15:
    v_cvt_pk_bf16_f32 v192, v160, v161
    v_cvt_pk_bf16_f32 v193, v162, v163
    v_cvt_pk_bf16_f32 v194, v164, v165
    v_cvt_pk_bf16_f32 v195, v166, v167
    v_cvt_pk_bf16_f32 v196, v168, v169
    v_cvt_pk_bf16_f32 v197, v170, v171
    v_cvt_pk_bf16_f32 v198, v172, v173
    v_cvt_pk_bf16_f32 v199, v174, v175
    v_cvt_pk_bf16_f32 v200, v176, v177
    v_cvt_pk_bf16_f32 v201, v178, v179
    v_cvt_pk_bf16_f32 v202, v180, v181
    v_cvt_pk_bf16_f32 v203, v182, v183
    v_cvt_pk_bf16_f32 v204, v184, v185
    v_cvt_pk_bf16_f32 v205, v186, v187
    v_cvt_pk_bf16_f32 v206, v188, v189
    v_cvt_pk_bf16_f32 v207, v190, v191
    s_nop 0
    s_waitcnt lgkmcnt(8)
    v_mfma_f32_32x32x16_bf16 v[64:79], v[208:211], v[192:195], v[64:79]
    ds_read_b64_tr_b16 v[228:229], v17 offset:4096
    ds_read_b64_tr_b16 v[230:231], v17 offset:6144
    s_waitcnt lgkmcnt(8)
    v_mfma_f32_32x32x16_bf16 v[64:79], v[212:215], v[196:199], v[64:79]
    ds_read_b64_tr_b16 v[208:209], v17 offset:8192
    ds_read_b64_tr_b16 v[210:211], v17 offset:10240
    s_waitcnt lgkmcnt(8)
    v_mfma_f32_32x32x16_bf16 v[64:79], v[216:219], v[200:203], v[64:79]
    ds_read_b64_tr_b16 v[212:213], v17 offset:12288
    ds_read_b64_tr_b16 v[214:215], v17 offset:14336
    s_waitcnt lgkmcnt(8)
    v_mfma_f32_32x32x16_bf16 v[64:79], v[220:223], v[204:207], v[64:79]
    ds_read_b64_tr_b16 v[216:217], v18 offset:0
    ds_read_b64_tr_b16 v[218:219], v18 offset:2048
    s_waitcnt lgkmcnt(8)
    v_mfma_f32_32x32x16_bf16 v[80:95], v[224:227], v[192:195], v[80:95]
    ds_read_b64_tr_b16 v[220:221], v18 offset:4096
    ds_read_b64_tr_b16 v[222:223], v18 offset:6144
    s_waitcnt lgkmcnt(8)
    v_mfma_f32_32x32x16_bf16 v[80:95], v[228:231], v[196:199], v[80:95]
    ds_read_b64_tr_b16 v[224:225], v18 offset:8192
    ds_read_b64_tr_b16 v[226:227], v18 offset:10240
    s_waitcnt lgkmcnt(8)
    v_mfma_f32_32x32x16_bf16 v[80:95], v[208:211], v[200:203], v[80:95]
    ds_read_b64_tr_b16 v[228:229], v18 offset:12288
    ds_read_b64_tr_b16 v[230:231], v18 offset:14336
    s_waitcnt lgkmcnt(8)
    v_mfma_f32_32x32x16_bf16 v[80:95], v[212:215], v[204:207], v[80:95]
    ds_read_b64_tr_b16 v[208:209], v19 offset:0
    ds_read_b64_tr_b16 v[210:211], v19 offset:2048
    s_waitcnt lgkmcnt(8)
    v_mfma_f32_32x32x16_bf16 v[96:111], v[216:219], v[192:195], v[96:111]
    ds_read_b64_tr_b16 v[212:213], v19 offset:4096
    ds_read_b64_tr_b16 v[214:215], v19 offset:6144
    s_waitcnt lgkmcnt(8)
    v_mfma_f32_32x32x16_bf16 v[96:111], v[220:223], v[196:199], v[96:111]
    ds_read_b64_tr_b16 v[216:217], v19 offset:8192
    ds_read_b64_tr_b16 v[218:219], v19 offset:10240
    s_waitcnt lgkmcnt(8)
    v_mfma_f32_32x32x16_bf16 v[96:111], v[224:227], v[200:203], v[96:111]
    ds_read_b64_tr_b16 v[220:221], v19 offset:12288
    ds_read_b64_tr_b16 v[222:223], v19 offset:14336
    s_waitcnt lgkmcnt(8)
    v_mfma_f32_32x32x16_bf16 v[96:111], v[228:231], v[204:207], v[96:111]
    s_waitcnt lgkmcnt(6)
    v_mfma_f32_32x32x16_bf16 v[112:127], v[208:211], v[192:195], v[112:127]
    s_waitcnt lgkmcnt(4)
    v_mfma_f32_32x32x16_bf16 v[112:127], v[212:215], v[196:199], v[112:127]
    s_waitcnt lgkmcnt(2)
    v_mfma_f32_32x32x16_bf16 v[112:127], v[216:219], v[200:203], v[112:127]
    s_waitcnt lgkmcnt(0)
    v_mfma_f32_32x32x16_bf16 v[112:127], v[220:223], v[204:207], v[112:127]
    v_mov_b32 v3, v31
    s_nop 1
    v_permlane32_swap_b32 v31, v3
    v_add_f32 v31, v31, v3
    v_rcp_f32 v232, v31
    s_nop 7
    s_nop 7
    s_mov_b32 s54, 4096
    v_mul_f32 v64, v64, v232
    v_mul_f32 v65, v65, v232
    v_mul_f32 v66, v66, v232
    v_mul_f32 v67, v67, v232
    v_mul_f32 v68, v68, v232
    v_mul_f32 v69, v69, v232
    v_mul_f32 v70, v70, v232
    v_mul_f32 v71, v71, v232
    v_cvt_pk_bf16_f32 v192, v64, v65
    v_cvt_pk_bf16_f32 v193, v66, v67
    v_cvt_pk_bf16_f32 v194, v68, v69
    v_cvt_pk_bf16_f32 v195, v70, v71
    buffer_store_dwordx4 v[192:195], v234, s[28:31], 0 offen offset:0
    v_mul_f32 v72, v72, v232
    v_mul_f32 v73, v73, v232
    v_mul_f32 v74, v74, v232
    v_mul_f32 v75, v75, v232
    v_mul_f32 v76, v76, v232
    v_mul_f32 v77, v77, v232
    v_mul_f32 v78, v78, v232
    v_mul_f32 v79, v79, v232
    v_cvt_pk_bf16_f32 v196, v72, v73
    v_cvt_pk_bf16_f32 v197, v74, v75
    v_cvt_pk_bf16_f32 v198, v76, v77
    v_cvt_pk_bf16_f32 v199, v78, v79
    buffer_store_dwordx4 v[196:199], v234, s[28:31], 0 offen offset:1024
    v_mul_f32 v80, v80, v232
    v_mul_f32 v81, v81, v232
    v_mul_f32 v82, v82, v232
    v_mul_f32 v83, v83, v232
    v_mul_f32 v84, v84, v232
    v_mul_f32 v85, v85, v232
    v_mul_f32 v86, v86, v232
    v_mul_f32 v87, v87, v232
    v_cvt_pk_bf16_f32 v200, v80, v81
    v_cvt_pk_bf16_f32 v201, v82, v83
    v_cvt_pk_bf16_f32 v202, v84, v85
    v_cvt_pk_bf16_f32 v203, v86, v87
    buffer_store_dwordx4 v[200:203], v234, s[28:31], 0 offen offset:2048
    v_mul_f32 v88, v88, v232
    v_mul_f32 v89, v89, v232
    v_mul_f32 v90, v90, v232
    v_mul_f32 v91, v91, v232
    v_mul_f32 v92, v92, v232
    v_mul_f32 v93, v93, v232
    v_mul_f32 v94, v94, v232
    v_mul_f32 v95, v95, v232
    v_cvt_pk_bf16_f32 v204, v88, v89
    v_cvt_pk_bf16_f32 v205, v90, v91
    v_cvt_pk_bf16_f32 v206, v92, v93
    v_cvt_pk_bf16_f32 v207, v94, v95
    buffer_store_dwordx4 v[204:207], v234, s[28:31], 0 offen offset:3072
    v_mul_f32 v96, v96, v232
    v_mul_f32 v97, v97, v232
    v_mul_f32 v98, v98, v232
    v_mul_f32 v99, v99, v232
    v_mul_f32 v100, v100, v232
    v_mul_f32 v101, v101, v232
    v_mul_f32 v102, v102, v232
    v_mul_f32 v103, v103, v232
    v_cvt_pk_bf16_f32 v192, v96, v97
    v_cvt_pk_bf16_f32 v193, v98, v99
    v_cvt_pk_bf16_f32 v194, v100, v101
    v_cvt_pk_bf16_f32 v195, v102, v103
    buffer_store_dwordx4 v[192:195], v234, s[28:31], s54 offen offset:0
    v_mul_f32 v104, v104, v232
    v_mul_f32 v105, v105, v232
    v_mul_f32 v106, v106, v232
    v_mul_f32 v107, v107, v232
    v_mul_f32 v108, v108, v232
    v_mul_f32 v109, v109, v232
    v_mul_f32 v110, v110, v232
    v_mul_f32 v111, v111, v232
    v_cvt_pk_bf16_f32 v196, v104, v105
    v_cvt_pk_bf16_f32 v197, v106, v107
    v_cvt_pk_bf16_f32 v198, v108, v109
    v_cvt_pk_bf16_f32 v199, v110, v111
    buffer_store_dwordx4 v[196:199], v234, s[28:31], s54 offen offset:1024
    v_mul_f32 v112, v112, v232
    v_mul_f32 v113, v113, v232
    v_mul_f32 v114, v114, v232
    v_mul_f32 v115, v115, v232
    v_mul_f32 v116, v116, v232
    v_mul_f32 v117, v117, v232
    v_mul_f32 v118, v118, v232
    v_mul_f32 v119, v119, v232
    v_cvt_pk_bf16_f32 v200, v112, v113
    v_cvt_pk_bf16_f32 v201, v114, v115
    v_cvt_pk_bf16_f32 v202, v116, v117
    v_cvt_pk_bf16_f32 v203, v118, v119
    buffer_store_dwordx4 v[200:203], v234, s[28:31], s54 offen offset:2048
    v_mul_f32 v120, v120, v232
    v_mul_f32 v121, v121, v232
    v_mul_f32 v122, v122, v232
    v_mul_f32 v123, v123, v232
    v_mul_f32 v124, v124, v232
    v_mul_f32 v125, v125, v232
    v_mul_f32 v126, v126, v232
    v_mul_f32 v127, v127, v232
    v_cvt_pk_bf16_f32 v204, v120, v121
    v_cvt_pk_bf16_f32 v205, v122, v123
    v_cvt_pk_bf16_f32 v206, v124, v125
    v_cvt_pk_bf16_f32 v207, v126, v127
    buffer_store_dwordx4 v[204:207], v234, s[28:31], s54 offen offset:3072
    s_waitcnt vmcnt(0)
L_attn_done:
    s_endpgm
    L_rs1_0:
    v_max_f32 v2, v2, v30
    v_sub_f32 v3, v30, v2
    v_mul_f32 v3, s35, v3
    v_exp_f32 v232, v3
    v_mov_b32 v30, v2
    v_mul_f32 v233, s35, v2
    s_mov_b32 s61, 1
    v_mul_f32 v31, v31, v232
    s_branch L_bk1_0
    L_rs1_1:
    v_max_f32 v2, v2, v30
    v_sub_f32 v3, v30, v2
    v_mul_f32 v3, s35, v3
    v_exp_f32 v232, v3
    v_mov_b32 v30, v2
    v_mul_f32 v233, s35, v2
    s_mov_b32 s61, 1
    v_mul_f32 v31, v31, v232
    s_branch L_bk1_1
    L_rs2_1:
    s_nop 7
    s_nop 7
    v_mul_f32 v64, v64, v232
    v_mul_f32 v65, v65, v232
    v_mul_f32 v66, v66, v232
    v_mul_f32 v67, v67, v232
    v_mul_f32 v68, v68, v232
    v_mul_f32 v69, v69, v232
    v_mul_f32 v70, v70, v232
    v_mul_f32 v71, v71, v232
    v_mul_f32 v72, v72, v232
    v_mul_f32 v73, v73, v232
    v_mul_f32 v74, v74, v232
    v_mul_f32 v75, v75, v232
    v_mul_f32 v76, v76, v232
    v_mul_f32 v77, v77, v232
    v_mul_f32 v78, v78, v232
    v_mul_f32 v79, v79, v232
    v_mul_f32 v80, v80, v232
    v_mul_f32 v81, v81, v232
    v_mul_f32 v82, v82, v232
    v_mul_f32 v83, v83, v232
    v_mul_f32 v84, v84, v232
    v_mul_f32 v85, v85, v232
    v_mul_f32 v86, v86, v232
    v_mul_f32 v87, v87, v232
    v_mul_f32 v88, v88, v232
    v_mul_f32 v89, v89, v232
    v_mul_f32 v90, v90, v232
    v_mul_f32 v91, v91, v232
    v_mul_f32 v92, v92, v232
    v_mul_f32 v93, v93, v232
    v_mul_f32 v94, v94, v232
    v_mul_f32 v95, v95, v232
    v_mul_f32 v96, v96, v232
    v_mul_f32 v97, v97, v232
    v_mul_f32 v98, v98, v232
    v_mul_f32 v99, v99, v232
    v_mul_f32 v100, v100, v232
    v_mul_f32 v101, v101, v232
    v_mul_f32 v102, v102, v232
    v_mul_f32 v103, v103, v232
    v_mul_f32 v104, v104, v232
    v_mul_f32 v105, v105, v232
    v_mul_f32 v106, v106, v232
    v_mul_f32 v107, v107, v232
    v_mul_f32 v108, v108, v232
    v_mul_f32 v109, v109, v232
    v_mul_f32 v110, v110, v232
    v_mul_f32 v111, v111, v232
    v_mul_f32 v112, v112, v232
    v_mul_f32 v113, v113, v232
    v_mul_f32 v114, v114, v232
    v_mul_f32 v115, v115, v232
    v_mul_f32 v116, v116, v232
    v_mul_f32 v117, v117, v232
    v_mul_f32 v118, v118, v232
    v_mul_f32 v119, v119, v232
    v_mul_f32 v120, v120, v232
    v_mul_f32 v121, v121, v232
    v_mul_f32 v122, v122, v232
    v_mul_f32 v123, v123, v232
    v_mul_f32 v124, v124, v232
    v_mul_f32 v125, v125, v232
    v_mul_f32 v126, v126, v232
    v_mul_f32 v127, v127, v232
    s_mov_b32 s61, 0
    s_nop 1
    s_branch L_bk2_1
    L_rs1_2:
    v_max_f32 v2, v2, v30
    v_sub_f32 v3, v30, v2
    v_mul_f32 v3, s35, v3
    v_exp_f32 v232, v3
    v_mov_b32 v30, v2
    v_mul_f32 v233, s35, v2
    s_mov_b32 s61, 1
    v_mul_f32 v31, v31, v232
    s_branch L_bk1_2
    L_rs2_2:
    s_nop 7
    s_nop 7
    v_mul_f32 v64, v64, v232
    v_mul_f32 v65, v65, v232
    v_mul_f32 v66, v66, v232
    v_mul_f32 v67, v67, v232
    v_mul_f32 v68, v68, v232
    v_mul_f32 v69, v69, v232
    v_mul_f32 v70, v70, v232
    v_mul_f32 v71, v71, v232
    v_mul_f32 v72, v72, v232
    v_mul_f32 v73, v73, v232
    v_mul_f32 v74, v74, v232
    v_mul_f32 v75, v75, v232
    v_mul_f32 v76, v76, v232
    v_mul_f32 v77, v77, v232
    v_mul_f32 v78, v78, v232
    v_mul_f32 v79, v79, v232
    v_mul_f32 v80, v80, v232
    v_mul_f32 v81, v81, v232
    v_mul_f32 v82, v82, v232
    v_mul_f32 v83, v83, v232
    v_mul_f32 v84, v84, v232
    v_mul_f32 v85, v85, v232
    v_mul_f32 v86, v86, v232
    v_mul_f32 v87, v87, v232
    v_mul_f32 v88, v88, v232
    v_mul_f32 v89, v89, v232
    v_mul_f32 v90, v90, v232
    v_mul_f32 v91, v91, v232
    v_mul_f32 v92, v92, v232
    v_mul_f32 v93, v93, v232
    v_mul_f32 v94, v94, v232
    v_mul_f32 v95, v95, v232
    v_mul_f32 v96, v96, v232
    v_mul_f32 v97, v97, v232
    v_mul_f32 v98, v98, v232
    v_mul_f32 v99, v99, v232
    v_mul_f32 v100, v100, v232
    v_mul_f32 v101, v101, v232
    v_mul_f32 v102, v102, v232
    v_mul_f32 v103, v103, v232
    v_mul_f32 v104, v104, v232
    v_mul_f32 v105, v105, v232
    v_mul_f32 v106, v106, v232
    v_mul_f32 v107, v107, v232
    v_mul_f32 v108, v108, v232
    v_mul_f32 v109, v109, v232
    v_mul_f32 v110, v110, v232
    v_mul_f32 v111, v111, v232
    v_mul_f32 v112, v112, v232
    v_mul_f32 v113, v113, v232
    v_mul_f32 v114, v114, v232
    v_mul_f32 v115, v115, v232
    v_mul_f32 v116, v116, v232
    v_mul_f32 v117, v117, v232
    v_mul_f32 v118, v118, v232
    v_mul_f32 v119, v119, v232
    v_mul_f32 v120, v120, v232
    v_mul_f32 v121, v121, v232
    v_mul_f32 v122, v122, v232
    v_mul_f32 v123, v123, v232
    v_mul_f32 v124, v124, v232
    v_mul_f32 v125, v125, v232
    v_mul_f32 v126, v126, v232
    v_mul_f32 v127, v127, v232
    s_mov_b32 s61, 0
    s_nop 1
    s_branch L_bk2_2
    L_rs1_3:
    v_max_f32 v2, v2, v30
    v_sub_f32 v3, v30, v2
    v_mul_f32 v3, s35, v3
    v_exp_f32 v232, v3
    v_mov_b32 v30, v2
    v_mul_f32 v233, s35, v2
    s_mov_b32 s61, 1
    v_mul_f32 v31, v31, v232
    s_branch L_bk1_3
    L_rs2_3:
    s_nop 7
    s_nop 7
    v_mul_f32 v64, v64, v232
    v_mul_f32 v65, v65, v232
    v_mul_f32 v66, v66, v232
    v_mul_f32 v67, v67, v232
    v_mul_f32 v68, v68, v232
    v_mul_f32 v69, v69, v232
    v_mul_f32 v70, v70, v232
    v_mul_f32 v71, v71, v232
    v_mul_f32 v72, v72, v232
    v_mul_f32 v73, v73, v232
    v_mul_f32 v74, v74, v232
    v_mul_f32 v75, v75, v232
    v_mul_f32 v76, v76, v232
    v_mul_f32 v77, v77, v232
    v_mul_f32 v78, v78, v232
    v_mul_f32 v79, v79, v232
    v_mul_f32 v80, v80, v232
    v_mul_f32 v81, v81, v232
    v_mul_f32 v82, v82, v232
    v_mul_f32 v83, v83, v232
    v_mul_f32 v84, v84, v232
    v_mul_f32 v85, v85, v232
    v_mul_f32 v86, v86, v232
    v_mul_f32 v87, v87, v232
    v_mul_f32 v88, v88, v232
    v_mul_f32 v89, v89, v232
    v_mul_f32 v90, v90, v232
    v_mul_f32 v91, v91, v232
    v_mul_f32 v92, v92, v232
    v_mul_f32 v93, v93, v232
    v_mul_f32 v94, v94, v232
    v_mul_f32 v95, v95, v232
    v_mul_f32 v96, v96, v232
    v_mul_f32 v97, v97, v232
    v_mul_f32 v98, v98, v232
    v_mul_f32 v99, v99, v232
    v_mul_f32 v100, v100, v232
    v_mul_f32 v101, v101, v232
    v_mul_f32 v102, v102, v232
    v_mul_f32 v103, v103, v232
    v_mul_f32 v104, v104, v232
    v_mul_f32 v105, v105, v232
    v_mul_f32 v106, v106, v232
    v_mul_f32 v107, v107, v232
    v_mul_f32 v108, v108, v232
    v_mul_f32 v109, v109, v232
    v_mul_f32 v110, v110, v232
    v_mul_f32 v111, v111, v232
    v_mul_f32 v112, v112, v232
    v_mul_f32 v113, v113, v232
    v_mul_f32 v114, v114, v232
    v_mul_f32 v115, v115, v232
    v_mul_f32 v116, v116, v232
    v_mul_f32 v117, v117, v232
    v_mul_f32 v118, v118, v232
    v_mul_f32 v119, v119, v232
    v_mul_f32 v120, v120, v232
    v_mul_f32 v121, v121, v232
    v_mul_f32 v122, v122, v232
    v_mul_f32 v123, v123, v232
    v_mul_f32 v124, v124, v232
    v_mul_f32 v125, v125, v232
    v_mul_f32 v126, v126, v232
    v_mul_f32 v127, v127, v232
    s_mov_b32 s61, 0
    s_nop 1
    s_branch L_bk2_3
    L_rs1_4:
    v_max_f32 v2, v2, v30
    v_sub_f32 v3, v30, v2
    v_mul_f32 v3, s35, v3
    v_exp_f32 v232, v3
    v_mov_b32 v30, v2
    v_mul_f32 v233, s35, v2
    s_mov_b32 s61, 1
    v_mul_f32 v31, v31, v232
    s_branch L_bk1_4
    L_rs2_4:
    s_nop 7
    s_nop 7
    v_mul_f32 v64, v64, v232
    v_mul_f32 v65, v65, v232
    v_mul_f32 v66, v66, v232
    v_mul_f32 v67, v67, v232
    v_mul_f32 v68, v68, v232
    v_mul_f32 v69, v69, v232
    v_mul_f32 v70, v70, v232
    v_mul_f32 v71, v71, v232
    v_mul_f32 v72, v72, v232
    v_mul_f32 v73, v73, v232
    v_mul_f32 v74, v74, v232
    v_mul_f32 v75, v75, v232
    v_mul_f32 v76, v76, v232
    v_mul_f32 v77, v77, v232
    v_mul_f32 v78, v78, v232
    v_mul_f32 v79, v79, v232
    v_mul_f32 v80, v80, v232
    v_mul_f32 v81, v81, v232
    v_mul_f32 v82, v82, v232
    v_mul_f32 v83, v83, v232
    v_mul_f32 v84, v84, v232
    v_mul_f32 v85, v85, v232
    v_mul_f32 v86, v86, v232
    v_mul_f32 v87, v87, v232
    v_mul_f32 v88, v88, v232
    v_mul_f32 v89, v89, v232
    v_mul_f32 v90, v90, v232
    v_mul_f32 v91, v91, v232
    v_mul_f32 v92, v92, v232
    v_mul_f32 v93, v93, v232
    v_mul_f32 v94, v94, v232
    v_mul_f32 v95, v95, v232
    v_mul_f32 v96, v96, v232
    v_mul_f32 v97, v97, v232
    v_mul_f32 v98, v98, v232
    v_mul_f32 v99, v99, v232
    v_mul_f32 v100, v100, v232
    v_mul_f32 v101, v101, v232
    v_mul_f32 v102, v102, v232
    v_mul_f32 v103, v103, v232
    v_mul_f32 v104, v104, v232
    v_mul_f32 v105, v105, v232
    v_mul_f32 v106, v106, v232
    v_mul_f32 v107, v107, v232
    v_mul_f32 v108, v108, v232
    v_mul_f32 v109, v109, v232
    v_mul_f32 v110, v110, v232
    v_mul_f32 v111, v111, v232
    v_mul_f32 v112, v112, v232
    v_mul_f32 v113, v113, v232
    v_mul_f32 v114, v114, v232
    v_mul_f32 v115, v115, v232
    v_mul_f32 v116, v116, v232
    v_mul_f32 v117, v117, v232
    v_mul_f32 v118, v118, v232
    v_mul_f32 v119, v119, v232
    v_mul_f32 v120, v120, v232
    v_mul_f32 v121, v121, v232
    v_mul_f32 v122, v122, v232
    v_mul_f32 v123, v123, v232
    v_mul_f32 v124, v124, v232
    v_mul_f32 v125, v125, v232
    v_mul_f32 v126, v126, v232
    v_mul_f32 v127, v127, v232
    s_mov_b32 s61, 0
    s_nop 1
    s_branch L_bk2_4
    L_rs1_5:
    v_max_f32 v2, v2, v30
    v_sub_f32 v3, v30, v2
    v_mul_f32 v3, s35, v3
    v_exp_f32 v232, v3
    v_mov_b32 v30, v2
    v_mul_f32 v233, s35, v2
    s_mov_b32 s61, 1
    v_mul_f32 v31, v31, v232
    s_branch L_bk1_5
    L_rs2_5:
    s_nop 7
    s_nop 7
    v_mul_f32 v64, v64, v232
    v_mul_f32 v65, v65, v232
    v_mul_f32 v66, v66, v232
    v_mul_f32 v67, v67, v232
    v_mul_f32 v68, v68, v232
    v_mul_f32 v69, v69, v232
    v_mul_f32 v70, v70, v232
    v_mul_f32 v71, v71, v232
    v_mul_f32 v72, v72, v232
    v_mul_f32 v73, v73, v232
    v_mul_f32 v74, v74, v232
    v_mul_f32 v75, v75, v232
    v_mul_f32 v76, v76, v232
    v_mul_f32 v77, v77, v232
    v_mul_f32 v78, v78, v232
    v_mul_f32 v79, v79, v232
    v_mul_f32 v80, v80, v232
    v_mul_f32 v81, v81, v232
    v_mul_f32 v82, v82, v232
    v_mul_f32 v83, v83, v232
    v_mul_f32 v84, v84, v232
    v_mul_f32 v85, v85, v232
    v_mul_f32 v86, v86, v232
    v_mul_f32 v87, v87, v232
    v_mul_f32 v88, v88, v232
    v_mul_f32 v89, v89, v232
    v_mul_f32 v90, v90, v232
    v_mul_f32 v91, v91, v232
    v_mul_f32 v92, v92, v232
    v_mul_f32 v93, v93, v232
    v_mul_f32 v94, v94, v232
    v_mul_f32 v95, v95, v232
    v_mul_f32 v96, v96, v232
    v_mul_f32 v97, v97, v232
    v_mul_f32 v98, v98, v232
    v_mul_f32 v99, v99, v232
    v_mul_f32 v100, v100, v232
    v_mul_f32 v101, v101, v232
    v_mul_f32 v102, v102, v232
    v_mul_f32 v103, v103, v232
    v_mul_f32 v104, v104, v232
    v_mul_f32 v105, v105, v232
    v_mul_f32 v106, v106, v232
    v_mul_f32 v107, v107, v232
    v_mul_f32 v108, v108, v232
    v_mul_f32 v109, v109, v232
    v_mul_f32 v110, v110, v232
    v_mul_f32 v111, v111, v232
    v_mul_f32 v112, v112, v232
    v_mul_f32 v113, v113, v232
    v_mul_f32 v114, v114, v232
    v_mul_f32 v115, v115, v232
    v_mul_f32 v116, v116, v232
    v_mul_f32 v117, v117, v232
    v_mul_f32 v118, v118, v232
    v_mul_f32 v119, v119, v232
    v_mul_f32 v120, v120, v232
    v_mul_f32 v121, v121, v232
    v_mul_f32 v122, v122, v232
    v_mul_f32 v123, v123, v232
    v_mul_f32 v124, v124, v232
    v_mul_f32 v125, v125, v232
    v_mul_f32 v126, v126, v232
    v_mul_f32 v127, v127, v232
    s_mov_b32 s61, 0
    s_nop 1
    s_branch L_bk2_5
    L_rs1_6:
    v_max_f32 v2, v2, v30
    v_sub_f32 v3, v30, v2
    v_mul_f32 v3, s35, v3
    v_exp_f32 v232, v3
    v_mov_b32 v30, v2
    v_mul_f32 v233, s35, v2
    s_mov_b32 s61, 1
    v_mul_f32 v31, v31, v232
    s_branch L_bk1_6
    L_rs2_6:
    s_nop 7
    s_nop 7
    v_mul_f32 v64, v64, v232
    v_mul_f32 v65, v65, v232
    v_mul_f32 v66, v66, v232
    v_mul_f32 v67, v67, v232
    v_mul_f32 v68, v68, v232
    v_mul_f32 v69, v69, v232
    v_mul_f32 v70, v70, v232
    v_mul_f32 v71, v71, v232
    v_mul_f32 v72, v72, v232
    v_mul_f32 v73, v73, v232
    v_mul_f32 v74, v74, v232
    v_mul_f32 v75, v75, v232
    v_mul_f32 v76, v76, v232
    v_mul_f32 v77, v77, v232
    v_mul_f32 v78, v78, v232
    v_mul_f32 v79, v79, v232
    v_mul_f32 v80, v80, v232
    v_mul_f32 v81, v81, v232
    v_mul_f32 v82, v82, v232
    v_mul_f32 v83, v83, v232
    v_mul_f32 v84, v84, v232
    v_mul_f32 v85, v85, v232
    v_mul_f32 v86, v86, v232
    v_mul_f32 v87, v87, v232
    v_mul_f32 v88, v88, v232
    v_mul_f32 v89, v89, v232
    v_mul_f32 v90, v90, v232
    v_mul_f32 v91, v91, v232
    v_mul_f32 v92, v92, v232
    v_mul_f32 v93, v93, v232
    v_mul_f32 v94, v94, v232
    v_mul_f32 v95, v95, v232
    v_mul_f32 v96, v96, v232
    v_mul_f32 v97, v97, v232
    v_mul_f32 v98, v98, v232
    v_mul_f32 v99, v99, v232
    v_mul_f32 v100, v100, v232
    v_mul_f32 v101, v101, v232
    v_mul_f32 v102, v102, v232
    v_mul_f32 v103, v103, v232
    v_mul_f32 v104, v104, v232
    v_mul_f32 v105, v105, v232
    v_mul_f32 v106, v106, v232
    v_mul_f32 v107, v107, v232
    v_mul_f32 v108, v108, v232
    v_mul_f32 v109, v109, v232
    v_mul_f32 v110, v110, v232
    v_mul_f32 v111, v111, v232
    v_mul_f32 v112, v112, v232
    v_mul_f32 v113, v113, v232
    v_mul_f32 v114, v114, v232
    v_mul_f32 v115, v115, v232
    v_mul_f32 v116, v116, v232
    v_mul_f32 v117, v117, v232
    v_mul_f32 v118, v118, v232
    v_mul_f32 v119, v119, v232
    v_mul_f32 v120, v120, v232
    v_mul_f32 v121, v121, v232
    v_mul_f32 v122, v122, v232
    v_mul_f32 v123, v123, v232
    v_mul_f32 v124, v124, v232
    v_mul_f32 v125, v125, v232
    v_mul_f32 v126, v126, v232
    v_mul_f32 v127, v127, v232
    s_mov_b32 s61, 0
    s_nop 1
    s_branch L_bk2_6
    L_rs1_7:
    v_max_f32 v2, v2, v30
    v_sub_f32 v3, v30, v2
    v_mul_f32 v3, s35, v3
    v_exp_f32 v232, v3
    v_mov_b32 v30, v2
    v_mul_f32 v233, s35, v2
    s_mov_b32 s61, 1
    v_mul_f32 v31, v31, v232
    s_branch L_bk1_7
    L_rs2_7:
    s_nop 7
    s_nop 7
    v_mul_f32 v64, v64, v232
    v_mul_f32 v65, v65, v232
    v_mul_f32 v66, v66, v232
    v_mul_f32 v67, v67, v232
    v_mul_f32 v68, v68, v232
    v_mul_f32 v69, v69, v232
    v_mul_f32 v70, v70, v232
    v_mul_f32 v71, v71, v232
    v_mul_f32 v72, v72, v232
    v_mul_f32 v73, v73, v232
    v_mul_f32 v74, v74, v232
    v_mul_f32 v75, v75, v232
    v_mul_f32 v76, v76, v232
    v_mul_f32 v77, v77, v232
    v_mul_f32 v78, v78, v232
    v_mul_f32 v79, v79, v232
    v_mul_f32 v80, v80, v232
    v_mul_f32 v81, v81, v232
    v_mul_f32 v82, v82, v232
    v_mul_f32 v83, v83, v232
    v_mul_f32 v84, v84, v232
    v_mul_f32 v85, v85, v232
    v_mul_f32 v86, v86, v232
    v_mul_f32 v87, v87, v232
    v_mul_f32 v88, v88, v232
    v_mul_f32 v89, v89, v232
    v_mul_f32 v90, v90, v232
    v_mul_f32 v91, v91, v232
    v_mul_f32 v92, v92, v232
    v_mul_f32 v93, v93, v232
    v_mul_f32 v94, v94, v232
    v_mul_f32 v95, v95, v232
    v_mul_f32 v96, v96, v232
    v_mul_f32 v97, v97, v232
    v_mul_f32 v98, v98, v232
    v_mul_f32 v99, v99, v232
    v_mul_f32 v100, v100, v232
    v_mul_f32 v101, v101, v232
    v_mul_f32 v102, v102, v232
    v_mul_f32 v103, v103, v232
    v_mul_f32 v104, v104, v232
    v_mul_f32 v105, v105, v232
    v_mul_f32 v106, v106, v232
    v_mul_f32 v107, v107, v232
    v_mul_f32 v108, v108, v232
    v_mul_f32 v109, v109, v232
    v_mul_f32 v110, v110, v232
    v_mul_f32 v111, v111, v232
    v_mul_f32 v112, v112, v232
    v_mul_f32 v113, v113, v232
    v_mul_f32 v114, v114, v232
    v_mul_f32 v115, v115, v232
    v_mul_f32 v116, v116, v232
    v_mul_f32 v117, v117, v232
    v_mul_f32 v118, v118, v232
    v_mul_f32 v119, v119, v232
    v_mul_f32 v120, v120, v232
    v_mul_f32 v121, v121, v232
    v_mul_f32 v122, v122, v232
    v_mul_f32 v123, v123, v232
    v_mul_f32 v124, v124, v232
    v_mul_f32 v125, v125, v232
    v_mul_f32 v126, v126, v232
    v_mul_f32 v127, v127, v232
    s_mov_b32 s61, 0
    s_nop 1
    s_branch L_bk2_7
    L_rs1_8:
    v_max_f32 v2, v2, v30
    v_sub_f32 v3, v30, v2
    v_mul_f32 v3, s35, v3
    v_exp_f32 v232, v3
    v_mov_b32 v30, v2
    v_mul_f32 v233, s35, v2
    s_mov_b32 s61, 1
    v_mul_f32 v31, v31, v232
    s_branch L_bk1_8
    L_rs2_8:
    s_nop 7
    s_nop 7
    v_mul_f32 v64, v64, v232
    v_mul_f32 v65, v65, v232
    v_mul_f32 v66, v66, v232
    v_mul_f32 v67, v67, v232
    v_mul_f32 v68, v68, v232
    v_mul_f32 v69, v69, v232
    v_mul_f32 v70, v70, v232
    v_mul_f32 v71, v71, v232
    v_mul_f32 v72, v72, v232
    v_mul_f32 v73, v73, v232
    v_mul_f32 v74, v74, v232
    v_mul_f32 v75, v75, v232
    v_mul_f32 v76, v76, v232
    v_mul_f32 v77, v77, v232
    v_mul_f32 v78, v78, v232
    v_mul_f32 v79, v79, v232
    v_mul_f32 v80, v80, v232
    v_mul_f32 v81, v81, v232
    v_mul_f32 v82, v82, v232
    v_mul_f32 v83, v83, v232
    v_mul_f32 v84, v84, v232
    v_mul_f32 v85, v85, v232
    v_mul_f32 v86, v86, v232
    v_mul_f32 v87, v87, v232
    v_mul_f32 v88, v88, v232
    v_mul_f32 v89, v89, v232
    v_mul_f32 v90, v90, v232
    v_mul_f32 v91, v91, v232
    v_mul_f32 v92, v92, v232
    v_mul_f32 v93, v93, v232
    v_mul_f32 v94, v94, v232
    v_mul_f32 v95, v95, v232
    v_mul_f32 v96, v96, v232
    v_mul_f32 v97, v97, v232
    v_mul_f32 v98, v98, v232
    v_mul_f32 v99, v99, v232
    v_mul_f32 v100, v100, v232
    v_mul_f32 v101, v101, v232
    v_mul_f32 v102, v102, v232
    v_mul_f32 v103, v103, v232
    v_mul_f32 v104, v104, v232
    v_mul_f32 v105, v105, v232
    v_mul_f32 v106, v106, v232
    v_mul_f32 v107, v107, v232
    v_mul_f32 v108, v108, v232
    v_mul_f32 v109, v109, v232
    v_mul_f32 v110, v110, v232
    v_mul_f32 v111, v111, v232
    v_mul_f32 v112, v112, v232
    v_mul_f32 v113, v113, v232
    v_mul_f32 v114, v114, v232
    v_mul_f32 v115, v115, v232
    v_mul_f32 v116, v116, v232
    v_mul_f32 v117, v117, v232
    v_mul_f32 v118, v118, v232
    v_mul_f32 v119, v119, v232
    v_mul_f32 v120, v120, v232
    v_mul_f32 v121, v121, v232
    v_mul_f32 v122, v122, v232
    v_mul_f32 v123, v123, v232
    v_mul_f32 v124, v124, v232
    v_mul_f32 v125, v125, v232
    v_mul_f32 v126, v126, v232
    v_mul_f32 v127, v127, v232
    s_mov_b32 s61, 0
    s_nop 1
    s_branch L_bk2_8
    L_rs1_9:
    v_max_f32 v2, v2, v30
    v_sub_f32 v3, v30, v2
    v_mul_f32 v3, s35, v3
    v_exp_f32 v232, v3
    v_mov_b32 v30, v2
    v_mul_f32 v233, s35, v2
    s_mov_b32 s61, 1
    v_mul_f32 v31, v31, v232
    s_branch L_bk1_9
    L_rs2_9:
    s_nop 7
    s_nop 7
    v_mul_f32 v64, v64, v232
    v_mul_f32 v65, v65, v232
    v_mul_f32 v66, v66, v232
    v_mul_f32 v67, v67, v232
    v_mul_f32 v68, v68, v232
    v_mul_f32 v69, v69, v232
    v_mul_f32 v70, v70, v232
    v_mul_f32 v71, v71, v232
    v_mul_f32 v72, v72, v232
    v_mul_f32 v73, v73, v232
    v_mul_f32 v74, v74, v232
    v_mul_f32 v75, v75, v232
    v_mul_f32 v76, v76, v232
    v_mul_f32 v77, v77, v232
    v_mul_f32 v78, v78, v232
    v_mul_f32 v79, v79, v232
    v_mul_f32 v80, v80, v232
    v_mul_f32 v81, v81, v232
    v_mul_f32 v82, v82, v232
    v_mul_f32 v83, v83, v232
    v_mul_f32 v84, v84, v232
    v_mul_f32 v85, v85, v232
    v_mul_f32 v86, v86, v232
    v_mul_f32 v87, v87, v232
    v_mul_f32 v88, v88, v232
    v_mul_f32 v89, v89, v232
    v_mul_f32 v90, v90, v232
    v_mul_f32 v91, v91, v232
    v_mul_f32 v92, v92, v232
    v_mul_f32 v93, v93, v232
    v_mul_f32 v94, v94, v232
    v_mul_f32 v95, v95, v232
    v_mul_f32 v96, v96, v232
    v_mul_f32 v97, v97, v232
    v_mul_f32 v98, v98, v232
    v_mul_f32 v99, v99, v232
    v_mul_f32 v100, v100, v232
    v_mul_f32 v101, v101, v232
    v_mul_f32 v102, v102, v232
    v_mul_f32 v103, v103, v232
    v_mul_f32 v104, v104, v232
    v_mul_f32 v105, v105, v232
    v_mul_f32 v106, v106, v232
    v_mul_f32 v107, v107, v232
    v_mul_f32 v108, v108, v232
    v_mul_f32 v109, v109, v232
    v_mul_f32 v110, v110, v232
    v_mul_f32 v111, v111, v232
    v_mul_f32 v112, v112, v232
    v_mul_f32 v113, v113, v232
    v_mul_f32 v114, v114, v232
    v_mul_f32 v115, v115, v232
    v_mul_f32 v116, v116, v232
    v_mul_f32 v117, v117, v232
    v_mul_f32 v118, v118, v232
    v_mul_f32 v119, v119, v232
    v_mul_f32 v120, v120, v232
    v_mul_f32 v121, v121, v232
    v_mul_f32 v122, v122, v232
    v_mul_f32 v123, v123, v232
    v_mul_f32 v124, v124, v232
    v_mul_f32 v125, v125, v232
    v_mul_f32 v126, v126, v232
    v_mul_f32 v127, v127, v232
    s_mov_b32 s61, 0
    s_nop 1
    s_branch L_bk2_9
    L_rs1_10:
    v_max_f32 v2, v2, v30
    v_sub_f32 v3, v30, v2
    v_mul_f32 v3, s35, v3
    v_exp_f32 v232, v3
    v_mov_b32 v30, v2
    v_mul_f32 v233, s35, v2
    s_mov_b32 s61, 1
    v_mul_f32 v31, v31, v232
    s_branch L_bk1_10
    L_rs2_10:
    s_nop 7
    s_nop 7
    v_mul_f32 v64, v64, v232
    v_mul_f32 v65, v65, v232
    v_mul_f32 v66, v66, v232
    v_mul_f32 v67, v67, v232
    v_mul_f32 v68, v68, v232
    v_mul_f32 v69, v69, v232
    v_mul_f32 v70, v70, v232
    v_mul_f32 v71, v71, v232
    v_mul_f32 v72, v72, v232
    v_mul_f32 v73, v73, v232
    v_mul_f32 v74, v74, v232
    v_mul_f32 v75, v75, v232
    v_mul_f32 v76, v76, v232
    v_mul_f32 v77, v77, v232
    v_mul_f32 v78, v78, v232
    v_mul_f32 v79, v79, v232
    v_mul_f32 v80, v80, v232
    v_mul_f32 v81, v81, v232
    v_mul_f32 v82, v82, v232
    v_mul_f32 v83, v83, v232
    v_mul_f32 v84, v84, v232
    v_mul_f32 v85, v85, v232
    v_mul_f32 v86, v86, v232
    v_mul_f32 v87, v87, v232
    v_mul_f32 v88, v88, v232
    v_mul_f32 v89, v89, v232
    v_mul_f32 v90, v90, v232
    v_mul_f32 v91, v91, v232
    v_mul_f32 v92, v92, v232
    v_mul_f32 v93, v93, v232
    v_mul_f32 v94, v94, v232
    v_mul_f32 v95, v95, v232
    v_mul_f32 v96, v96, v232
    v_mul_f32 v97, v97, v232
    v_mul_f32 v98, v98, v232
    v_mul_f32 v99, v99, v232
    v_mul_f32 v100, v100, v232
    v_mul_f32 v101, v101, v232
    v_mul_f32 v102, v102, v232
    v_mul_f32 v103, v103, v232
    v_mul_f32 v104, v104, v232
    v_mul_f32 v105, v105, v232
    v_mul_f32 v106, v106, v232
    v_mul_f32 v107, v107, v232
    v_mul_f32 v108, v108, v232
    v_mul_f32 v109, v109, v232
    v_mul_f32 v110, v110, v232
    v_mul_f32 v111, v111, v232
    v_mul_f32 v112, v112, v232
    v_mul_f32 v113, v113, v232
    v_mul_f32 v114, v114, v232
    v_mul_f32 v115, v115, v232
    v_mul_f32 v116, v116, v232
    v_mul_f32 v117, v117, v232
    v_mul_f32 v118, v118, v232
    v_mul_f32 v119, v119, v232
    v_mul_f32 v120, v120, v232
    v_mul_f32 v121, v121, v232
    v_mul_f32 v122, v122, v232
    v_mul_f32 v123, v123, v232
    v_mul_f32 v124, v124, v232
    v_mul_f32 v125, v125, v232
    v_mul_f32 v126, v126, v232
    v_mul_f32 v127, v127, v232
    s_mov_b32 s61, 0
    s_nop 1
    s_branch L_bk2_10
    L_rs1_11:
    v_max_f32 v2, v2, v30
    v_sub_f32 v3, v30, v2
    v_mul_f32 v3, s35, v3
    v_exp_f32 v232, v3
    v_mov_b32 v30, v2
    v_mul_f32 v233, s35, v2
    s_mov_b32 s61, 1
    v_mul_f32 v31, v31, v232
    s_branch L_bk1_11
    L_rs2_11:
    s_nop 7
    s_nop 7
    v_mul_f32 v64, v64, v232
    v_mul_f32 v65, v65, v232
    v_mul_f32 v66, v66, v232
    v_mul_f32 v67, v67, v232
    v_mul_f32 v68, v68, v232
    v_mul_f32 v69, v69, v232
    v_mul_f32 v70, v70, v232
    v_mul_f32 v71, v71, v232
    v_mul_f32 v72, v72, v232
    v_mul_f32 v73, v73, v232
    v_mul_f32 v74, v74, v232
    v_mul_f32 v75, v75, v232
    v_mul_f32 v76, v76, v232
    v_mul_f32 v77, v77, v232
    v_mul_f32 v78, v78, v232
    v_mul_f32 v79, v79, v232
    v_mul_f32 v80, v80, v232
    v_mul_f32 v81, v81, v232
    v_mul_f32 v82, v82, v232
    v_mul_f32 v83, v83, v232
    v_mul_f32 v84, v84, v232
    v_mul_f32 v85, v85, v232
    v_mul_f32 v86, v86, v232
    v_mul_f32 v87, v87, v232
    v_mul_f32 v88, v88, v232
    v_mul_f32 v89, v89, v232
    v_mul_f32 v90, v90, v232
    v_mul_f32 v91, v91, v232
    v_mul_f32 v92, v92, v232
    v_mul_f32 v93, v93, v232
    v_mul_f32 v94, v94, v232
    v_mul_f32 v95, v95, v232
    v_mul_f32 v96, v96, v232
    v_mul_f32 v97, v97, v232
    v_mul_f32 v98, v98, v232
    v_mul_f32 v99, v99, v232
    v_mul_f32 v100, v100, v232
    v_mul_f32 v101, v101, v232
    v_mul_f32 v102, v102, v232
    v_mul_f32 v103, v103, v232
    v_mul_f32 v104, v104, v232
    v_mul_f32 v105, v105, v232
    v_mul_f32 v106, v106, v232
    v_mul_f32 v107, v107, v232
    v_mul_f32 v108, v108, v232
    v_mul_f32 v109, v109, v232
    v_mul_f32 v110, v110, v232
    v_mul_f32 v111, v111, v232
    v_mul_f32 v112, v112, v232
    v_mul_f32 v113, v113, v232
    v_mul_f32 v114, v114, v232
    v_mul_f32 v115, v115, v232
    v_mul_f32 v116, v116, v232
    v_mul_f32 v117, v117, v232
    v_mul_f32 v118, v118, v232
    v_mul_f32 v119, v119, v232
    v_mul_f32 v120, v120, v232
    v_mul_f32 v121, v121, v232
    v_mul_f32 v122, v122, v232
    v_mul_f32 v123, v123, v232
    v_mul_f32 v124, v124, v232
    v_mul_f32 v125, v125, v232
    v_mul_f32 v126, v126, v232
    v_mul_f32 v127, v127, v232
    s_mov_b32 s61, 0
    s_nop 1
    s_branch L_bk2_11
    L_rs1_12:
    v_max_f32 v2, v2, v30
    v_sub_f32 v3, v30, v2
    v_mul_f32 v3, s35, v3
    v_exp_f32 v232, v3
    v_mov_b32 v30, v2
    v_mul_f32 v233, s35, v2
    s_mov_b32 s61, 1
    v_mul_f32 v31, v31, v232
    s_branch L_bk1_12
    L_rs2_12:
    s_nop 7
    s_nop 7
    v_mul_f32 v64, v64, v232
    v_mul_f32 v65, v65, v232
    v_mul_f32 v66, v66, v232
    v_mul_f32 v67, v67, v232
    v_mul_f32 v68, v68, v232
    v_mul_f32 v69, v69, v232
    v_mul_f32 v70, v70, v232
    v_mul_f32 v71, v71, v232
    v_mul_f32 v72, v72, v232
    v_mul_f32 v73, v73, v232
    v_mul_f32 v74, v74, v232
    v_mul_f32 v75, v75, v232
    v_mul_f32 v76, v76, v232
    v_mul_f32 v77, v77, v232
    v_mul_f32 v78, v78, v232
    v_mul_f32 v79, v79, v232
    v_mul_f32 v80, v80, v232
    v_mul_f32 v81, v81, v232
    v_mul_f32 v82, v82, v232
    v_mul_f32 v83, v83, v232
    v_mul_f32 v84, v84, v232
    v_mul_f32 v85, v85, v232
    v_mul_f32 v86, v86, v232
    v_mul_f32 v87, v87, v232
    v_mul_f32 v88, v88, v232
    v_mul_f32 v89, v89, v232
    v_mul_f32 v90, v90, v232
    v_mul_f32 v91, v91, v232
    v_mul_f32 v92, v92, v232
    v_mul_f32 v93, v93, v232
    v_mul_f32 v94, v94, v232
    v_mul_f32 v95, v95, v232
    v_mul_f32 v96, v96, v232
    v_mul_f32 v97, v97, v232
    v_mul_f32 v98, v98, v232
    v_mul_f32 v99, v99, v232
    v_mul_f32 v100, v100, v232
    v_mul_f32 v101, v101, v232
    v_mul_f32 v102, v102, v232
    v_mul_f32 v103, v103, v232
    v_mul_f32 v104, v104, v232
    v_mul_f32 v105, v105, v232
    v_mul_f32 v106, v106, v232
    v_mul_f32 v107, v107, v232
    v_mul_f32 v108, v108, v232
    v_mul_f32 v109, v109, v232
    v_mul_f32 v110, v110, v232
    v_mul_f32 v111, v111, v232
    v_mul_f32 v112, v112, v232
    v_mul_f32 v113, v113, v232
    v_mul_f32 v114, v114, v232
    v_mul_f32 v115, v115, v232
    v_mul_f32 v116, v116, v232
    v_mul_f32 v117, v117, v232
    v_mul_f32 v118, v118, v232
    v_mul_f32 v119, v119, v232
    v_mul_f32 v120, v120, v232
    v_mul_f32 v121, v121, v232
    v_mul_f32 v122, v122, v232
    v_mul_f32 v123, v123, v232
    v_mul_f32 v124, v124, v232
    v_mul_f32 v125, v125, v232
    v_mul_f32 v126, v126, v232
    v_mul_f32 v127, v127, v232
    s_mov_b32 s61, 0
    s_nop 1
    s_branch L_bk2_12
    L_rs1_13:
    v_max_f32 v2, v2, v30
    v_sub_f32 v3, v30, v2
    v_mul_f32 v3, s35, v3
    v_exp_f32 v232, v3
    v_mov_b32 v30, v2
    v_mul_f32 v233, s35, v2
    s_mov_b32 s61, 1
    v_mul_f32 v31, v31, v232
    s_branch L_bk1_13
    L_rs2_13:
    s_nop 7
    s_nop 7
    v_mul_f32 v64, v64, v232
    v_mul_f32 v65, v65, v232
    v_mul_f32 v66, v66, v232
    v_mul_f32 v67, v67, v232
    v_mul_f32 v68, v68, v232
    v_mul_f32 v69, v69, v232
    v_mul_f32 v70, v70, v232
    v_mul_f32 v71, v71, v232
    v_mul_f32 v72, v72, v232
    v_mul_f32 v73, v73, v232
    v_mul_f32 v74, v74, v232
    v_mul_f32 v75, v75, v232
    v_mul_f32 v76, v76, v232
    v_mul_f32 v77, v77, v232
    v_mul_f32 v78, v78, v232
    v_mul_f32 v79, v79, v232
    v_mul_f32 v80, v80, v232
    v_mul_f32 v81, v81, v232
    v_mul_f32 v82, v82, v232
    v_mul_f32 v83, v83, v232
    v_mul_f32 v84, v84, v232
    v_mul_f32 v85, v85, v232
    v_mul_f32 v86, v86, v232
    v_mul_f32 v87, v87, v232
    v_mul_f32 v88, v88, v232
    v_mul_f32 v89, v89, v232
    v_mul_f32 v90, v90, v232
    v_mul_f32 v91, v91, v232
    v_mul_f32 v92, v92, v232
    v_mul_f32 v93, v93, v232
    v_mul_f32 v94, v94, v232
    v_mul_f32 v95, v95, v232
    v_mul_f32 v96, v96, v232
    v_mul_f32 v97, v97, v232
    v_mul_f32 v98, v98, v232
    v_mul_f32 v99, v99, v232
    v_mul_f32 v100, v100, v232
    v_mul_f32 v101, v101, v232
    v_mul_f32 v102, v102, v232
    v_mul_f32 v103, v103, v232
    v_mul_f32 v104, v104, v232
    v_mul_f32 v105, v105, v232
    v_mul_f32 v106, v106, v232
    v_mul_f32 v107, v107, v232
    v_mul_f32 v108, v108, v232
    v_mul_f32 v109, v109, v232
    v_mul_f32 v110, v110, v232
    v_mul_f32 v111, v111, v232
    v_mul_f32 v112, v112, v232
    v_mul_f32 v113, v113, v232
    v_mul_f32 v114, v114, v232
    v_mul_f32 v115, v115, v232
    v_mul_f32 v116, v116, v232
    v_mul_f32 v117, v117, v232
    v_mul_f32 v118, v118, v232
    v_mul_f32 v119, v119, v232
    v_mul_f32 v120, v120, v232
    v_mul_f32 v121, v121, v232
    v_mul_f32 v122, v122, v232
    v_mul_f32 v123, v123, v232
    v_mul_f32 v124, v124, v232
    v_mul_f32 v125, v125, v232
    v_mul_f32 v126, v126, v232
    v_mul_f32 v127, v127, v232
    s_mov_b32 s61, 0
    s_nop 1
    s_branch L_bk2_13
    L_rs1_14:
    v_max_f32 v2, v2, v30
    v_sub_f32 v3, v30, v2
    v_mul_f32 v3, s35, v3
    v_exp_f32 v232, v3
    v_mov_b32 v30, v2
    v_mul_f32 v233, s35, v2
    s_mov_b32 s61, 1
    v_mul_f32 v31, v31, v232
    s_branch L_bk1_14
    L_rs2_14:
    s_nop 7
    s_nop 7
    v_mul_f32 v64, v64, v232
    v_mul_f32 v65, v65, v232
    v_mul_f32 v66, v66, v232
    v_mul_f32 v67, v67, v232
    v_mul_f32 v68, v68, v232
    v_mul_f32 v69, v69, v232
    v_mul_f32 v70, v70, v232
    v_mul_f32 v71, v71, v232
    v_mul_f32 v72, v72, v232
    v_mul_f32 v73, v73, v232
    v_mul_f32 v74, v74, v232
    v_mul_f32 v75, v75, v232
    v_mul_f32 v76, v76, v232
    v_mul_f32 v77, v77, v232
    v_mul_f32 v78, v78, v232
    v_mul_f32 v79, v79, v232
    v_mul_f32 v80, v80, v232
    v_mul_f32 v81, v81, v232
    v_mul_f32 v82, v82, v232
    v_mul_f32 v83, v83, v232
    v_mul_f32 v84, v84, v232
    v_mul_f32 v85, v85, v232
    v_mul_f32 v86, v86, v232
    v_mul_f32 v87, v87, v232
    v_mul_f32 v88, v88, v232
    v_mul_f32 v89, v89, v232
    v_mul_f32 v90, v90, v232
    v_mul_f32 v91, v91, v232
    v_mul_f32 v92, v92, v232
    v_mul_f32 v93, v93, v232
    v_mul_f32 v94, v94, v232
    v_mul_f32 v95, v95, v232
    v_mul_f32 v96, v96, v232
    v_mul_f32 v97, v97, v232
    v_mul_f32 v98, v98, v232
    v_mul_f32 v99, v99, v232
    v_mul_f32 v100, v100, v232
    v_mul_f32 v101, v101, v232
    v_mul_f32 v102, v102, v232
    v_mul_f32 v103, v103, v232
    v_mul_f32 v104, v104, v232
    v_mul_f32 v105, v105, v232
    v_mul_f32 v106, v106, v232
    v_mul_f32 v107, v107, v232
    v_mul_f32 v108, v108, v232
    v_mul_f32 v109, v109, v232
    v_mul_f32 v110, v110, v232
    v_mul_f32 v111, v111, v232
    v_mul_f32 v112, v112, v232
    v_mul_f32 v113, v113, v232
    v_mul_f32 v114, v114, v232
    v_mul_f32 v115, v115, v232
    v_mul_f32 v116, v116, v232
    v_mul_f32 v117, v117, v232
    v_mul_f32 v118, v118, v232
    v_mul_f32 v119, v119, v232
    v_mul_f32 v120, v120, v232
    v_mul_f32 v121, v121, v232
    v_mul_f32 v122, v122, v232
    v_mul_f32 v123, v123, v232
    v_mul_f32 v124, v124, v232
    v_mul_f32 v125, v125, v232
    v_mul_f32 v126, v126, v232
    v_mul_f32 v127, v127, v232
    s_mov_b32 s61, 0
    s_nop 1
    s_branch L_bk2_14
    L_rs1_15:
    v_max_f32 v2, v2, v30
    v_sub_f32 v3, v30, v2
    v_mul_f32 v3, s35, v3
    v_exp_f32 v232, v3
    v_mov_b32 v30, v2
    v_mul_f32 v233, s35, v2
    s_mov_b32 s61, 1
    v_mul_f32 v31, v31, v232
    s_branch L_bk1_15
    L_rs2_15:
    s_nop 7
    s_nop 7
    v_mul_f32 v64, v64, v232
    v_mul_f32 v65, v65, v232
    v_mul_f32 v66, v66, v232
    v_mul_f32 v67, v67, v232
    v_mul_f32 v68, v68, v232
    v_mul_f32 v69, v69, v232
    v_mul_f32 v70, v70, v232
    v_mul_f32 v71, v71, v232
    v_mul_f32 v72, v72, v232
    v_mul_f32 v73, v73, v232
    v_mul_f32 v74, v74, v232
    v_mul_f32 v75, v75, v232
    v_mul_f32 v76, v76, v232
    v_mul_f32 v77, v77, v232
    v_mul_f32 v78, v78, v232
    v_mul_f32 v79, v79, v232
    v_mul_f32 v80, v80, v232
    v_mul_f32 v81, v81, v232
    v_mul_f32 v82, v82, v232
    v_mul_f32 v83, v83, v232
    v_mul_f32 v84, v84, v232
    v_mul_f32 v85, v85, v232
    v_mul_f32 v86, v86, v232
    v_mul_f32 v87, v87, v232
    v_mul_f32 v88, v88, v232
    v_mul_f32 v89, v89, v232
    v_mul_f32 v90, v90, v232
    v_mul_f32 v91, v91, v232
    v_mul_f32 v92, v92, v232
    v_mul_f32 v93, v93, v232
    v_mul_f32 v94, v94, v232
    v_mul_f32 v95, v95, v232
    v_mul_f32 v96, v96, v232
    v_mul_f32 v97, v97, v232
    v_mul_f32 v98, v98, v232
    v_mul_f32 v99, v99, v232
    v_mul_f32 v100, v100, v232
    v_mul_f32 v101, v101, v232
    v_mul_f32 v102, v102, v232
    v_mul_f32 v103, v103, v232
    v_mul_f32 v104, v104, v232
    v_mul_f32 v105, v105, v232
    v_mul_f32 v106, v106, v232
    v_mul_f32 v107, v107, v232
    v_mul_f32 v108, v108, v232
    v_mul_f32 v109, v109, v232
    v_mul_f32 v110, v110, v232
    v_mul_f32 v111, v111, v232
    v_mul_f32 v112, v112, v232
    v_mul_f32 v113, v113, v232
    v_mul_f32 v114, v114, v232
    v_mul_f32 v115, v115, v232
    v_mul_f32 v116, v116, v232
    v_mul_f32 v117, v117, v232
    v_mul_f32 v118, v118, v232
    v_mul_f32 v119, v119, v232
    v_mul_f32 v120, v120, v232
    v_mul_f32 v121, v121, v232
    v_mul_f32 v122, v122, v232
    v_mul_f32 v123, v123, v232
    v_mul_f32 v124, v124, v232
    v_mul_f32 v125, v125, v232
    v_mul_f32 v126, v126, v232
    v_mul_f32 v127, v127, v232
    s_mov_b32 s61, 0
    s_nop 1
    s_branch L_bk2_15
.globl oproj_kernel
.p2align 8
.type oproj_kernel,@function
oproj_kernel:
    s_cmp_ge_u32 s2, 256
    s_cbranch_scc1 L_gemm_done
    s_load_dwordx2 s[46:47], s[0:1], 40
    s_load_dwordx2 s[52:53], s[0:1], 56
    s_lshr_b32 s3, s2, 6
    s_lshl_b32 s3, s3, 3
    s_and_b32 s33, s2, 7
    s_add_u32 s3, s3, s33
    s_bfe_u32 s33, s2, 0x30003
    v_lshrrev_b32 v7, 6, v0
    v_and_b32 v1, 63, v0
    s_nop 0
    v_readfirstlane_b32 s34, v7
    v_lshlrev_b32 v2, 4, v1
    v_add_u32 v3, 262144, v2
    s_waitcnt lgkmcnt(0)
    s_lshl_b32 s54, s3, 19
    s_lshl_b32 s55, s34, 15
    s_add_u32 s54, s54, s55
    s_add_u32 s12, s52, s54
    s_addc_u32 s13, s53, 0
    s_sub_u32 s14, 16777216, s54
    s_mov_b32 s15, 0x00020000
    s_lshl_b32 s54, s33, 19
    s_add_u32 s54, s54, s55
    s_sub_u32 s18, 4194304, s54
    s_add_u32 s54, s54, 33554432
    s_add_u32 s16, s52, s54
    s_addc_u32 s17, s53, 0
    s_mov_b32 s19, 0x00020000
    s_mov_b32 s36, 0
    buffer_load_dwordx4 v[16:19], v2, s[12:15], s36 offen offset:0
    buffer_load_dwordx4 v[20:23], v2, s[12:15], s36 offen offset:1024
    buffer_load_dwordx4 v[24:27], v3, s[12:15], s36 offen offset:0
    buffer_load_dwordx4 v[28:31], v3, s[12:15], s36 offen offset:1024
    buffer_load_dwordx4 v[32:35], v2, s[16:19], s36 offen offset:0
    buffer_load_dwordx4 v[36:39], v2, s[16:19], s36 offen offset:1024
    buffer_load_dwordx4 v[40:43], v3, s[16:19], s36 offen offset:0
    buffer_load_dwordx4 v[44:47], v3, s[16:19], s36 offen offset:1024
    s_add_u32 s36, s36, 2048
    buffer_load_dwordx4 v[48:51], v2, s[12:15], s36 offen offset:0
    buffer_load_dwordx4 v[52:55], v2, s[12:15], s36 offen offset:1024
    buffer_load_dwordx4 v[56:59], v3, s[12:15], s36 offen offset:0
    buffer_load_dwordx4 v[60:63], v3, s[12:15], s36 offen offset:1024
    buffer_load_dwordx4 v[64:67], v2, s[16:19], s36 offen offset:0
    buffer_load_dwordx4 v[68:71], v2, s[16:19], s36 offen offset:1024
    buffer_load_dwordx4 v[72:75], v3, s[16:19], s36 offen offset:0
    buffer_load_dwordx4 v[76:79], v3, s[16:19], s36 offen offset:1024
    s_add_u32 s36, s36, 2048
    buffer_load_dwordx4 v[80:83], v2, s[12:15], s36 offen offset:0
    buffer_load_dwordx4 v[84:87], v2, s[12:15], s36 offen offset:1024
    buffer_load_dwordx4 v[88:91], v3, s[12:15], s36 offen offset:0
    buffer_load_dwordx4 v[92:95], v3, s[12:15], s36 offen offset:1024
    buffer_load_dwordx4 v[96:99], v2, s[16:19], s36 offen offset:0
    buffer_load_dwordx4 v[100:103], v2, s[16:19], s36 offen offset:1024
    buffer_load_dwordx4 v[104:107], v3, s[16:19], s36 offen offset:0
    buffer_load_dwordx4 v[108:111], v3, s[16:19], s36 offen offset:1024
    s_add_u32 s36, s36, 2048
    buffer_load_dwordx4 v[112:115], v2, s[12:15], s36 offen offset:0
    buffer_load_dwordx4 v[116:119], v2, s[12:15], s36 offen offset:1024
    buffer_load_dwordx4 v[120:123], v3, s[12:15], s36 offen offset:0
    buffer_load_dwordx4 v[124:127], v3, s[12:15], s36 offen offset:1024
    buffer_load_dwordx4 v[128:131], v2, s[16:19], s36 offen offset:0
    buffer_load_dwordx4 v[132:135], v2, s[16:19], s36 offen offset:1024
    buffer_load_dwordx4 v[136:139], v3, s[16:19], s36 offen offset:0
    buffer_load_dwordx4 v[140:143], v3, s[16:19], s36 offen offset:1024
    s_add_u32 s36, s36, 2048
    s_lshl_b32 s54, s3, 16
    s_lshl_b32 s55, s33, 7
    s_add_u32 s54, s54, s55
    s_add_u32 s20, s46, s54
    s_addc_u32 s21, s47, 0
    s_sub_u32 s22, 2097152, s54
    s_mov_b32 s23, 0x00020000
    buffer_load_dwordx4 v[144:147], v2, s[12:15], s36 offen offset:0
    buffer_load_dwordx4 v[148:151], v2, s[12:15], s36 offen offset:1024
    buffer_load_dwordx4 v[152:155], v3, s[12:15], s36 offen offset:0
    buffer_load_dwordx4 v[156:159], v3, s[12:15], s36 offen offset:1024
    buffer_load_dwordx4 v[160:163], v2, s[16:19], s36 offen offset:0
    buffer_load_dwordx4 v[164:167], v2, s[16:19], s36 offen offset:1024
    buffer_load_dwordx4 v[168:171], v3, s[16:19], s36 offen offset:0
    buffer_load_dwordx4 v[172:175], v3, s[16:19], s36 offen offset:1024
    s_add_u32 s36, s36, 2048
    s_waitcnt vmcnt(32)
    v_mfma_f32_32x32x16_bf16 v[176:191], v[32:35], v[16:19], 0
    v_mfma_f32_32x32x16_bf16 v[192:207], v[32:35], v[24:27], 0
    v_mfma_f32_32x32x16_bf16 v[208:223], v[40:43], v[16:19], 0
    v_mfma_f32_32x32x16_bf16 v[224:239], v[40:43], v[24:27], 0
    v_mfma_f32_32x32x16_bf16 v[176:191], v[36:39], v[20:23], v[176:191]
    v_mfma_f32_32x32x16_bf16 v[192:207], v[36:39], v[28:31], v[192:207]
    v_mfma_f32_32x32x16_bf16 v[208:223], v[44:47], v[20:23], v[208:223]
    v_mfma_f32_32x32x16_bf16 v[224:239], v[44:47], v[28:31], v[224:239]
    buffer_load_dwordx4 v[16:19], v2, s[12:15], s36 offen offset:0
    buffer_load_dwordx4 v[20:23], v2, s[12:15], s36 offen offset:1024
    buffer_load_dwordx4 v[24:27], v3, s[12:15], s36 offen offset:0
    buffer_load_dwordx4 v[28:31], v3, s[12:15], s36 offen offset:1024
    buffer_load_dwordx4 v[32:35], v2, s[16:19], s36 offen offset:0
    buffer_load_dwordx4 v[36:39], v2, s[16:19], s36 offen offset:1024
    buffer_load_dwordx4 v[40:43], v3, s[16:19], s36 offen offset:0
    buffer_load_dwordx4 v[44:47], v3, s[16:19], s36 offen offset:1024
    s_add_u32 s36, s36, 2048
    s_waitcnt vmcnt(32)
    v_mfma_f32_32x32x16_bf16 v[176:191], v[64:67], v[48:51], v[176:191]
    v_mfma_f32_32x32x16_bf16 v[192:207], v[64:67], v[56:59], v[192:207]
    v_mfma_f32_32x32x16_bf16 v[208:223], v[72:75], v[48:51], v[208:223]
    v_mfma_f32_32x32x16_bf16 v[224:239], v[72:75], v[56:59], v[224:239]
    v_mfma_f32_32x32x16_bf16 v[176:191], v[68:71], v[52:55], v[176:191]
    v_mfma_f32_32x32x16_bf16 v[192:207], v[68:71], v[60:63], v[192:207]
    v_mfma_f32_32x32x16_bf16 v[208:223], v[76:79], v[52:55], v[208:223]
    v_mfma_f32_32x32x16_bf16 v[224:239], v[76:79], v[60:63], v[224:239]
    buffer_load_dwordx4 v[48:51], v2, s[12:15], s36 offen offset:0
    buffer_load_dwordx4 v[52:55], v2, s[12:15], s36 offen offset:1024
    buffer_load_dwordx4 v[56:59], v3, s[12:15], s36 offen offset:0
    buffer_load_dwordx4 v[60:63], v3, s[12:15], s36 offen offset:1024
    buffer_load_dwordx4 v[64:67], v2, s[16:19], s36 offen offset:0
    buffer_load_dwordx4 v[68:71], v2, s[16:19], s36 offen offset:1024
    buffer_load_dwordx4 v[72:75], v3, s[16:19], s36 offen offset:0
    buffer_load_dwordx4 v[76:79], v3, s[16:19], s36 offen offset:1024
    s_add_u32 s36, s36, 2048
    s_waitcnt vmcnt(32)
    v_mfma_f32_32x32x16_bf16 v[176:191], v[96:99], v[80:83], v[176:191]
    v_mfma_f32_32x32x16_bf16 v[192:207], v[96:99], v[88:91], v[192:207]
    v_mfma_f32_32x32x16_bf16 v[208:223], v[104:107], v[80:83], v[208:223]
    v_mfma_f32_32x32x16_bf16 v[224:239], v[104:107], v[88:91], v[224:239]
    v_mfma_f32_32x32x16_bf16 v[176:191], v[100:103], v[84:87], v[176:191]
    v_mfma_f32_32x32x16_bf16 v[192:207], v[100:103], v[92:95], v[192:207]
    v_mfma_f32_32x32x16_bf16 v[208:223], v[108:111], v[84:87], v[208:223]
    v_mfma_f32_32x32x16_bf16 v[224:239], v[108:111], v[92:95], v[224:239]
    buffer_load_dwordx4 v[80:83], v2, s[12:15], s36 offen offset:0
    buffer_load_dwordx4 v[84:87], v2, s[12:15], s36 offen offset:1024
    buffer_load_dwordx4 v[88:91], v3, s[12:15], s36 offen offset:0
    buffer_load_dwordx4 v[92:95], v3, s[12:15], s36 offen offset:1024
    buffer_load_dwordx4 v[96:99], v2, s[16:19], s36 offen offset:0
    buffer_load_dwordx4 v[100:103], v2, s[16:19], s36 offen offset:1024
    buffer_load_dwordx4 v[104:107], v3, s[16:19], s36 offen offset:0
    buffer_load_dwordx4 v[108:111], v3, s[16:19], s36 offen offset:1024
    s_add_u32 s36, s36, 2048
    s_waitcnt vmcnt(32)
    v_mfma_f32_32x32x16_bf16 v[176:191], v[128:131], v[112:115], v[176:191]
    v_mfma_f32_32x32x16_bf16 v[192:207], v[128:131], v[120:123], v[192:207]
    v_mfma_f32_32x32x16_bf16 v[208:223], v[136:139], v[112:115], v[208:223]
    v_mfma_f32_32x32x16_bf16 v[224:239], v[136:139], v[120:123], v[224:239]
    v_mfma_f32_32x32x16_bf16 v[176:191], v[132:135], v[116:119], v[176:191]
    v_mfma_f32_32x32x16_bf16 v[192:207], v[132:135], v[124:127], v[192:207]
    v_mfma_f32_32x32x16_bf16 v[208:223], v[140:143], v[116:119], v[208:223]
    v_mfma_f32_32x32x16_bf16 v[224:239], v[140:143], v[124:127], v[224:239]
    buffer_load_dwordx4 v[112:115], v2, s[12:15], s36 offen offset:0
    buffer_load_dwordx4 v[116:119], v2, s[12:15], s36 offen offset:1024
    buffer_load_dwordx4 v[120:123], v3, s[12:15], s36 offen offset:0
    buffer_load_dwordx4 v[124:127], v3, s[12:15], s36 offen offset:1024
    buffer_load_dwordx4 v[128:131], v2, s[16:19], s36 offen offset:0
    buffer_load_dwordx4 v[132:135], v2, s[16:19], s36 offen offset:1024
    buffer_load_dwordx4 v[136:139], v3, s[16:19], s36 offen offset:0
    buffer_load_dwordx4 v[140:143], v3, s[16:19], s36 offen offset:1024
    s_add_u32 s36, s36, 2048
    s_waitcnt vmcnt(32)
    v_mfma_f32_32x32x16_bf16 v[176:191], v[160:163], v[144:147], v[176:191]
    v_mfma_f32_32x32x16_bf16 v[192:207], v[160:163], v[152:155], v[192:207]
    v_mfma_f32_32x32x16_bf16 v[208:223], v[168:171], v[144:147], v[208:223]
    v_mfma_f32_32x32x16_bf16 v[224:239], v[168:171], v[152:155], v[224:239]
    v_mfma_f32_32x32x16_bf16 v[176:191], v[164:167], v[148:151], v[176:191]
    v_mfma_f32_32x32x16_bf16 v[192:207], v[164:167], v[156:159], v[192:207]
    v_mfma_f32_32x32x16_bf16 v[208:223], v[172:175], v[148:151], v[208:223]
    v_mfma_f32_32x32x16_bf16 v[224:239], v[172:175], v[156:159], v[224:239]
    buffer_load_dwordx4 v[144:147], v2, s[12:15], s36 offen offset:0
    buffer_load_dwordx4 v[148:151], v2, s[12:15], s36 offen offset:1024
    buffer_load_dwordx4 v[152:155], v3, s[12:15], s36 offen offset:0
    buffer_load_dwordx4 v[156:159], v3, s[12:15], s36 offen offset:1024
    buffer_load_dwordx4 v[160:163], v2, s[16:19], s36 offen offset:0
    buffer_load_dwordx4 v[164:167], v2, s[16:19], s36 offen offset:1024
    buffer_load_dwordx4 v[168:171], v3, s[16:19], s36 offen offset:0
    buffer_load_dwordx4 v[172:175], v3, s[16:19], s36 offen offset:1024
    s_add_u32 s36, s36, 2048
    s_waitcnt vmcnt(32)
    v_mfma_f32_32x32x16_bf16 v[176:191], v[32:35], v[16:19], v[176:191]
    v_mfma_f32_32x32x16_bf16 v[192:207], v[32:35], v[24:27], v[192:207]
    v_mfma_f32_32x32x16_bf16 v[208:223], v[40:43], v[16:19], v[208:223]
    v_mfma_f32_32x32x16_bf16 v[224:239], v[40:43], v[24:27], v[224:239]
    v_mfma_f32_32x32x16_bf16 v[176:191], v[36:39], v[20:23], v[176:191]
    v_mfma_f32_32x32x16_bf16 v[192:207], v[36:39], v[28:31], v[192:207]
    v_mfma_f32_32x32x16_bf16 v[208:223], v[44:47], v[20:23], v[208:223]
    v_mfma_f32_32x32x16_bf16 v[224:239], v[44:47], v[28:31], v[224:239]
    buffer_load_dwordx4 v[16:19], v2, s[12:15], s36 offen offset:0
    buffer_load_dwordx4 v[20:23], v2, s[12:15], s36 offen offset:1024
    buffer_load_dwordx4 v[24:27], v3, s[12:15], s36 offen offset:0
    buffer_load_dwordx4 v[28:31], v3, s[12:15], s36 offen offset:1024
    buffer_load_dwordx4 v[32:35], v2, s[16:19], s36 offen offset:0
    buffer_load_dwordx4 v[36:39], v2, s[16:19], s36 offen offset:1024
    buffer_load_dwordx4 v[40:43], v3, s[16:19], s36 offen offset:0
    buffer_load_dwordx4 v[44:47], v3, s[16:19], s36 offen offset:1024
    s_add_u32 s36, s36, 2048
    s_waitcnt vmcnt(32)
    v_mfma_f32_32x32x16_bf16 v[176:191], v[64:67], v[48:51], v[176:191]
    v_mfma_f32_32x32x16_bf16 v[192:207], v[64:67], v[56:59], v[192:207]
    v_mfma_f32_32x32x16_bf16 v[208:223], v[72:75], v[48:51], v[208:223]
    v_mfma_f32_32x32x16_bf16 v[224:239], v[72:75], v[56:59], v[224:239]
    v_mfma_f32_32x32x16_bf16 v[176:191], v[68:71], v[52:55], v[176:191]
    v_mfma_f32_32x32x16_bf16 v[192:207], v[68:71], v[60:63], v[192:207]
    v_mfma_f32_32x32x16_bf16 v[208:223], v[76:79], v[52:55], v[208:223]
    v_mfma_f32_32x32x16_bf16 v[224:239], v[76:79], v[60:63], v[224:239]
    buffer_load_dwordx4 v[48:51], v2, s[12:15], s36 offen offset:0
    buffer_load_dwordx4 v[52:55], v2, s[12:15], s36 offen offset:1024
    buffer_load_dwordx4 v[56:59], v3, s[12:15], s36 offen offset:0
    buffer_load_dwordx4 v[60:63], v3, s[12:15], s36 offen offset:1024
    buffer_load_dwordx4 v[64:67], v2, s[16:19], s36 offen offset:0
    buffer_load_dwordx4 v[68:71], v2, s[16:19], s36 offen offset:1024
    buffer_load_dwordx4 v[72:75], v3, s[16:19], s36 offen offset:0
    buffer_load_dwordx4 v[76:79], v3, s[16:19], s36 offen offset:1024
    s_add_u32 s36, s36, 2048
    s_waitcnt vmcnt(32)
    v_mfma_f32_32x32x16_bf16 v[176:191], v[96:99], v[80:83], v[176:191]
    v_mfma_f32_32x32x16_bf16 v[192:207], v[96:99], v[88:91], v[192:207]
    v_mfma_f32_32x32x16_bf16 v[208:223], v[104:107], v[80:83], v[208:223]
    v_mfma_f32_32x32x16_bf16 v[224:239], v[104:107], v[88:91], v[224:239]
    v_mfma_f32_32x32x16_bf16 v[176:191], v[100:103], v[84:87], v[176:191]
    v_mfma_f32_32x32x16_bf16 v[192:207], v[100:103], v[92:95], v[192:207]
    v_mfma_f32_32x32x16_bf16 v[208:223], v[108:111], v[84:87], v[208:223]
    v_mfma_f32_32x32x16_bf16 v[224:239], v[108:111], v[92:95], v[224:239]
    buffer_load_dwordx4 v[80:83], v2, s[12:15], s36 offen offset:0
    buffer_load_dwordx4 v[84:87], v2, s[12:15], s36 offen offset:1024
    buffer_load_dwordx4 v[88:91], v3, s[12:15], s36 offen offset:0
    buffer_load_dwordx4 v[92:95], v3, s[12:15], s36 offen offset:1024
    buffer_load_dwordx4 v[96:99], v2, s[16:19], s36 offen offset:0
    buffer_load_dwordx4 v[100:103], v2, s[16:19], s36 offen offset:1024
    buffer_load_dwordx4 v[104:107], v3, s[16:19], s36 offen offset:0
    buffer_load_dwordx4 v[108:111], v3, s[16:19], s36 offen offset:1024
    s_add_u32 s36, s36, 2048
    s_waitcnt vmcnt(32)
    v_mfma_f32_32x32x16_bf16 v[176:191], v[128:131], v[112:115], v[176:191]
    v_mfma_f32_32x32x16_bf16 v[192:207], v[128:131], v[120:123], v[192:207]
    v_mfma_f32_32x32x16_bf16 v[208:223], v[136:139], v[112:115], v[208:223]
    v_mfma_f32_32x32x16_bf16 v[224:239], v[136:139], v[120:123], v[224:239]
    v_mfma_f32_32x32x16_bf16 v[176:191], v[132:135], v[116:119], v[176:191]
    v_mfma_f32_32x32x16_bf16 v[192:207], v[132:135], v[124:127], v[192:207]
    v_mfma_f32_32x32x16_bf16 v[208:223], v[140:143], v[116:119], v[208:223]
    v_mfma_f32_32x32x16_bf16 v[224:239], v[140:143], v[124:127], v[224:239]
    buffer_load_dwordx4 v[112:115], v2, s[12:15], s36 offen offset:0
    buffer_load_dwordx4 v[116:119], v2, s[12:15], s36 offen offset:1024
    buffer_load_dwordx4 v[120:123], v3, s[12:15], s36 offen offset:0
    buffer_load_dwordx4 v[124:127], v3, s[12:15], s36 offen offset:1024
    buffer_load_dwordx4 v[128:131], v2, s[16:19], s36 offen offset:0
    buffer_load_dwordx4 v[132:135], v2, s[16:19], s36 offen offset:1024
    buffer_load_dwordx4 v[136:139], v3, s[16:19], s36 offen offset:0
    buffer_load_dwordx4 v[140:143], v3, s[16:19], s36 offen offset:1024
    s_add_u32 s36, s36, 2048
    s_waitcnt vmcnt(32)
    v_mfma_f32_32x32x16_bf16 v[176:191], v[160:163], v[144:147], v[176:191]
    v_mfma_f32_32x32x16_bf16 v[192:207], v[160:163], v[152:155], v[192:207]
    v_mfma_f32_32x32x16_bf16 v[208:223], v[168:171], v[144:147], v[208:223]
    v_mfma_f32_32x32x16_bf16 v[224:239], v[168:171], v[152:155], v[224:239]
    v_mfma_f32_32x32x16_bf16 v[176:191], v[164:167], v[148:151], v[176:191]
    v_mfma_f32_32x32x16_bf16 v[192:207], v[164:167], v[156:159], v[192:207]
    v_mfma_f32_32x32x16_bf16 v[208:223], v[172:175], v[148:151], v[208:223]
    v_mfma_f32_32x32x16_bf16 v[224:239], v[172:175], v[156:159], v[224:239]
    buffer_load_dwordx4 v[144:147], v2, s[12:15], s36 offen offset:0
    buffer_load_dwordx4 v[148:151], v2, s[12:15], s36 offen offset:1024
    buffer_load_dwordx4 v[152:155], v3, s[12:15], s36 offen offset:0
    buffer_load_dwordx4 v[156:159], v3, s[12:15], s36 offen offset:1024
    buffer_load_dwordx4 v[160:163], v2, s[16:19], s36 offen offset:0
    buffer_load_dwordx4 v[164:167], v2, s[16:19], s36 offen offset:1024
    buffer_load_dwordx4 v[168:171], v3, s[16:19], s36 offen offset:0
    buffer_load_dwordx4 v[172:175], v3, s[16:19], s36 offen offset:1024
    s_add_u32 s36, s36, 2048
    s_waitcnt vmcnt(32)
    v_mfma_f32_32x32x16_bf16 v[176:191], v[32:35], v[16:19], v[176:191]
    v_mfma_f32_32x32x16_bf16 v[192:207], v[32:35], v[24:27], v[192:207]
    v_mfma_f32_32x32x16_bf16 v[208:223], v[40:43], v[16:19], v[208:223]
    v_mfma_f32_32x32x16_bf16 v[224:239], v[40:43], v[24:27], v[224:239]
    v_mfma_f32_32x32x16_bf16 v[176:191], v[36:39], v[20:23], v[176:191]
    v_mfma_f32_32x32x16_bf16 v[192:207], v[36:39], v[28:31], v[192:207]
    v_mfma_f32_32x32x16_bf16 v[208:223], v[44:47], v[20:23], v[208:223]
    v_mfma_f32_32x32x16_bf16 v[224:239], v[44:47], v[28:31], v[224:239]
    buffer_load_dwordx4 v[16:19], v2, s[12:15], s36 offen offset:0
    buffer_load_dwordx4 v[20:23], v2, s[12:15], s36 offen offset:1024
    buffer_load_dwordx4 v[24:27], v3, s[12:15], s36 offen offset:0
    buffer_load_dwordx4 v[28:31], v3, s[12:15], s36 offen offset:1024
    buffer_load_dwordx4 v[32:35], v2, s[16:19], s36 offen offset:0
    buffer_load_dwordx4 v[36:39], v2, s[16:19], s36 offen offset:1024
    buffer_load_dwordx4 v[40:43], v3, s[16:19], s36 offen offset:0
    buffer_load_dwordx4 v[44:47], v3, s[16:19], s36 offen offset:1024
    s_add_u32 s36, s36, 2048
    s_waitcnt vmcnt(32)
    v_mfma_f32_32x32x16_bf16 v[176:191], v[64:67], v[48:51], v[176:191]
    v_mfma_f32_32x32x16_bf16 v[192:207], v[64:67], v[56:59], v[192:207]
    v_mfma_f32_32x32x16_bf16 v[208:223], v[72:75], v[48:51], v[208:223]
    v_mfma_f32_32x32x16_bf16 v[224:239], v[72:75], v[56:59], v[224:239]
    v_mfma_f32_32x32x16_bf16 v[176:191], v[68:71], v[52:55], v[176:191]
    v_mfma_f32_32x32x16_bf16 v[192:207], v[68:71], v[60:63], v[192:207]
    v_mfma_f32_32x32x16_bf16 v[208:223], v[76:79], v[52:55], v[208:223]
    v_mfma_f32_32x32x16_bf16 v[224:239], v[76:79], v[60:63], v[224:239]
    s_waitcnt vmcnt(24)
    v_mfma_f32_32x32x16_bf16 v[176:191], v[96:99], v[80:83], v[176:191]
    v_mfma_f32_32x32x16_bf16 v[192:207], v[96:99], v[88:91], v[192:207]
    v_mfma_f32_32x32x16_bf16 v[208:223], v[104:107], v[80:83], v[208:223]
    v_mfma_f32_32x32x16_bf16 v[224:239], v[104:107], v[88:91], v[224:239]
    v_mfma_f32_32x32x16_bf16 v[176:191], v[100:103], v[84:87], v[176:191]
    v_mfma_f32_32x32x16_bf16 v[192:207], v[100:103], v[92:95], v[192:207]
    v_mfma_f32_32x32x16_bf16 v[208:223], v[108:111], v[84:87], v[208:223]
    v_mfma_f32_32x32x16_bf16 v[224:239], v[108:111], v[92:95], v[224:239]
    s_waitcnt vmcnt(16)
    v_mfma_f32_32x32x16_bf16 v[176:191], v[128:131], v[112:115], v[176:191]
    v_mfma_f32_32x32x16_bf16 v[192:207], v[128:131], v[120:123], v[192:207]
    v_mfma_f32_32x32x16_bf16 v[208:223], v[136:139], v[112:115], v[208:223]
    v_mfma_f32_32x32x16_bf16 v[224:239], v[136:139], v[120:123], v[224:239]
    v_mfma_f32_32x32x16_bf16 v[176:191], v[132:135], v[116:119], v[176:191]
    v_mfma_f32_32x32x16_bf16 v[192:207], v[132:135], v[124:127], v[192:207]
    v_mfma_f32_32x32x16_bf16 v[208:223], v[140:143], v[116:119], v[208:223]
    v_mfma_f32_32x32x16_bf16 v[224:239], v[140:143], v[124:127], v[224:239]
    s_waitcnt vmcnt(8)
    v_mfma_f32_32x32x16_bf16 v[176:191], v[160:163], v[144:147], v[176:191]
    v_mfma_f32_32x32x16_bf16 v[192:207], v[160:163], v[152:155], v[192:207]
    v_mfma_f32_32x32x16_bf16 v[208:223], v[168:171], v[144:147], v[208:223]
    v_mfma_f32_32x32x16_bf16 v[224:239], v[168:171], v[152:155], v[224:239]
    v_mfma_f32_32x32x16_bf16 v[176:191], v[164:167], v[148:151], v[176:191]
    v_mfma_f32_32x32x16_bf16 v[192:207], v[164:167], v[156:159], v[192:207]
    v_mfma_f32_32x32x16_bf16 v[208:223], v[172:175], v[148:151], v[208:223]
    v_mfma_f32_32x32x16_bf16 v[224:239], v[172:175], v[156:159], v[224:239]
    s_waitcnt vmcnt(0)
    v_mfma_f32_32x32x16_bf16 v[176:191], v[32:35], v[16:19], v[176:191]
    v_mfma_f32_32x32x16_bf16 v[192:207], v[32:35], v[24:27], v[192:207]
    v_mfma_f32_32x32x16_bf16 v[208:223], v[40:43], v[16:19], v[208:223]
    v_mfma_f32_32x32x16_bf16 v[224:239], v[40:43], v[24:27], v[224:239]
    v_mfma_f32_32x32x16_bf16 v[176:191], v[36:39], v[20:23], v[176:191]
    v_mfma_f32_32x32x16_bf16 v[192:207], v[36:39], v[28:31], v[192:207]
    v_mfma_f32_32x32x16_bf16 v[208:223], v[44:47], v[20:23], v[208:223]
    v_mfma_f32_32x32x16_bf16 v[224:239], v[44:47], v[28:31], v[224:239]
    s_nop 7
    s_nop 7
    s_lshl_b32 s54, s34, 14
    v_lshlrev_b32 v7, 4, v1
    v_add_u32 v10, s54, v7
    ds_write_b128 v10, v[176:179] offset:0
    ds_write_b128 v10, v[180:183] offset:1024
    ds_write_b128 v10, v[184:187] offset:2048
    ds_write_b128 v10, v[188:191] offset:3072
    ds_write_b128 v10, v[192:195] offset:4096
    ds_write_b128 v10, v[196:199] offset:5120
    ds_write_b128 v10, v[200:203] offset:6144
    ds_write_b128 v10, v[204:207] offset:7168
    ds_write_b128 v10, v[208:211] offset:8192
    ds_write_b128 v10, v[212:215] offset:9216
    ds_write_b128 v10, v[216:219] offset:10240
    ds_write_b128 v10, v[220:223] offset:11264
    ds_write_b128 v10, v[224:227] offset:12288
    ds_write_b128 v10, v[228:231] offset:13312
    ds_write_b128 v10, v[232:235] offset:14336
    ds_write_b128 v10, v[236:239] offset:15360
    s_waitcnt lgkmcnt(0)
    s_barrier
    s_lshl_b32 s54, s34, 11
    v_add_u32 v10, s54, v7
    v_add_u32 v8, 0x10000, v10
    ds_read_b128 v[16:19], v10 offset:0
    ds_read_b128 v[20:23], v10 offset:1024
    ds_read_b128 v[24:27], v10 offset:16384
    ds_read_b128 v[28:31], v10 offset:17408
    ds_read_b128 v[32:35], v10 offset:32768
    ds_read_b128 v[36:39], v10 offset:33792
    ds_read_b128 v[40:43], v10 offset:49152
    ds_read_b128 v[44:47], v10 offset:50176
    ds_read_b128 v[48:51], v8 offset:0
    ds_read_b128 v[52:55], v8 offset:1024
    ds_read_b128 v[56:59], v8 offset:16384
    ds_read_b128 v[60:63], v8 offset:17408
    ds_read_b128 v[64:67], v8 offset:32768
    ds_read_b128 v[68:71], v8 offset:33792
    ds_read_b128 v[72:75], v8 offset:49152
    ds_read_b128 v[76:79], v8 offset:50176
    s_waitcnt lgkmcnt(0)
    v_add_f32 v16, v16, v24
    v_add_f32 v32, v32, v40
    v_add_f32 v48, v48, v56
    v_add_f32 v64, v64, v72
    v_add_f32 v17, v17, v25
    v_add_f32 v33, v33, v41
    v_add_f32 v49, v49, v57
    v_add_f32 v65, v65, v73
    v_add_f32 v18, v18, v26
    v_add_f32 v34, v34, v42
    v_add_f32 v50, v50, v58
    v_add_f32 v66, v66, v74
    v_add_f32 v19, v19, v27
    v_add_f32 v35, v35, v43
    v_add_f32 v51, v51, v59
    v_add_f32 v67, v67, v75
    v_add_f32 v20, v20, v28
    v_add_f32 v36, v36, v44
    v_add_f32 v52, v52, v60
    v_add_f32 v68, v68, v76
    v_add_f32 v21, v21, v29
    v_add_f32 v37, v37, v45
    v_add_f32 v53, v53, v61
    v_add_f32 v69, v69, v77
    v_add_f32 v22, v22, v30
    v_add_f32 v38, v38, v46
    v_add_f32 v54, v54, v62
    v_add_f32 v70, v70, v78
    v_add_f32 v23, v23, v31
    v_add_f32 v39, v39, v47
    v_add_f32 v55, v55, v63
    v_add_f32 v71, v71, v79
    v_add_f32 v16, v16, v32
    v_add_f32 v48, v48, v64
    v_add_f32 v17, v17, v33
    v_add_f32 v49, v49, v65
    v_add_f32 v18, v18, v34
    v_add_f32 v50, v50, v66
    v_add_f32 v19, v19, v35
    v_add_f32 v51, v51, v67
    v_add_f32 v20, v20, v36
    v_add_f32 v52, v52, v68
    v_add_f32 v21, v21, v37
    v_add_f32 v53, v53, v69
    v_add_f32 v22, v22, v38
    v_add_f32 v54, v54, v70
    v_add_f32 v23, v23, v39
    v_add_f32 v55, v55, v71
    v_add_f32 v16, v16, v48
    v_add_f32 v17, v17, v49
    v_add_f32 v18, v18, v50
    v_add_f32 v19, v19, v51
    v_add_f32 v20, v20, v52
    v_add_f32 v21, v21, v53
    v_add_f32 v22, v22, v54
    v_add_f32 v23, v23, v55
    s_bfe_u32 s54, s34, 0x10001
    s_lshl_b32 s54, s54, 15
    s_lshr_b32 s55, s34, 2
    s_lshl_b32 s55, s55, 6
    s_add_u32 s54, s54, s55
    s_and_b32 s55, s34, 1
    s_lshl_b32 s55, s55, 5
    s_add_u32 s54, s54, s55
    v_and_b32 v8, 31, v1
    v_lshlrev_b32 v8, 10, v8
    v_lshrrev_b32 v9, 5, v1
    v_lshl_add_u32 v8, v9, 3, v8
    v_add_u32 v11, s54, v8
    v_cvt_pk_bf16_f32 v80, v16, v17
    v_cvt_pk_bf16_f32 v81, v18, v19
    buffer_store_dwordx2 v[80:81], v11, s[20:23], 0 offen offset:0
    v_cvt_pk_bf16_f32 v82, v20, v21
    v_cvt_pk_bf16_f32 v83, v22, v23
    buffer_store_dwordx2 v[82:83], v11, s[20:23], 0 offen offset:16
L_gemm_done:
    s_endpgm
.section .rodata,"a"
.p2align 6
.amdhsa_kernel attn_kernel
  .amdhsa_next_free_vgpr 252
  .amdhsa_next_free_sgpr 100
  .amdhsa_accum_offset 252
  .amdhsa_group_segment_fixed_size 0
  .amdhsa_kernarg_size 64
  .amdhsa_user_sgpr_count 2
  .amdhsa_user_sgpr_kernarg_segment_ptr 1
  .amdhsa_system_sgpr_workgroup_id_x 1
  .amdhsa_float_denorm_mode_32 3
.end_amdhsa_kernel
.p2align 6
.amdhsa_kernel oproj_kernel
  .amdhsa_next_free_vgpr 240
  .amdhsa_next_free_sgpr 100
  .amdhsa_accum_offset 240
  .amdhsa_group_segment_fixed_size 0
  .amdhsa_kernarg_size 64
  .amdhsa_user_sgpr_count 2
  .amdhsa_user_sgpr_kernarg_segment_ptr 1
  .amdhsa_system_sgpr_workgroup_id_x 1
  .amdhsa_float_denorm_mode_32 3
.end_amdhsa_kernel
```
